```python
import torch

def _softmax(x, axis=-1):
    return torch.softmax(x, dim=axis)

def _gelu(x):
    return torch.nn.functional.gelu(x, approximate='tanh')

def _silu(x):
    return torch.nn.functional.silu(x)

def _sigmoid(x):
    return torch.sigmoid(x)

def _layernorm(x, axis=-1, eps=1e-05):
    m = x.mean(dim=axis, keepdim=True)
    v = x.var(dim=axis, keepdim=True, unbiased=False)
    return (x - m) / torch.sqrt(v + eps)

def _scatter_add(tgt, idx, src, axis=0):
    return tgt.clone().index_add_(axis, idx, src)

def _segment_sum(src, seg, n):
    out = torch.zeros((n,) + src.shape[1:], dtype=src.dtype)
    return out.index_add_(0, seg, src)

def _pad(x, pw):
    flat = tuple((v for pair in reversed(pw) for v in pair))
    return torch.nn.functional.pad(x, flat)
kernel_name = 'gated_mix__ssm_conv_s5__memory_aug_recurrent_mem_tr__prompt'

def setup_inputs():

    _w = lambda a: (lambda t: t.to(torch.bfloat16) if t.is_floating_point() else t)(torch.as_tensor(a))

    def _A_setup():
        B, S, D = (1, 2048, 448)
        P = D
        Lambda_re = -0.5 * (lambda _x: torch.exp(torch.as_tensor(_x)))((lambda *s: torch.randn(*s, dtype=torch.bfloat16) * 0.8)(P))
        Lambda_im = (lambda *s: torch.randn(*s, dtype=torch.bfloat16) * 0.8)(P) * 1.0
        B_re = (lambda *s: torch.randn(*s, dtype=torch.bfloat16) * 0.8)(P, D) * D ** (-0.5)
        B_im = (lambda *s: torch.randn(*s, dtype=torch.bfloat16) * 0.8)(P, D) * D ** (-0.5)
        C_re = (lambda *s: torch.randn(*s, dtype=torch.bfloat16) * 0.8)(D, P) * P ** (-0.5)
        C_im = (lambda *s: torch.randn(*s, dtype=torch.bfloat16) * 0.8)(D, P) * P ** (-0.5)
        log_dt = (lambda *s: torch.randn(*s, dtype=torch.bfloat16) * 0.8)(P) * 0.3 - 2.0
        Dskip = (lambda *s: torch.randn(*s, dtype=torch.bfloat16) * 0.8)(D)
        return {'x': _w((lambda *s: torch.randn(*s, dtype=torch.bfloat16) * 0.05)(B, S, D)), 'Lambda_re': _w(Lambda_re), 'Lambda_im': _w(Lambda_im), 'B_re': _w(B_re), 'B_im': _w(B_im), 'C_re': _w(C_re), 'C_im': _w(C_im), 'log_dt': _w(log_dt), 'Dskip': _w(Dskip)}
    _A_in = _A_setup()

    def _B_setup():
        B, S, Dm = (1, 2048, 448)
        H, Dh = (16, 256)
        M, seg = (8, 32)
        seg = min(seg, S)
        S = S // seg * seg
        return {'x': _w((lambda *s: torch.randn(*s, dtype=torch.bfloat16) * 0.05)(B, S, Dm)), 'mem0': _w((lambda *s: torch.randn(*s, dtype=torch.bfloat16) * 0.8)(B, M, Dm)), 'Wq': _w((lambda *s: torch.randn(*s, dtype=torch.bfloat16) * 3.2)(Dm, H, Dh) * Dm ** (-0.5)), 'Wk': _w((lambda *s: torch.randn(*s, dtype=torch.bfloat16) * 3.2)(Dm, H, Dh) * Dm ** (-0.5)), 'Wv': _w((lambda *s: torch.randn(*s, dtype=torch.bfloat16) * 0.8)(Dm, H, Dh) * Dm ** (-0.5)), 'Wo': _w((lambda *s: torch.randn(*s, dtype=torch.bfloat16) * 0.8)(H, Dh, Dm) * (H * Dh) ** (-0.5)), 'seg_len': seg}
    _B_in = _B_setup()
    return {'A_x': _A_in['x'], 'A_Lambda_re': _A_in['Lambda_re'], 'A_Lambda_im': _A_in['Lambda_im'], 'A_B_re': _A_in['B_re'], 'A_B_im': _A_in['B_im'], 'A_C_re': _A_in['C_re'], 'A_C_im': _A_in['C_im'], 'A_log_dt': _A_in['log_dt'], 'A_Dskip': _A_in['Dskip'], 'B_x': _B_in['x'], 'B_mem0': _B_in['mem0'], 'B_Wq': _B_in['Wq'], 'B_Wk': _B_in['Wk'], 'B_Wv': _B_in['Wv'], 'B_Wo': _B_in['Wo'], 'B_seg_len': _B_in['seg_len'], 'gate_w': _w((lambda *s: torch.randn(*s, dtype=torch.bfloat16) * 0.05)(448) * 16.0)}

def reference(A_x, A_Lambda_re, A_Lambda_im, A_B_re, A_B_im, A_C_re, A_C_im, A_log_dt, A_Dskip, B_x, B_mem0, B_Wq, B_Wk, B_Wv, B_Wo, B_seg_len, gate_w):

    def _A_ref(x, Lambda_re, Lambda_im, B_re, B_im, C_re, C_im, log_dt, Dskip):
        Bsz, L, H = x.shape
        Lam = Lambda_re + 1j * Lambda_im
        Bmat = B_re + 1j * B_im
        Cmat = C_re + 1j * C_im
        dt = torch.exp(log_dt)
        Lam_bar = torch.exp(dt * Lam)
        B_bar = ((Lam_bar - 1.0) / Lam)[:, None] * Bmat
        Bu = torch.einsum('bld,pd->blp', x + 0j, B_bar)
        h = torch.zeros_like(Bu[:, 0, :])
        hs = []
        for t in range(L):
            h = Lam_bar[None, :] * h + Bu[:, t, :]
            hs.append(h)
        hseq = torch.stack(hs, 1)
        y = 2.0 * torch.einsum('blp,dp->bld', hseq, Cmat).real + x * Dskip[None, None, :]
        return y

    def _B_ref(x, mem0, Wq, Wk, Wv, Wo, seg_len):
        B, S, Dm = x.shape
        H, Dh = (Wq.shape[1], Wq.shape[2])
        M = mem0.shape[1]
        scale = Dh ** (-0.5)
        n_seg = S // seg_len
        L = M + seg_len
        idx = torch.arange(L)
        mask = (idx[:, None] < M) | (idx[:, None] >= idx[None, :])
        mem = mem0
        outs = []
        for s in range(n_seg):
            xs = x[:, s * seg_len:(s + 1) * seg_len, :].clone()
            h = torch.concatenate([mem, xs], axis=1)
            q = torch.einsum('btd,dhe->bhte', h, Wq)
            k = torch.einsum('btd,dhe->bhte', h, Wk)
            v = torch.einsum('btd,dhe->bhte', h, Wv)
            scores = torch.einsum('bhqe,bhke->bhqk', q, k) * scale
            scores = torch.where(mask[None, None], scores, -1000000000.0)
            p = _softmax(scores, axis=-1)
            o = torch.einsum('bhqk,bhke->bhqe', p, v)
            o = torch.einsum('bhte,hed->btd', o, Wo)
            mem = o[:, :M, :].clone()
            outs.append(o[:, M:, :])
        return torch.concatenate(outs, axis=1)
    x = A_x
    g = _sigmoid((x * gate_w).sum(-1, keepdims=True))
    a = _A_ref(x, A_Lambda_re, A_Lambda_im, A_B_re, A_B_im, A_C_re, A_C_im, A_log_dt, A_Dskip)
    b = _B_ref(x, B_mem0, B_Wq, B_Wk, B_Wv, B_Wo, B_seg_len)
    return g * a + (1 - g) * b
```

```asm
; @launch kernel=prep_kernel grid=(648,1,1) block=(256,1,1) lds=65536
; @launch kernel=chain_kernel grid=(256,1,1) block=(256,1,1) lds=86016
.amdgcn_target "amdgcn-amd-amdhsa--gfx950"
.text
.globl prep_kernel
.p2align 8
.type prep_kernel,@function
prep_kernel:
    s_cmp_ge_u32 s2, 648
    s_cbranch_scc1 prep_end
    v_and_b32 v1, 63, v0
    v_and_b32 v2, 15, v0
    v_lshrrev_b32 v3, 4, v1
    v_lshrrev_b32 v4, 6, v0
    s_nop 0
    v_readfirstlane_b32 s3, v4
    s_cmp_ge_u32 s2, 392
    s_cbranch_scc1 prep_aux
    s_and_b32 s20, s2, 7
    s_mul_i32 s20, s20, 196
    s_lshr_b32 s21, s2, 3
    s_lshl_b32 s21, s21, 2
    s_add_u32 s20, s20, s21
    s_add_u32 s20, s20, s3
    s_mul_i32 s4, s20, 1338
    s_lshr_b32 s4, s4, 20
    s_mul_i32 s21, s4, 784
    s_sub_u32 s20, s20, s21
    s_mul_i32 s5, s20, 21400
    s_lshr_b32 s5, s5, 20
    s_mul_i32 s21, s5, 49
    s_sub_u32 s20, s20, s21
    s_mul_i32 s6, s20, 149797
    s_lshr_b32 s6, s6, 20
    s_mul_i32 s21, s6, 7
    s_sub_u32 s7, s20, s21
    s_load_dwordx2 s[8:9], s[0:1], 88
    s_load_dwordx2 s[12:13], s[0:1], 96
    s_load_dwordx2 s[22:23], s[0:1], 104
    s_load_dwordx2 s[24:25], s[0:1], 112
    s_load_dwordx2 s[16:17], s[0:1], 152
    s_waitcnt lgkmcnt(0)
    s_cmp_eq_u32 s4, 1
    s_cselect_b32 s8, s22, s8
    s_cselect_b32 s9, s23, s9
    s_cselect_b32 s12, s24, s12
    s_cselect_b32 s13, s25, s13
    s_and_b32 s9, s9, 0xffff
    s_mov_b32 s11, 0x20000
    s_and_b32 s13, s13, 0xffff
    s_mov_b32 s15, 0x20000
    s_and_b32 s17, s17, 0xffff
    s_mov_b32 s19, 0x20000
    s_mov_b32 s10, 3670016
    s_mov_b32 s14, 3670016
    s_mov_b32 s18, 26607616
    s_lshl_b32 s20, s6, 6
    v_add_u32 v4, s20, v2
    v_lshlrev_b32 v4, 13, v4
    v_lshlrev_b32 v5, 4, v3
    v_add_u32 v4, v4, v5
    s_lshl_b32 s21, s5, 9
    v_add_u32 v4, s21, v4
    v_mov_b32 v160, 0
    v_mov_b32 v161, 0
    v_mov_b32 v162, 0
    v_mov_b32 v163, 0
    v_mov_b32 v164, 0
    v_mov_b32 v165, 0
    v_mov_b32 v166, 0
    v_mov_b32 v167, 0
    v_mov_b32 v168, 0
    v_mov_b32 v169, 0
    v_mov_b32 v170, 0
    v_mov_b32 v171, 0
    v_mov_b32 v172, 0
    v_mov_b32 v173, 0
    v_mov_b32 v174, 0
    v_mov_b32 v175, 0
    v_mov_b32 v176, 0
    v_mov_b32 v177, 0
    v_mov_b32 v178, 0
    v_mov_b32 v179, 0
    v_mov_b32 v180, 0
    v_mov_b32 v181, 0
    v_mov_b32 v182, 0
    v_mov_b32 v183, 0
    v_mov_b32 v184, 0
    v_mov_b32 v185, 0
    v_mov_b32 v186, 0
    v_mov_b32 v187, 0
    v_mov_b32 v188, 0
    v_mov_b32 v189, 0
    v_mov_b32 v190, 0
    v_mov_b32 v191, 0
    v_mov_b32 v192, 0
    v_mov_b32 v193, 0
    v_mov_b32 v194, 0
    v_mov_b32 v195, 0
    v_mov_b32 v196, 0
    v_mov_b32 v197, 0
    v_mov_b32 v198, 0
    v_mov_b32 v199, 0
    v_mov_b32 v200, 0
    v_mov_b32 v201, 0
    v_mov_b32 v202, 0
    v_mov_b32 v203, 0
    v_mov_b32 v204, 0
    v_mov_b32 v205, 0
    v_mov_b32 v206, 0
    v_mov_b32 v207, 0
    v_mov_b32 v208, 0
    v_mov_b32 v209, 0
    v_mov_b32 v210, 0
    v_mov_b32 v211, 0
    v_mov_b32 v212, 0
    v_mov_b32 v213, 0
    v_mov_b32 v214, 0
    v_mov_b32 v215, 0
    v_mov_b32 v216, 0
    v_mov_b32 v217, 0
    v_mov_b32 v218, 0
    v_mov_b32 v219, 0
    v_mov_b32 v220, 0
    v_mov_b32 v221, 0
    v_mov_b32 v222, 0
    v_mov_b32 v223, 0
    s_lshl_b32 s30, s3, 14
    v_lshrrev_b32 v12, 2, v1
    v_and_b32 v13, 3, v1
    v_xor_b32 v13, v13, v3
    v_lshlrev_b32 v13, 4, v13
    v_lshrrev_b32 v15, 2, v2
    v_xor_b32 v15, v15, v3
    v_lshlrev_b32 v14, 6, v2
    v_lshl_add_u32 v14, v15, 4, v14
    v_add_u32 v14, s30, v14
    s_lshl_b32 s20, s6, 6
    v_add_u32 v4, s20, v12
    v_lshlrev_b32 v4, 13, v4
    v_add_u32 v4, v4, v13
    v_add_u32 v4, s21, v4
    s_cmp_eq_u32 s4, 1
    s_cbranch_scc1 prep_vo
    s_lshl_b32 s20, s7, 6
    v_add_u32 v6, s20, v12
    v_lshlrev_b32 v6, 13, v6
    v_add_u32 v6, v6, v13
    v_add_u32 v6, s21, v6
    s_add_u32 m0, s30, 0
    s_mov_b32 s26, 0
    buffer_load_dwordx4 v4, s[8:11], s26 offen lds
    s_add_u32 m0, s30, 1024
    s_mov_b32 s26, 131072
    buffer_load_dwordx4 v4, s[8:11], s26 offen lds
    s_add_u32 m0, s30, 2048
    s_mov_b32 s26, 262144
    buffer_load_dwordx4 v4, s[8:11], s26 offen lds
    s_add_u32 m0, s30, 3072
    s_mov_b32 s26, 393216
    buffer_load_dwordx4 v4, s[8:11], s26 offen lds
    s_add_u32 m0, s30, 4096
    s_mov_b32 s26, 0
    buffer_load_dwordx4 v6, s[12:15], s26 offen lds
    s_add_u32 m0, s30, 5120
    s_mov_b32 s26, 131072
    buffer_load_dwordx4 v6, s[12:15], s26 offen lds
    s_add_u32 m0, s30, 6144
    s_mov_b32 s26, 262144
    buffer_load_dwordx4 v6, s[12:15], s26 offen lds
    s_add_u32 m0, s30, 7168
    s_mov_b32 s26, 393216
    buffer_load_dwordx4 v6, s[12:15], s26 offen lds
    s_add_u32 m0, s30, 8192
    s_mov_b32 s26, 64
    buffer_load_dwordx4 v4, s[8:11], s26 offen lds
    s_add_u32 m0, s30, 9216
    s_mov_b32 s26, 131136
    buffer_load_dwordx4 v4, s[8:11], s26 offen lds
    s_add_u32 m0, s30, 10240
    s_mov_b32 s26, 262208
    buffer_load_dwordx4 v4, s[8:11], s26 offen lds
    s_add_u32 m0, s30, 11264
    s_mov_b32 s26, 393280
    buffer_load_dwordx4 v4, s[8:11], s26 offen lds
    s_add_u32 m0, s30, 12288
    s_mov_b32 s26, 64
    buffer_load_dwordx4 v6, s[12:15], s26 offen lds
    s_add_u32 m0, s30, 13312
    s_mov_b32 s26, 131136
    buffer_load_dwordx4 v6, s[12:15], s26 offen lds
    s_add_u32 m0, s30, 14336
    s_mov_b32 s26, 262208
    buffer_load_dwordx4 v6, s[12:15], s26 offen lds
    s_add_u32 m0, s30, 15360
    s_mov_b32 s26, 393280
    buffer_load_dwordx4 v6, s[12:15], s26 offen lds
    s_waitcnt vmcnt(8)
    ds_read_b128 v[16:19], v14 offset:0
    ds_read_b128 v[20:23], v14 offset:1024
    ds_read_b128 v[24:27], v14 offset:2048
    ds_read_b128 v[28:31], v14 offset:3072
    ds_read_b128 v[32:35], v14 offset:4096
    ds_read_b128 v[36:39], v14 offset:5120
    ds_read_b128 v[40:43], v14 offset:6144
    ds_read_b128 v[44:47], v14 offset:7168
    s_waitcnt lgkmcnt(0)
    v_mfma_f32_16x16x32_bf16 v[160:163], v[16:19], v[32:35], v[160:163]
    v_mfma_f32_16x16x32_bf16 v[164:167], v[16:19], v[36:39], v[164:167]
    v_mfma_f32_16x16x32_bf16 v[168:171], v[16:19], v[40:43], v[168:171]
    v_mfma_f32_16x16x32_bf16 v[172:175], v[16:19], v[44:47], v[172:175]
    v_mfma_f32_16x16x32_bf16 v[176:179], v[20:23], v[32:35], v[176:179]
    v_mfma_f32_16x16x32_bf16 v[180:183], v[20:23], v[36:39], v[180:183]
    v_mfma_f32_16x16x32_bf16 v[184:187], v[20:23], v[40:43], v[184:187]
    v_mfma_f32_16x16x32_bf16 v[188:191], v[20:23], v[44:47], v[188:191]
    v_mfma_f32_16x16x32_bf16 v[192:195], v[24:27], v[32:35], v[192:195]
    v_mfma_f32_16x16x32_bf16 v[196:199], v[24:27], v[36:39], v[196:199]
    v_mfma_f32_16x16x32_bf16 v[200:203], v[24:27], v[40:43], v[200:203]
    v_mfma_f32_16x16x32_bf16 v[204:207], v[24:27], v[44:47], v[204:207]
    v_mfma_f32_16x16x32_bf16 v[208:211], v[28:31], v[32:35], v[208:211]
    v_mfma_f32_16x16x32_bf16 v[212:215], v[28:31], v[36:39], v[212:215]
    v_mfma_f32_16x16x32_bf16 v[216:219], v[28:31], v[40:43], v[216:219]
    v_mfma_f32_16x16x32_bf16 v[220:223], v[28:31], v[44:47], v[220:223]
    s_add_u32 m0, s30, 0
    s_mov_b32 s26, 128
    buffer_load_dwordx4 v4, s[8:11], s26 offen lds
    s_add_u32 m0, s30, 1024
    s_mov_b32 s26, 131200
    buffer_load_dwordx4 v4, s[8:11], s26 offen lds
    s_add_u32 m0, s30, 2048
    s_mov_b32 s26, 262272
    buffer_load_dwordx4 v4, s[8:11], s26 offen lds
    s_add_u32 m0, s30, 3072
    s_mov_b32 s26, 393344
    buffer_load_dwordx4 v4, s[8:11], s26 offen lds
    s_add_u32 m0, s30, 4096
    s_mov_b32 s26, 128
    buffer_load_dwordx4 v6, s[12:15], s26 offen lds
    s_add_u32 m0, s30, 5120
    s_mov_b32 s26, 131200
    buffer_load_dwordx4 v6, s[12:15], s26 offen lds
    s_add_u32 m0, s30, 6144
    s_mov_b32 s26, 262272
    buffer_load_dwordx4 v6, s[12:15], s26 offen lds
    s_add_u32 m0, s30, 7168
    s_mov_b32 s26, 393344
    buffer_load_dwordx4 v6, s[12:15], s26 offen lds
    s_waitcnt vmcnt(8)
    ds_read_b128 v[48:51], v14 offset:8192
    ds_read_b128 v[52:55], v14 offset:9216
    ds_read_b128 v[56:59], v14 offset:10240
    ds_read_b128 v[60:63], v14 offset:11264
    ds_read_b128 v[64:67], v14 offset:12288
    ds_read_b128 v[68:71], v14 offset:13312
    ds_read_b128 v[72:75], v14 offset:14336
    ds_read_b128 v[76:79], v14 offset:15360
    s_waitcnt lgkmcnt(0)
    v_mfma_f32_16x16x32_bf16 v[160:163], v[48:51], v[64:67], v[160:163]
    v_mfma_f32_16x16x32_bf16 v[164:167], v[48:51], v[68:71], v[164:167]
    v_mfma_f32_16x16x32_bf16 v[168:171], v[48:51], v[72:75], v[168:171]
    v_mfma_f32_16x16x32_bf16 v[172:175], v[48:51], v[76:79], v[172:175]
    v_mfma_f32_16x16x32_bf16 v[176:179], v[52:55], v[64:67], v[176:179]
    v_mfma_f32_16x16x32_bf16 v[180:183], v[52:55], v[68:71], v[180:183]
    v_mfma_f32_16x16x32_bf16 v[184:187], v[52:55], v[72:75], v[184:187]
    v_mfma_f32_16x16x32_bf16 v[188:191], v[52:55], v[76:79], v[188:191]
    v_mfma_f32_16x16x32_bf16 v[192:195], v[56:59], v[64:67], v[192:195]
    v_mfma_f32_16x16x32_bf16 v[196:199], v[56:59], v[68:71], v[196:199]
    v_mfma_f32_16x16x32_bf16 v[200:203], v[56:59], v[72:75], v[200:203]
    v_mfma_f32_16x16x32_bf16 v[204:207], v[56:59], v[76:79], v[204:207]
    v_mfma_f32_16x16x32_bf16 v[208:211], v[60:63], v[64:67], v[208:211]
    v_mfma_f32_16x16x32_bf16 v[212:215], v[60:63], v[68:71], v[212:215]
    v_mfma_f32_16x16x32_bf16 v[216:219], v[60:63], v[72:75], v[216:219]
    v_mfma_f32_16x16x32_bf16 v[220:223], v[60:63], v[76:79], v[220:223]
    s_add_u32 m0, s30, 8192
    s_mov_b32 s26, 192
    buffer_load_dwordx4 v4, s[8:11], s26 offen lds
    s_add_u32 m0, s30, 9216
    s_mov_b32 s26, 131264
    buffer_load_dwordx4 v4, s[8:11], s26 offen lds
    s_add_u32 m0, s30, 10240
    s_mov_b32 s26, 262336
    buffer_load_dwordx4 v4, s[8:11], s26 offen lds
    s_add_u32 m0, s30, 11264
    s_mov_b32 s26, 393408
    buffer_load_dwordx4 v4, s[8:11], s26 offen lds
    s_add_u32 m0, s30, 12288
    s_mov_b32 s26, 192
    buffer_load_dwordx4 v6, s[12:15], s26 offen lds
    s_add_u32 m0, s30, 13312
    s_mov_b32 s26, 131264
    buffer_load_dwordx4 v6, s[12:15], s26 offen lds
    s_add_u32 m0, s30, 14336
    s_mov_b32 s26, 262336
    buffer_load_dwordx4 v6, s[12:15], s26 offen lds
    s_add_u32 m0, s30, 15360
    s_mov_b32 s26, 393408
    buffer_load_dwordx4 v6, s[12:15], s26 offen lds
    s_waitcnt vmcnt(8)
    ds_read_b128 v[16:19], v14 offset:0
    ds_read_b128 v[20:23], v14 offset:1024
    ds_read_b128 v[24:27], v14 offset:2048
    ds_read_b128 v[28:31], v14 offset:3072
    ds_read_b128 v[32:35], v14 offset:4096
    ds_read_b128 v[36:39], v14 offset:5120
    ds_read_b128 v[40:43], v14 offset:6144
    ds_read_b128 v[44:47], v14 offset:7168
    s_waitcnt lgkmcnt(0)
    v_mfma_f32_16x16x32_bf16 v[160:163], v[16:19], v[32:35], v[160:163]
    v_mfma_f32_16x16x32_bf16 v[164:167], v[16:19], v[36:39], v[164:167]
    v_mfma_f32_16x16x32_bf16 v[168:171], v[16:19], v[40:43], v[168:171]
    v_mfma_f32_16x16x32_bf16 v[172:175], v[16:19], v[44:47], v[172:175]
    v_mfma_f32_16x16x32_bf16 v[176:179], v[20:23], v[32:35], v[176:179]
    v_mfma_f32_16x16x32_bf16 v[180:183], v[20:23], v[36:39], v[180:183]
    v_mfma_f32_16x16x32_bf16 v[184:187], v[20:23], v[40:43], v[184:187]
    v_mfma_f32_16x16x32_bf16 v[188:191], v[20:23], v[44:47], v[188:191]
    v_mfma_f32_16x16x32_bf16 v[192:195], v[24:27], v[32:35], v[192:195]
    v_mfma_f32_16x16x32_bf16 v[196:199], v[24:27], v[36:39], v[196:199]
    v_mfma_f32_16x16x32_bf16 v[200:203], v[24:27], v[40:43], v[200:203]
    v_mfma_f32_16x16x32_bf16 v[204:207], v[24:27], v[44:47], v[204:207]
    v_mfma_f32_16x16x32_bf16 v[208:211], v[28:31], v[32:35], v[208:211]
    v_mfma_f32_16x16x32_bf16 v[212:215], v[28:31], v[36:39], v[212:215]
    v_mfma_f32_16x16x32_bf16 v[216:219], v[28:31], v[40:43], v[216:219]
    v_mfma_f32_16x16x32_bf16 v[220:223], v[28:31], v[44:47], v[220:223]
    s_add_u32 m0, s30, 0
    s_mov_b32 s26, 256
    buffer_load_dwordx4 v4, s[8:11], s26 offen lds
    s_add_u32 m0, s30, 1024
    s_mov_b32 s26, 131328
    buffer_load_dwordx4 v4, s[8:11], s26 offen lds
    s_add_u32 m0, s30, 2048
    s_mov_b32 s26, 262400
    buffer_load_dwordx4 v4, s[8:11], s26 offen lds
    s_add_u32 m0, s30, 3072
    s_mov_b32 s26, 393472
    buffer_load_dwordx4 v4, s[8:11], s26 offen lds
    s_add_u32 m0, s30, 4096
    s_mov_b32 s26, 256
    buffer_load_dwordx4 v6, s[12:15], s26 offen lds
    s_add_u32 m0, s30, 5120
    s_mov_b32 s26, 131328
    buffer_load_dwordx4 v6, s[12:15], s26 offen lds
    s_add_u32 m0, s30, 6144
    s_mov_b32 s26, 262400
    buffer_load_dwordx4 v6, s[12:15], s26 offen lds
    s_add_u32 m0, s30, 7168
    s_mov_b32 s26, 393472
    buffer_load_dwordx4 v6, s[12:15], s26 offen lds
    s_waitcnt vmcnt(8)
    ds_read_b128 v[48:51], v14 offset:8192
    ds_read_b128 v[52:55], v14 offset:9216
    ds_read_b128 v[56:59], v14 offset:10240
    ds_read_b128 v[60:63], v14 offset:11264
    ds_read_b128 v[64:67], v14 offset:12288
    ds_read_b128 v[68:71], v14 offset:13312
    ds_read_b128 v[72:75], v14 offset:14336
    ds_read_b128 v[76:79], v14 offset:15360
    s_waitcnt lgkmcnt(0)
    v_mfma_f32_16x16x32_bf16 v[160:163], v[48:51], v[64:67], v[160:163]
    v_mfma_f32_16x16x32_bf16 v[164:167], v[48:51], v[68:71], v[164:167]
    v_mfma_f32_16x16x32_bf16 v[168:171], v[48:51], v[72:75], v[168:171]
    v_mfma_f32_16x16x32_bf16 v[172:175], v[48:51], v[76:79], v[172:175]
    v_mfma_f32_16x16x32_bf16 v[176:179], v[52:55], v[64:67], v[176:179]
    v_mfma_f32_16x16x32_bf16 v[180:183], v[52:55], v[68:71], v[180:183]
    v_mfma_f32_16x16x32_bf16 v[184:187], v[52:55], v[72:75], v[184:187]
    v_mfma_f32_16x16x32_bf16 v[188:191], v[52:55], v[76:79], v[188:191]
    v_mfma_f32_16x16x32_bf16 v[192:195], v[56:59], v[64:67], v[192:195]
    v_mfma_f32_16x16x32_bf16 v[196:199], v[56:59], v[68:71], v[196:199]
    v_mfma_f32_16x16x32_bf16 v[200:203], v[56:59], v[72:75], v[200:203]
    v_mfma_f32_16x16x32_bf16 v[204:207], v[56:59], v[76:79], v[204:207]
    v_mfma_f32_16x16x32_bf16 v[208:211], v[60:63], v[64:67], v[208:211]
    v_mfma_f32_16x16x32_bf16 v[212:215], v[60:63], v[68:71], v[212:215]
    v_mfma_f32_16x16x32_bf16 v[216:219], v[60:63], v[72:75], v[216:219]
    v_mfma_f32_16x16x32_bf16 v[220:223], v[60:63], v[76:79], v[220:223]
    s_add_u32 m0, s30, 8192
    s_mov_b32 s26, 320
    buffer_load_dwordx4 v4, s[8:11], s26 offen lds
    s_add_u32 m0, s30, 9216
    s_mov_b32 s26, 131392
    buffer_load_dwordx4 v4, s[8:11], s26 offen lds
    s_add_u32 m0, s30, 10240
    s_mov_b32 s26, 262464
    buffer_load_dwordx4 v4, s[8:11], s26 offen lds
    s_add_u32 m0, s30, 11264
    s_mov_b32 s26, 393536
    buffer_load_dwordx4 v4, s[8:11], s26 offen lds
    s_add_u32 m0, s30, 12288
    s_mov_b32 s26, 320
    buffer_load_dwordx4 v6, s[12:15], s26 offen lds
    s_add_u32 m0, s30, 13312
    s_mov_b32 s26, 131392
    buffer_load_dwordx4 v6, s[12:15], s26 offen lds
    s_add_u32 m0, s30, 14336
    s_mov_b32 s26, 262464
    buffer_load_dwordx4 v6, s[12:15], s26 offen lds
    s_add_u32 m0, s30, 15360
    s_mov_b32 s26, 393536
    buffer_load_dwordx4 v6, s[12:15], s26 offen lds
    s_waitcnt vmcnt(8)
    ds_read_b128 v[16:19], v14 offset:0
    ds_read_b128 v[20:23], v14 offset:1024
    ds_read_b128 v[24:27], v14 offset:2048
    ds_read_b128 v[28:31], v14 offset:3072
    ds_read_b128 v[32:35], v14 offset:4096
    ds_read_b128 v[36:39], v14 offset:5120
    ds_read_b128 v[40:43], v14 offset:6144
    ds_read_b128 v[44:47], v14 offset:7168
    s_waitcnt lgkmcnt(0)
    v_mfma_f32_16x16x32_bf16 v[160:163], v[16:19], v[32:35], v[160:163]
    v_mfma_f32_16x16x32_bf16 v[164:167], v[16:19], v[36:39], v[164:167]
    v_mfma_f32_16x16x32_bf16 v[168:171], v[16:19], v[40:43], v[168:171]
    v_mfma_f32_16x16x32_bf16 v[172:175], v[16:19], v[44:47], v[172:175]
    v_mfma_f32_16x16x32_bf16 v[176:179], v[20:23], v[32:35], v[176:179]
    v_mfma_f32_16x16x32_bf16 v[180:183], v[20:23], v[36:39], v[180:183]
    v_mfma_f32_16x16x32_bf16 v[184:187], v[20:23], v[40:43], v[184:187]
    v_mfma_f32_16x16x32_bf16 v[188:191], v[20:23], v[44:47], v[188:191]
    v_mfma_f32_16x16x32_bf16 v[192:195], v[24:27], v[32:35], v[192:195]
    v_mfma_f32_16x16x32_bf16 v[196:199], v[24:27], v[36:39], v[196:199]
    v_mfma_f32_16x16x32_bf16 v[200:203], v[24:27], v[40:43], v[200:203]
    v_mfma_f32_16x16x32_bf16 v[204:207], v[24:27], v[44:47], v[204:207]
    v_mfma_f32_16x16x32_bf16 v[208:211], v[28:31], v[32:35], v[208:211]
    v_mfma_f32_16x16x32_bf16 v[212:215], v[28:31], v[36:39], v[212:215]
    v_mfma_f32_16x16x32_bf16 v[216:219], v[28:31], v[40:43], v[216:219]
    v_mfma_f32_16x16x32_bf16 v[220:223], v[28:31], v[44:47], v[220:223]
    s_add_u32 m0, s30, 0
    s_mov_b32 s26, 384
    buffer_load_dwordx4 v4, s[8:11], s26 offen lds
    s_add_u32 m0, s30, 1024
    s_mov_b32 s26, 131456
    buffer_load_dwordx4 v4, s[8:11], s26 offen lds
    s_add_u32 m0, s30, 2048
    s_mov_b32 s26, 262528
    buffer_load_dwordx4 v4, s[8:11], s26 offen lds
    s_add_u32 m0, s30, 3072
    s_mov_b32 s26, 393600
    buffer_load_dwordx4 v4, s[8:11], s26 offen lds
    s_add_u32 m0, s30, 4096
    s_mov_b32 s26, 384
    buffer_load_dwordx4 v6, s[12:15], s26 offen lds
    s_add_u32 m0, s30, 5120
    s_mov_b32 s26, 131456
    buffer_load_dwordx4 v6, s[12:15], s26 offen lds
    s_add_u32 m0, s30, 6144
    s_mov_b32 s26, 262528
    buffer_load_dwordx4 v6, s[12:15], s26 offen lds
    s_add_u32 m0, s30, 7168
    s_mov_b32 s26, 393600
    buffer_load_dwordx4 v6, s[12:15], s26 offen lds
    s_waitcnt vmcnt(8)
    ds_read_b128 v[48:51], v14 offset:8192
    ds_read_b128 v[52:55], v14 offset:9216
    ds_read_b128 v[56:59], v14 offset:10240
    ds_read_b128 v[60:63], v14 offset:11264
    ds_read_b128 v[64:67], v14 offset:12288
    ds_read_b128 v[68:71], v14 offset:13312
    ds_read_b128 v[72:75], v14 offset:14336
    ds_read_b128 v[76:79], v14 offset:15360
    s_waitcnt lgkmcnt(0)
    v_mfma_f32_16x16x32_bf16 v[160:163], v[48:51], v[64:67], v[160:163]
    v_mfma_f32_16x16x32_bf16 v[164:167], v[48:51], v[68:71], v[164:167]
    v_mfma_f32_16x16x32_bf16 v[168:171], v[48:51], v[72:75], v[168:171]
    v_mfma_f32_16x16x32_bf16 v[172:175], v[48:51], v[76:79], v[172:175]
    v_mfma_f32_16x16x32_bf16 v[176:179], v[52:55], v[64:67], v[176:179]
    v_mfma_f32_16x16x32_bf16 v[180:183], v[52:55], v[68:71], v[180:183]
    v_mfma_f32_16x16x32_bf16 v[184:187], v[52:55], v[72:75], v[184:187]
    v_mfma_f32_16x16x32_bf16 v[188:191], v[52:55], v[76:79], v[188:191]
    v_mfma_f32_16x16x32_bf16 v[192:195], v[56:59], v[64:67], v[192:195]
    v_mfma_f32_16x16x32_bf16 v[196:199], v[56:59], v[68:71], v[196:199]
    v_mfma_f32_16x16x32_bf16 v[200:203], v[56:59], v[72:75], v[200:203]
    v_mfma_f32_16x16x32_bf16 v[204:207], v[56:59], v[76:79], v[204:207]
    v_mfma_f32_16x16x32_bf16 v[208:211], v[60:63], v[64:67], v[208:211]
    v_mfma_f32_16x16x32_bf16 v[212:215], v[60:63], v[68:71], v[212:215]
    v_mfma_f32_16x16x32_bf16 v[216:219], v[60:63], v[72:75], v[216:219]
    v_mfma_f32_16x16x32_bf16 v[220:223], v[60:63], v[76:79], v[220:223]
    s_add_u32 m0, s30, 8192
    s_mov_b32 s26, 448
    buffer_load_dwordx4 v4, s[8:11], s26 offen lds
    s_add_u32 m0, s30, 9216
    s_mov_b32 s26, 131520
    buffer_load_dwordx4 v4, s[8:11], s26 offen lds
    s_add_u32 m0, s30, 10240
    s_mov_b32 s26, 262592
    buffer_load_dwordx4 v4, s[8:11], s26 offen lds
    s_add_u32 m0, s30, 11264
    s_mov_b32 s26, 393664
    buffer_load_dwordx4 v4, s[8:11], s26 offen lds
    s_add_u32 m0, s30, 12288
    s_mov_b32 s26, 448
    buffer_load_dwordx4 v6, s[12:15], s26 offen lds
    s_add_u32 m0, s30, 13312
    s_mov_b32 s26, 131520
    buffer_load_dwordx4 v6, s[12:15], s26 offen lds
    s_add_u32 m0, s30, 14336
    s_mov_b32 s26, 262592
    buffer_load_dwordx4 v6, s[12:15], s26 offen lds
    s_add_u32 m0, s30, 15360
    s_mov_b32 s26, 393664
    buffer_load_dwordx4 v6, s[12:15], s26 offen lds
    s_waitcnt vmcnt(8)
    ds_read_b128 v[16:19], v14 offset:0
    ds_read_b128 v[20:23], v14 offset:1024
    ds_read_b128 v[24:27], v14 offset:2048
    ds_read_b128 v[28:31], v14 offset:3072
    ds_read_b128 v[32:35], v14 offset:4096
    ds_read_b128 v[36:39], v14 offset:5120
    ds_read_b128 v[40:43], v14 offset:6144
    ds_read_b128 v[44:47], v14 offset:7168
    s_waitcnt lgkmcnt(0)
    v_mfma_f32_16x16x32_bf16 v[160:163], v[16:19], v[32:35], v[160:163]
    v_mfma_f32_16x16x32_bf16 v[164:167], v[16:19], v[36:39], v[164:167]
    v_mfma_f32_16x16x32_bf16 v[168:171], v[16:19], v[40:43], v[168:171]
    v_mfma_f32_16x16x32_bf16 v[172:175], v[16:19], v[44:47], v[172:175]
    v_mfma_f32_16x16x32_bf16 v[176:179], v[20:23], v[32:35], v[176:179]
    v_mfma_f32_16x16x32_bf16 v[180:183], v[20:23], v[36:39], v[180:183]
    v_mfma_f32_16x16x32_bf16 v[184:187], v[20:23], v[40:43], v[184:187]
    v_mfma_f32_16x16x32_bf16 v[188:191], v[20:23], v[44:47], v[188:191]
    v_mfma_f32_16x16x32_bf16 v[192:195], v[24:27], v[32:35], v[192:195]
    v_mfma_f32_16x16x32_bf16 v[196:199], v[24:27], v[36:39], v[196:199]
    v_mfma_f32_16x16x32_bf16 v[200:203], v[24:27], v[40:43], v[200:203]
    v_mfma_f32_16x16x32_bf16 v[204:207], v[24:27], v[44:47], v[204:207]
    v_mfma_f32_16x16x32_bf16 v[208:211], v[28:31], v[32:35], v[208:211]
    v_mfma_f32_16x16x32_bf16 v[212:215], v[28:31], v[36:39], v[212:215]
    v_mfma_f32_16x16x32_bf16 v[216:219], v[28:31], v[40:43], v[216:219]
    v_mfma_f32_16x16x32_bf16 v[220:223], v[28:31], v[44:47], v[220:223]
    s_waitcnt vmcnt(0)
    ds_read_b128 v[48:51], v14 offset:8192
    ds_read_b128 v[52:55], v14 offset:9216
    ds_read_b128 v[56:59], v14 offset:10240
    ds_read_b128 v[60:63], v14 offset:11264
    ds_read_b128 v[64:67], v14 offset:12288
    ds_read_b128 v[68:71], v14 offset:13312
    ds_read_b128 v[72:75], v14 offset:14336
    ds_read_b128 v[76:79], v14 offset:15360
    s_waitcnt lgkmcnt(0)
    v_mfma_f32_16x16x32_bf16 v[160:163], v[48:51], v[64:67], v[160:163]
    v_mfma_f32_16x16x32_bf16 v[164:167], v[48:51], v[68:71], v[164:167]
    v_mfma_f32_16x16x32_bf16 v[168:171], v[48:51], v[72:75], v[168:171]
    v_mfma_f32_16x16x32_bf16 v[172:175], v[48:51], v[76:79], v[172:175]
    v_mfma_f32_16x16x32_bf16 v[176:179], v[52:55], v[64:67], v[176:179]
    v_mfma_f32_16x16x32_bf16 v[180:183], v[52:55], v[68:71], v[180:183]
    v_mfma_f32_16x16x32_bf16 v[184:187], v[52:55], v[72:75], v[184:187]
    v_mfma_f32_16x16x32_bf16 v[188:191], v[52:55], v[76:79], v[188:191]
    v_mfma_f32_16x16x32_bf16 v[192:195], v[56:59], v[64:67], v[192:195]
    v_mfma_f32_16x16x32_bf16 v[196:199], v[56:59], v[68:71], v[196:199]
    v_mfma_f32_16x16x32_bf16 v[200:203], v[56:59], v[72:75], v[200:203]
    v_mfma_f32_16x16x32_bf16 v[204:207], v[56:59], v[76:79], v[204:207]
    v_mfma_f32_16x16x32_bf16 v[208:211], v[60:63], v[64:67], v[208:211]
    v_mfma_f32_16x16x32_bf16 v[212:215], v[60:63], v[68:71], v[212:215]
    v_mfma_f32_16x16x32_bf16 v[216:219], v[60:63], v[72:75], v[216:219]
    v_mfma_f32_16x16x32_bf16 v[220:223], v[60:63], v[76:79], v[220:223]
    s_nop 7
    v_mul_f32 v160, 0x3d800000, v160
    v_mul_f32 v161, 0x3d800000, v161
    v_mul_f32 v162, 0x3d800000, v162
    v_mul_f32 v163, 0x3d800000, v163
    v_mul_f32 v164, 0x3d800000, v164
    v_mul_f32 v165, 0x3d800000, v165
    v_mul_f32 v166, 0x3d800000, v166
    v_mul_f32 v167, 0x3d800000, v167
    v_mul_f32 v168, 0x3d800000, v168
    v_mul_f32 v169, 0x3d800000, v169
    v_mul_f32 v170, 0x3d800000, v170
    v_mul_f32 v171, 0x3d800000, v171
    v_mul_f32 v172, 0x3d800000, v172
    v_mul_f32 v173, 0x3d800000, v173
    v_mul_f32 v174, 0x3d800000, v174
    v_mul_f32 v175, 0x3d800000, v175
    v_mul_f32 v176, 0x3d800000, v176
    v_mul_f32 v177, 0x3d800000, v177
    v_mul_f32 v178, 0x3d800000, v178
    v_mul_f32 v179, 0x3d800000, v179
    v_mul_f32 v180, 0x3d800000, v180
    v_mul_f32 v181, 0x3d800000, v181
    v_mul_f32 v182, 0x3d800000, v182
    v_mul_f32 v183, 0x3d800000, v183
    v_mul_f32 v184, 0x3d800000, v184
    v_mul_f32 v185, 0x3d800000, v185
    v_mul_f32 v186, 0x3d800000, v186
    v_mul_f32 v187, 0x3d800000, v187
    v_mul_f32 v188, 0x3d800000, v188
    v_mul_f32 v189, 0x3d800000, v189
    v_mul_f32 v190, 0x3d800000, v190
    v_mul_f32 v191, 0x3d800000, v191
    v_mul_f32 v192, 0x3d800000, v192
    v_mul_f32 v193, 0x3d800000, v193
    v_mul_f32 v194, 0x3d800000, v194
    v_mul_f32 v195, 0x3d800000, v195
    v_mul_f32 v196, 0x3d800000, v196
    v_mul_f32 v197, 0x3d800000, v197
    v_mul_f32 v198, 0x3d800000, v198
    v_mul_f32 v199, 0x3d800000, v199
    v_mul_f32 v200, 0x3d800000, v200
    v_mul_f32 v201, 0x3d800000, v201
    v_mul_f32 v202, 0x3d800000, v202
    v_mul_f32 v203, 0x3d800000, v203
    v_mul_f32 v204, 0x3d800000, v204
    v_mul_f32 v205, 0x3d800000, v205
    v_mul_f32 v206, 0x3d800000, v206
    v_mul_f32 v207, 0x3d800000, v207
    v_mul_f32 v208, 0x3d800000, v208
    v_mul_f32 v209, 0x3d800000, v209
    v_mul_f32 v210, 0x3d800000, v210
    v_mul_f32 v211, 0x3d800000, v211
    v_mul_f32 v212, 0x3d800000, v212
    v_mul_f32 v213, 0x3d800000, v213
    v_mul_f32 v214, 0x3d800000, v214
    v_mul_f32 v215, 0x3d800000, v215
    v_mul_f32 v216, 0x3d800000, v216
    v_mul_f32 v217, 0x3d800000, v217
    v_mul_f32 v218, 0x3d800000, v218
    v_mul_f32 v219, 0x3d800000, v219
    v_mul_f32 v220, 0x3d800000, v220
    v_mul_f32 v221, 0x3d800000, v221
    v_mul_f32 v222, 0x3d800000, v222
    v_mul_f32 v223, 0x3d800000, v223
    s_lshl_b32 s20, s3, 14
    v_mul_u32_u24 v4, 144, v2
    v_lshl_add_u32 v4, v3, 3, v4
    v_add_u32 v4, s20, v4
    v_cvt_pk_bf16_f32 v16, v160, v161
    v_cvt_pk_bf16_f32 v17, v162, v163
    ds_write_b64 v4, v[16:17] offset:0
    v_cvt_pk_bf16_f32 v18, v164, v165
    v_cvt_pk_bf16_f32 v19, v166, v167
    ds_write_b64 v4, v[18:19] offset:2304
    v_cvt_pk_bf16_f32 v20, v168, v169
    v_cvt_pk_bf16_f32 v21, v170, v171
    ds_write_b64 v4, v[20:21] offset:4608
    v_cvt_pk_bf16_f32 v22, v172, v173
    v_cvt_pk_bf16_f32 v23, v174, v175
    ds_write_b64 v4, v[22:23] offset:6912
    v_cvt_pk_bf16_f32 v16, v176, v177
    v_cvt_pk_bf16_f32 v17, v178, v179
    ds_write_b64 v4, v[16:17] offset:32
    v_cvt_pk_bf16_f32 v18, v180, v181
    v_cvt_pk_bf16_f32 v19, v182, v183
    ds_write_b64 v4, v[18:19] offset:2336
    v_cvt_pk_bf16_f32 v20, v184, v185
    v_cvt_pk_bf16_f32 v21, v186, v187
    ds_write_b64 v4, v[20:21] offset:4640
    v_cvt_pk_bf16_f32 v22, v188, v189
    v_cvt_pk_bf16_f32 v23, v190, v191
    ds_write_b64 v4, v[22:23] offset:6944
    v_cvt_pk_bf16_f32 v16, v192, v193
    v_cvt_pk_bf16_f32 v17, v194, v195
    ds_write_b64 v4, v[16:17] offset:64
    v_cvt_pk_bf16_f32 v18, v196, v197
    v_cvt_pk_bf16_f32 v19, v198, v199
    ds_write_b64 v4, v[18:19] offset:2368
    v_cvt_pk_bf16_f32 v20, v200, v201
    v_cvt_pk_bf16_f32 v21, v202, v203
    ds_write_b64 v4, v[20:21] offset:4672
    v_cvt_pk_bf16_f32 v22, v204, v205
    v_cvt_pk_bf16_f32 v23, v206, v207
    ds_write_b64 v4, v[22:23] offset:6976
    v_cvt_pk_bf16_f32 v16, v208, v209
    v_cvt_pk_bf16_f32 v17, v210, v211
    ds_write_b64 v4, v[16:17] offset:96
    v_cvt_pk_bf16_f32 v18, v212, v213
    v_cvt_pk_bf16_f32 v19, v214, v215
    ds_write_b64 v4, v[18:19] offset:2400
    v_cvt_pk_bf16_f32 v20, v216, v217
    v_cvt_pk_bf16_f32 v21, v218, v219
    ds_write_b64 v4, v[20:21] offset:4704
    v_cvt_pk_bf16_f32 v22, v220, v221
    v_cvt_pk_bf16_f32 v23, v222, v223
    ds_write_b64 v4, v[22:23] offset:7008
    v_mul_u32_u24 v7, 144, v2
    v_add_u32 v7, s20, v7
    v_lshl_add_u32 v5, v3, 4, v7
    v_lshrrev_b32 v6, 1, v3
    v_lshlrev_b32 v6, 5, v6
    v_and_b32 v8, 1, v3
    v_lshl_add_u32 v6, v8, 3, v6
    v_add_u32 v6, v6, v7
    s_waitcnt lgkmcnt(0)
    ds_read_b128 v[32:35], v5 offset:0
    ds_read_b128 v[36:39], v5 offset:64
    ds_read_b64 v[40:41], v6 offset:0
    ds_read_b64 v[42:43], v6 offset:16
    ds_read_b64 v[44:45], v6 offset:64
    ds_read_b64 v[46:47], v6 offset:80
    ds_read_b128 v[48:51], v5 offset:2304
    ds_read_b128 v[52:55], v5 offset:2368
    ds_read_b64 v[56:57], v6 offset:2304
    ds_read_b64 v[58:59], v6 offset:2320
    ds_read_b64 v[60:61], v6 offset:2368
    ds_read_b64 v[62:63], v6 offset:2384
    ds_read_b128 v[64:67], v5 offset:4608
    ds_read_b128 v[68:71], v5 offset:4672
    ds_read_b64 v[72:73], v6 offset:4608
    ds_read_b64 v[74:75], v6 offset:4624
    ds_read_b64 v[76:77], v6 offset:4672
    ds_read_b64 v[78:79], v6 offset:4688
    ds_read_b128 v[80:83], v5 offset:6912
    ds_read_b128 v[84:87], v5 offset:6976
    ds_read_b64 v[88:89], v6 offset:6912
    ds_read_b64 v[90:91], v6 offset:6928
    ds_read_b64 v[92:93], v6 offset:6976
    ds_read_b64 v[94:95], v6 offset:6992
    s_mul_i32 s20, s5, 28
    s_lshl_b32 s21, s7, 2
    s_add_u32 s20, s20, s21
    s_add_u32 s20, s20, 0
    s_mul_i32 s22, s20, 14
    s_lshl_b32 s21, s6, 1
    s_add_u32 s22, s22, s21
    s_lshl_b32 s22, s22, 10
    s_add_u32 s22, s22, 12845056
    s_mul_i32 s20, s20, 7
    s_add_u32 s20, s20, s6
    s_lshl_b32 s20, s20, 11
    s_add_u32 s20, s20, 0
    v_lshlrev_b32 v8, 4, v1
    v_add_u32 v9, s20, v8
    v_add_u32 v8, s22, v8
    s_waitcnt lgkmcnt(15)
    v_swap_b32 v41, v42
    v_swap_b32 v45, v46
    buffer_store_dwordx4 v[32:35], v8, s[16:19], 0 offen offset:0
    buffer_store_dwordx4 v[36:39], v8, s[16:19], 0 offen offset:1024
    buffer_store_dwordx4 v[40:43], v9, s[16:19], 0 offen offset:0
    buffer_store_dwordx4 v[44:47], v9, s[16:19], 0 offen offset:1024
    s_nop 1
    s_mul_i32 s20, s5, 28
    s_lshl_b32 s21, s7, 2
    s_add_u32 s20, s20, s21
    s_add_u32 s20, s20, 1
    s_mul_i32 s22, s20, 14
    s_lshl_b32 s21, s6, 1
    s_add_u32 s22, s22, s21
    s_lshl_b32 s22, s22, 10
    s_add_u32 s22, s22, 12845056
    s_mul_i32 s20, s20, 7
    s_add_u32 s20, s20, s6
    s_lshl_b32 s20, s20, 11
    s_add_u32 s20, s20, 0
    v_lshlrev_b32 v8, 4, v1
    v_add_u32 v9, s20, v8
    v_add_u32 v8, s22, v8
    s_waitcnt lgkmcnt(12)
    v_swap_b32 v57, v58
    v_swap_b32 v61, v62
    buffer_store_dwordx4 v[48:51], v8, s[16:19], 0 offen offset:0
    buffer_store_dwordx4 v[52:55], v8, s[16:19], 0 offen offset:1024
    buffer_store_dwordx4 v[56:59], v9, s[16:19], 0 offen offset:0
    buffer_store_dwordx4 v[60:63], v9, s[16:19], 0 offen offset:1024
    s_nop 1
    s_mul_i32 s20, s5, 28
    s_lshl_b32 s21, s7, 2
    s_add_u32 s20, s20, s21
    s_add_u32 s20, s20, 2
    s_mul_i32 s22, s20, 14
    s_lshl_b32 s21, s6, 1
    s_add_u32 s22, s22, s21
    s_lshl_b32 s22, s22, 10
    s_add_u32 s22, s22, 12845056
    s_mul_i32 s20, s20, 7
    s_add_u32 s20, s20, s6
    s_lshl_b32 s20, s20, 11
    s_add_u32 s20, s20, 0
    v_lshlrev_b32 v8, 4, v1
    v_add_u32 v9, s20, v8
    v_add_u32 v8, s22, v8
    s_waitcnt lgkmcnt(6)
    v_swap_b32 v73, v74
    v_swap_b32 v77, v78
    buffer_store_dwordx4 v[64:67], v8, s[16:19], 0 offen offset:0
    buffer_store_dwordx4 v[68:71], v8, s[16:19], 0 offen offset:1024
    buffer_store_dwordx4 v[72:75], v9, s[16:19], 0 offen offset:0
    buffer_store_dwordx4 v[76:79], v9, s[16:19], 0 offen offset:1024
    s_nop 1
    s_mul_i32 s20, s5, 28
    s_lshl_b32 s21, s7, 2
    s_add_u32 s20, s20, s21
    s_add_u32 s20, s20, 3
    s_mul_i32 s22, s20, 14
    s_lshl_b32 s21, s6, 1
    s_add_u32 s22, s22, s21
    s_lshl_b32 s22, s22, 10
    s_add_u32 s22, s22, 12845056
    s_mul_i32 s20, s20, 7
    s_add_u32 s20, s20, s6
    s_lshl_b32 s20, s20, 11
    s_add_u32 s20, s20, 0
    v_lshlrev_b32 v8, 4, v1
    v_add_u32 v9, s20, v8
    v_add_u32 v8, s22, v8
    s_waitcnt lgkmcnt(0)
    v_swap_b32 v89, v90
    v_swap_b32 v93, v94
    buffer_store_dwordx4 v[80:83], v8, s[16:19], 0 offen offset:0
    buffer_store_dwordx4 v[84:87], v8, s[16:19], 0 offen offset:1024
    buffer_store_dwordx4 v[88:91], v9, s[16:19], 0 offen offset:0
    buffer_store_dwordx4 v[92:95], v9, s[16:19], 0 offen offset:1024
    s_nop 1
    s_endpgm
prep_vo:
    s_lshl_b32 s20, s5, 8
    v_lshlrev_b32 v5, 3, v3
    v_add_u32 v5, s20, v5
    v_mul_u32_u24 v6, 896, v5
    s_lshl_b32 s20, s7, 7
    v_lshlrev_b32 v5, 3, v2
    v_add_u32 v6, v6, v5
    v_add_u32 v6, s20, v6
    s_mov_b32 s27, 0x05040100
    s_mov_b32 s28, 0x07060302
    s_add_u32 m0, s30, 0
    s_mov_b32 s26, 0
    buffer_load_dwordx4 v4, s[8:11], s26 offen lds
    s_add_u32 m0, s30, 1024
    s_mov_b32 s26, 131072
    buffer_load_dwordx4 v4, s[8:11], s26 offen lds
    s_add_u32 m0, s30, 2048
    s_mov_b32 s26, 262144
    buffer_load_dwordx4 v4, s[8:11], s26 offen lds
    s_add_u32 m0, s30, 3072
    s_mov_b32 s26, 393216
    buffer_load_dwordx4 v4, s[8:11], s26 offen lds
    s_mov_b32 s26, 0
    buffer_load_dwordx2 v[80:81], v6, s[12:15], s26 offen
    s_mov_b32 s26, 896
    buffer_load_dwordx2 v[82:83], v6, s[12:15], s26 offen
    s_mov_b32 s26, 1792
    buffer_load_dwordx2 v[84:85], v6, s[12:15], s26 offen
    s_mov_b32 s26, 2688
    buffer_load_dwordx2 v[86:87], v6, s[12:15], s26 offen
    s_mov_b32 s26, 3584
    buffer_load_dwordx2 v[88:89], v6, s[12:15], s26 offen
    s_mov_b32 s26, 4480
    buffer_load_dwordx2 v[90:91], v6, s[12:15], s26 offen
    s_mov_b32 s26, 5376
    buffer_load_dwordx2 v[92:93], v6, s[12:15], s26 offen
    s_mov_b32 s26, 6272
    buffer_load_dwordx2 v[94:95], v6, s[12:15], s26 offen
    s_add_u32 m0, s30, 4096
    s_mov_b32 s26, 64
    buffer_load_dwordx4 v4, s[8:11], s26 offen lds
    s_add_u32 m0, s30, 5120
    s_mov_b32 s26, 131136
    buffer_load_dwordx4 v4, s[8:11], s26 offen lds
    s_add_u32 m0, s30, 6144
    s_mov_b32 s26, 262208
    buffer_load_dwordx4 v4, s[8:11], s26 offen lds
    s_add_u32 m0, s30, 7168
    s_mov_b32 s26, 393280
    buffer_load_dwordx4 v4, s[8:11], s26 offen lds
    s_mov_b32 s26, 28672
    buffer_load_dwordx2 v[96:97], v6, s[12:15], s26 offen
    s_mov_b32 s26, 29568
    buffer_load_dwordx2 v[98:99], v6, s[12:15], s26 offen
    s_mov_b32 s26, 30464
    buffer_load_dwordx2 v[100:101], v6, s[12:15], s26 offen
    s_mov_b32 s26, 31360
    buffer_load_dwordx2 v[102:103], v6, s[12:15], s26 offen
    s_mov_b32 s26, 32256
    buffer_load_dwordx2 v[104:105], v6, s[12:15], s26 offen
    s_mov_b32 s26, 33152
    buffer_load_dwordx2 v[106:107], v6, s[12:15], s26 offen
    s_mov_b32 s26, 34048
    buffer_load_dwordx2 v[108:109], v6, s[12:15], s26 offen
    s_mov_b32 s26, 34944
    buffer_load_dwordx2 v[110:111], v6, s[12:15], s26 offen
    s_add_u32 m0, s30, 8192
    s_mov_b32 s26, 128
    buffer_load_dwordx4 v4, s[8:11], s26 offen lds
    s_add_u32 m0, s30, 9216
    s_mov_b32 s26, 131200
    buffer_load_dwordx4 v4, s[8:11], s26 offen lds
    s_add_u32 m0, s30, 10240
    s_mov_b32 s26, 262272
    buffer_load_dwordx4 v4, s[8:11], s26 offen lds
    s_add_u32 m0, s30, 11264
    s_mov_b32 s26, 393344
    buffer_load_dwordx4 v4, s[8:11], s26 offen lds
    s_mov_b32 s26, 57344
    buffer_load_dwordx2 v[112:113], v6, s[12:15], s26 offen
    s_mov_b32 s26, 58240
    buffer_load_dwordx2 v[114:115], v6, s[12:15], s26 offen
    s_mov_b32 s26, 59136
    buffer_load_dwordx2 v[116:117], v6, s[12:15], s26 offen
    s_mov_b32 s26, 60032
    buffer_load_dwordx2 v[118:119], v6, s[12:15], s26 offen
    s_mov_b32 s26, 60928
    buffer_load_dwordx2 v[120:121], v6, s[12:15], s26 offen
    s_mov_b32 s26, 61824
    buffer_load_dwordx2 v[122:123], v6, s[12:15], s26 offen
    s_mov_b32 s26, 62720
    buffer_load_dwordx2 v[124:125], v6, s[12:15], s26 offen
    s_mov_b32 s26, 63616
    buffer_load_dwordx2 v[126:127], v6, s[12:15], s26 offen
    s_add_u32 m0, s30, 12288
    s_mov_b32 s26, 192
    buffer_load_dwordx4 v4, s[8:11], s26 offen lds
    s_add_u32 m0, s30, 13312
    s_mov_b32 s26, 131264
    buffer_load_dwordx4 v4, s[8:11], s26 offen lds
    s_add_u32 m0, s30, 14336
    s_mov_b32 s26, 262336
    buffer_load_dwordx4 v4, s[8:11], s26 offen lds
    s_add_u32 m0, s30, 15360
    s_mov_b32 s26, 393408
    buffer_load_dwordx4 v4, s[8:11], s26 offen lds
    s_mov_b32 s26, 86016
    buffer_load_dwordx2 v[128:129], v6, s[12:15], s26 offen
    s_mov_b32 s26, 86912
    buffer_load_dwordx2 v[130:131], v6, s[12:15], s26 offen
    s_mov_b32 s26, 87808
    buffer_load_dwordx2 v[132:133], v6, s[12:15], s26 offen
    s_mov_b32 s26, 88704
    buffer_load_dwordx2 v[134:135], v6, s[12:15], s26 offen
    s_mov_b32 s26, 89600
    buffer_load_dwordx2 v[136:137], v6, s[12:15], s26 offen
    s_mov_b32 s26, 90496
    buffer_load_dwordx2 v[138:139], v6, s[12:15], s26 offen
    s_mov_b32 s26, 91392
    buffer_load_dwordx2 v[140:141], v6, s[12:15], s26 offen
    s_mov_b32 s26, 92288
    buffer_load_dwordx2 v[142:143], v6, s[12:15], s26 offen
    s_waitcnt vmcnt(36)
    ds_read_b128 v[16:19], v14 offset:0
    ds_read_b128 v[20:23], v14 offset:1024
    ds_read_b128 v[24:27], v14 offset:2048
    ds_read_b128 v[28:31], v14 offset:3072
    v_perm_b32 v144, v82, v80, s27
    v_perm_b32 v145, v86, v84, s27
    v_perm_b32 v146, v90, v88, s27
    v_perm_b32 v147, v94, v92, s27
    v_perm_b32 v148, v82, v80, s28
    v_perm_b32 v149, v86, v84, s28
    v_perm_b32 v150, v90, v88, s28
    v_perm_b32 v151, v94, v92, s28
    v_perm_b32 v152, v83, v81, s27
    v_perm_b32 v153, v87, v85, s27
    v_perm_b32 v154, v91, v89, s27
    v_perm_b32 v155, v95, v93, s27
    v_perm_b32 v156, v83, v81, s28
    v_perm_b32 v157, v87, v85, s28
    v_perm_b32 v158, v91, v89, s28
    v_perm_b32 v159, v95, v93, s28
    s_waitcnt lgkmcnt(0)
    v_mfma_f32_16x16x32_bf16 v[160:163], v[16:19], v[144:147], v[160:163]
    v_mfma_f32_16x16x32_bf16 v[164:167], v[16:19], v[148:151], v[164:167]
    v_mfma_f32_16x16x32_bf16 v[168:171], v[16:19], v[152:155], v[168:171]
    v_mfma_f32_16x16x32_bf16 v[172:175], v[16:19], v[156:159], v[172:175]
    v_mfma_f32_16x16x32_bf16 v[176:179], v[20:23], v[144:147], v[176:179]
    v_mfma_f32_16x16x32_bf16 v[180:183], v[20:23], v[148:151], v[180:183]
    v_mfma_f32_16x16x32_bf16 v[184:187], v[20:23], v[152:155], v[184:187]
    v_mfma_f32_16x16x32_bf16 v[188:191], v[20:23], v[156:159], v[188:191]
    v_mfma_f32_16x16x32_bf16 v[192:195], v[24:27], v[144:147], v[192:195]
    v_mfma_f32_16x16x32_bf16 v[196:199], v[24:27], v[148:151], v[196:199]
    v_mfma_f32_16x16x32_bf16 v[200:203], v[24:27], v[152:155], v[200:203]
    v_mfma_f32_16x16x32_bf16 v[204:207], v[24:27], v[156:159], v[204:207]
    v_mfma_f32_16x16x32_bf16 v[208:211], v[28:31], v[144:147], v[208:211]
    v_mfma_f32_16x16x32_bf16 v[212:215], v[28:31], v[148:151], v[212:215]
    v_mfma_f32_16x16x32_bf16 v[216:219], v[28:31], v[152:155], v[216:219]
    v_mfma_f32_16x16x32_bf16 v[220:223], v[28:31], v[156:159], v[220:223]
    s_nop 7
    s_add_u32 m0, s30, 0
    s_mov_b32 s26, 256
    buffer_load_dwordx4 v4, s[8:11], s26 offen lds
    s_add_u32 m0, s30, 1024
    s_mov_b32 s26, 131328
    buffer_load_dwordx4 v4, s[8:11], s26 offen lds
    s_add_u32 m0, s30, 2048
    s_mov_b32 s26, 262400
    buffer_load_dwordx4 v4, s[8:11], s26 offen lds
    s_add_u32 m0, s30, 3072
    s_mov_b32 s26, 393472
    buffer_load_dwordx4 v4, s[8:11], s26 offen lds
    s_mov_b32 s26, 114688
    buffer_load_dwordx2 v[80:81], v6, s[12:15], s26 offen
    s_mov_b32 s26, 115584
    buffer_load_dwordx2 v[82:83], v6, s[12:15], s26 offen
    s_mov_b32 s26, 116480
    buffer_load_dwordx2 v[84:85], v6, s[12:15], s26 offen
    s_mov_b32 s26, 117376
    buffer_load_dwordx2 v[86:87], v6, s[12:15], s26 offen
    s_mov_b32 s26, 118272
    buffer_load_dwordx2 v[88:89], v6, s[12:15], s26 offen
    s_mov_b32 s26, 119168
    buffer_load_dwordx2 v[90:91], v6, s[12:15], s26 offen
    s_mov_b32 s26, 120064
    buffer_load_dwordx2 v[92:93], v6, s[12:15], s26 offen
    s_mov_b32 s26, 120960
    buffer_load_dwordx2 v[94:95], v6, s[12:15], s26 offen
    s_waitcnt vmcnt(36)
    ds_read_b128 v[32:35], v14 offset:4096
    ds_read_b128 v[36:39], v14 offset:5120
    ds_read_b128 v[40:43], v14 offset:6144
    ds_read_b128 v[44:47], v14 offset:7168
    v_perm_b32 v144, v98, v96, s27
    v_perm_b32 v145, v102, v100, s27
    v_perm_b32 v146, v106, v104, s27
    v_perm_b32 v147, v110, v108, s27
    v_perm_b32 v148, v98, v96, s28
    v_perm_b32 v149, v102, v100, s28
    v_perm_b32 v150, v106, v104, s28
    v_perm_b32 v151, v110, v108, s28
    v_perm_b32 v152, v99, v97, s27
    v_perm_b32 v153, v103, v101, s27
    v_perm_b32 v154, v107, v105, s27
    v_perm_b32 v155, v111, v109, s27
    v_perm_b32 v156, v99, v97, s28
    v_perm_b32 v157, v103, v101, s28
    v_perm_b32 v158, v107, v105, s28
    v_perm_b32 v159, v111, v109, s28
    s_waitcnt lgkmcnt(0)
    v_mfma_f32_16x16x32_bf16 v[160:163], v[32:35], v[144:147], v[160:163]
    v_mfma_f32_16x16x32_bf16 v[164:167], v[32:35], v[148:151], v[164:167]
    v_mfma_f32_16x16x32_bf16 v[168:171], v[32:35], v[152:155], v[168:171]
    v_mfma_f32_16x16x32_bf16 v[172:175], v[32:35], v[156:159], v[172:175]
    v_mfma_f32_16x16x32_bf16 v[176:179], v[36:39], v[144:147], v[176:179]
    v_mfma_f32_16x16x32_bf16 v[180:183], v[36:39], v[148:151], v[180:183]
    v_mfma_f32_16x16x32_bf16 v[184:187], v[36:39], v[152:155], v[184:187]
    v_mfma_f32_16x16x32_bf16 v[188:191], v[36:39], v[156:159], v[188:191]
    v_mfma_f32_16x16x32_bf16 v[192:195], v[40:43], v[144:147], v[192:195]
    v_mfma_f32_16x16x32_bf16 v[196:199], v[40:43], v[148:151], v[196:199]
    v_mfma_f32_16x16x32_bf16 v[200:203], v[40:43], v[152:155], v[200:203]
    v_mfma_f32_16x16x32_bf16 v[204:207], v[40:43], v[156:159], v[204:207]
    v_mfma_f32_16x16x32_bf16 v[208:211], v[44:47], v[144:147], v[208:211]
    v_mfma_f32_16x16x32_bf16 v[212:215], v[44:47], v[148:151], v[212:215]
    v_mfma_f32_16x16x32_bf16 v[216:219], v[44:47], v[152:155], v[216:219]
    v_mfma_f32_16x16x32_bf16 v[220:223], v[44:47], v[156:159], v[220:223]
    s_nop 7
    s_add_u32 m0, s30, 4096
    s_mov_b32 s26, 320
    buffer_load_dwordx4 v4, s[8:11], s26 offen lds
    s_add_u32 m0, s30, 5120
    s_mov_b32 s26, 131392
    buffer_load_dwordx4 v4, s[8:11], s26 offen lds
    s_add_u32 m0, s30, 6144
    s_mov_b32 s26, 262464
    buffer_load_dwordx4 v4, s[8:11], s26 offen lds
    s_add_u32 m0, s30, 7168
    s_mov_b32 s26, 393536
    buffer_load_dwordx4 v4, s[8:11], s26 offen lds
    s_mov_b32 s26, 143360
    buffer_load_dwordx2 v[96:97], v6, s[12:15], s26 offen
    s_mov_b32 s26, 144256
    buffer_load_dwordx2 v[98:99], v6, s[12:15], s26 offen
    s_mov_b32 s26, 145152
    buffer_load_dwordx2 v[100:101], v6, s[12:15], s26 offen
    s_mov_b32 s26, 146048
    buffer_load_dwordx2 v[102:103], v6, s[12:15], s26 offen
    s_mov_b32 s26, 146944
    buffer_load_dwordx2 v[104:105], v6, s[12:15], s26 offen
    s_mov_b32 s26, 147840
    buffer_load_dwordx2 v[106:107], v6, s[12:15], s26 offen
    s_mov_b32 s26, 148736
    buffer_load_dwordx2 v[108:109], v6, s[12:15], s26 offen
    s_mov_b32 s26, 149632
    buffer_load_dwordx2 v[110:111], v6, s[12:15], s26 offen
    s_waitcnt vmcnt(36)
    ds_read_b128 v[16:19], v14 offset:8192
    ds_read_b128 v[20:23], v14 offset:9216
    ds_read_b128 v[24:27], v14 offset:10240
    ds_read_b128 v[28:31], v14 offset:11264
    v_perm_b32 v144, v114, v112, s27
    v_perm_b32 v145, v118, v116, s27
    v_perm_b32 v146, v122, v120, s27
    v_perm_b32 v147, v126, v124, s27
    v_perm_b32 v148, v114, v112, s28
    v_perm_b32 v149, v118, v116, s28
    v_perm_b32 v150, v122, v120, s28
    v_perm_b32 v151, v126, v124, s28
    v_perm_b32 v152, v115, v113, s27
    v_perm_b32 v153, v119, v117, s27
    v_perm_b32 v154, v123, v121, s27
    v_perm_b32 v155, v127, v125, s27
    v_perm_b32 v156, v115, v113, s28
    v_perm_b32 v157, v119, v117, s28
    v_perm_b32 v158, v123, v121, s28
    v_perm_b32 v159, v127, v125, s28
    s_waitcnt lgkmcnt(0)
    v_mfma_f32_16x16x32_bf16 v[160:163], v[16:19], v[144:147], v[160:163]
    v_mfma_f32_16x16x32_bf16 v[164:167], v[16:19], v[148:151], v[164:167]
    v_mfma_f32_16x16x32_bf16 v[168:171], v[16:19], v[152:155], v[168:171]
    v_mfma_f32_16x16x32_bf16 v[172:175], v[16:19], v[156:159], v[172:175]
    v_mfma_f32_16x16x32_bf16 v[176:179], v[20:23], v[144:147], v[176:179]
    v_mfma_f32_16x16x32_bf16 v[180:183], v[20:23], v[148:151], v[180:183]
    v_mfma_f32_16x16x32_bf16 v[184:187], v[20:23], v[152:155], v[184:187]
    v_mfma_f32_16x16x32_bf16 v[188:191], v[20:23], v[156:159], v[188:191]
    v_mfma_f32_16x16x32_bf16 v[192:195], v[24:27], v[144:147], v[192:195]
    v_mfma_f32_16x16x32_bf16 v[196:199], v[24:27], v[148:151], v[196:199]
    v_mfma_f32_16x16x32_bf16 v[200:203], v[24:27], v[152:155], v[200:203]
    v_mfma_f32_16x16x32_bf16 v[204:207], v[24:27], v[156:159], v[204:207]
    v_mfma_f32_16x16x32_bf16 v[208:211], v[28:31], v[144:147], v[208:211]
    v_mfma_f32_16x16x32_bf16 v[212:215], v[28:31], v[148:151], v[212:215]
    v_mfma_f32_16x16x32_bf16 v[216:219], v[28:31], v[152:155], v[216:219]
    v_mfma_f32_16x16x32_bf16 v[220:223], v[28:31], v[156:159], v[220:223]
    s_nop 7
    s_add_u32 m0, s30, 8192
    s_mov_b32 s26, 384
    buffer_load_dwordx4 v4, s[8:11], s26 offen lds
    s_add_u32 m0, s30, 9216
    s_mov_b32 s26, 131456
    buffer_load_dwordx4 v4, s[8:11], s26 offen lds
    s_add_u32 m0, s30, 10240
    s_mov_b32 s26, 262528
    buffer_load_dwordx4 v4, s[8:11], s26 offen lds
    s_add_u32 m0, s30, 11264
    s_mov_b32 s26, 393600
    buffer_load_dwordx4 v4, s[8:11], s26 offen lds
    s_mov_b32 s26, 172032
    buffer_load_dwordx2 v[112:113], v6, s[12:15], s26 offen
    s_mov_b32 s26, 172928
    buffer_load_dwordx2 v[114:115], v6, s[12:15], s26 offen
    s_mov_b32 s26, 173824
    buffer_load_dwordx2 v[116:117], v6, s[12:15], s26 offen
    s_mov_b32 s26, 174720
    buffer_load_dwordx2 v[118:119], v6, s[12:15], s26 offen
    s_mov_b32 s26, 175616
    buffer_load_dwordx2 v[120:121], v6, s[12:15], s26 offen
    s_mov_b32 s26, 176512
    buffer_load_dwordx2 v[122:123], v6, s[12:15], s26 offen
    s_mov_b32 s26, 177408
    buffer_load_dwordx2 v[124:125], v6, s[12:15], s26 offen
    s_mov_b32 s26, 178304
    buffer_load_dwordx2 v[126:127], v6, s[12:15], s26 offen
    s_waitcnt vmcnt(36)
    ds_read_b128 v[32:35], v14 offset:12288
    ds_read_b128 v[36:39], v14 offset:13312
    ds_read_b128 v[40:43], v14 offset:14336
    ds_read_b128 v[44:47], v14 offset:15360
    v_perm_b32 v144, v130, v128, s27
    v_perm_b32 v145, v134, v132, s27
    v_perm_b32 v146, v138, v136, s27
    v_perm_b32 v147, v142, v140, s27
    v_perm_b32 v148, v130, v128, s28
    v_perm_b32 v149, v134, v132, s28
    v_perm_b32 v150, v138, v136, s28
    v_perm_b32 v151, v142, v140, s28
    v_perm_b32 v152, v131, v129, s27
    v_perm_b32 v153, v135, v133, s27
    v_perm_b32 v154, v139, v137, s27
    v_perm_b32 v155, v143, v141, s27
    v_perm_b32 v156, v131, v129, s28
    v_perm_b32 v157, v135, v133, s28
    v_perm_b32 v158, v139, v137, s28
    v_perm_b32 v159, v143, v141, s28
    s_waitcnt lgkmcnt(0)
    v_mfma_f32_16x16x32_bf16 v[160:163], v[32:35], v[144:147], v[160:163]
    v_mfma_f32_16x16x32_bf16 v[164:167], v[32:35], v[148:151], v[164:167]
    v_mfma_f32_16x16x32_bf16 v[168:171], v[32:35], v[152:155], v[168:171]
    v_mfma_f32_16x16x32_bf16 v[172:175], v[32:35], v[156:159], v[172:175]
    v_mfma_f32_16x16x32_bf16 v[176:179], v[36:39], v[144:147], v[176:179]
    v_mfma_f32_16x16x32_bf16 v[180:183], v[36:39], v[148:151], v[180:183]
    v_mfma_f32_16x16x32_bf16 v[184:187], v[36:39], v[152:155], v[184:187]
    v_mfma_f32_16x16x32_bf16 v[188:191], v[36:39], v[156:159], v[188:191]
    v_mfma_f32_16x16x32_bf16 v[192:195], v[40:43], v[144:147], v[192:195]
    v_mfma_f32_16x16x32_bf16 v[196:199], v[40:43], v[148:151], v[196:199]
    v_mfma_f32_16x16x32_bf16 v[200:203], v[40:43], v[152:155], v[200:203]
    v_mfma_f32_16x16x32_bf16 v[204:207], v[40:43], v[156:159], v[204:207]
    v_mfma_f32_16x16x32_bf16 v[208:211], v[44:47], v[144:147], v[208:211]
    v_mfma_f32_16x16x32_bf16 v[212:215], v[44:47], v[148:151], v[212:215]
    v_mfma_f32_16x16x32_bf16 v[216:219], v[44:47], v[152:155], v[216:219]
    v_mfma_f32_16x16x32_bf16 v[220:223], v[44:47], v[156:159], v[220:223]
    s_nop 7
    s_add_u32 m0, s30, 12288
    s_mov_b32 s26, 448
    buffer_load_dwordx4 v4, s[8:11], s26 offen lds
    s_add_u32 m0, s30, 13312
    s_mov_b32 s26, 131520
    buffer_load_dwordx4 v4, s[8:11], s26 offen lds
    s_add_u32 m0, s30, 14336
    s_mov_b32 s26, 262592
    buffer_load_dwordx4 v4, s[8:11], s26 offen lds
    s_add_u32 m0, s30, 15360
    s_mov_b32 s26, 393664
    buffer_load_dwordx4 v4, s[8:11], s26 offen lds
    s_mov_b32 s26, 200704
    buffer_load_dwordx2 v[128:129], v6, s[12:15], s26 offen
    s_mov_b32 s26, 201600
    buffer_load_dwordx2 v[130:131], v6, s[12:15], s26 offen
    s_mov_b32 s26, 202496
    buffer_load_dwordx2 v[132:133], v6, s[12:15], s26 offen
    s_mov_b32 s26, 203392
    buffer_load_dwordx2 v[134:135], v6, s[12:15], s26 offen
    s_mov_b32 s26, 204288
    buffer_load_dwordx2 v[136:137], v6, s[12:15], s26 offen
    s_mov_b32 s26, 205184
    buffer_load_dwordx2 v[138:139], v6, s[12:15], s26 offen
    s_mov_b32 s26, 206080
    buffer_load_dwordx2 v[140:141], v6, s[12:15], s26 offen
    s_mov_b32 s26, 206976
    buffer_load_dwordx2 v[142:143], v6, s[12:15], s26 offen
    s_waitcnt vmcnt(36)
    ds_read_b128 v[16:19], v14 offset:0
    ds_read_b128 v[20:23], v14 offset:1024
    ds_read_b128 v[24:27], v14 offset:2048
    ds_read_b128 v[28:31], v14 offset:3072
    v_perm_b32 v144, v82, v80, s27
    v_perm_b32 v145, v86, v84, s27
    v_perm_b32 v146, v90, v88, s27
    v_perm_b32 v147, v94, v92, s27
    v_perm_b32 v148, v82, v80, s28
    v_perm_b32 v149, v86, v84, s28
    v_perm_b32 v150, v90, v88, s28
    v_perm_b32 v151, v94, v92, s28
    v_perm_b32 v152, v83, v81, s27
    v_perm_b32 v153, v87, v85, s27
    v_perm_b32 v154, v91, v89, s27
    v_perm_b32 v155, v95, v93, s27
    v_perm_b32 v156, v83, v81, s28
    v_perm_b32 v157, v87, v85, s28
    v_perm_b32 v158, v91, v89, s28
    v_perm_b32 v159, v95, v93, s28
    s_waitcnt lgkmcnt(0)
    v_mfma_f32_16x16x32_bf16 v[160:163], v[16:19], v[144:147], v[160:163]
    v_mfma_f32_16x16x32_bf16 v[164:167], v[16:19], v[148:151], v[164:167]
    v_mfma_f32_16x16x32_bf16 v[168:171], v[16:19], v[152:155], v[168:171]
    v_mfma_f32_16x16x32_bf16 v[172:175], v[16:19], v[156:159], v[172:175]
    v_mfma_f32_16x16x32_bf16 v[176:179], v[20:23], v[144:147], v[176:179]
    v_mfma_f32_16x16x32_bf16 v[180:183], v[20:23], v[148:151], v[180:183]
    v_mfma_f32_16x16x32_bf16 v[184:187], v[20:23], v[152:155], v[184:187]
    v_mfma_f32_16x16x32_bf16 v[188:191], v[20:23], v[156:159], v[188:191]
    v_mfma_f32_16x16x32_bf16 v[192:195], v[24:27], v[144:147], v[192:195]
    v_mfma_f32_16x16x32_bf16 v[196:199], v[24:27], v[148:151], v[196:199]
    v_mfma_f32_16x16x32_bf16 v[200:203], v[24:27], v[152:155], v[200:203]
    v_mfma_f32_16x16x32_bf16 v[204:207], v[24:27], v[156:159], v[204:207]
    v_mfma_f32_16x16x32_bf16 v[208:211], v[28:31], v[144:147], v[208:211]
    v_mfma_f32_16x16x32_bf16 v[212:215], v[28:31], v[148:151], v[212:215]
    v_mfma_f32_16x16x32_bf16 v[216:219], v[28:31], v[152:155], v[216:219]
    v_mfma_f32_16x16x32_bf16 v[220:223], v[28:31], v[156:159], v[220:223]
    s_nop 7
    s_waitcnt vmcnt(24)
    ds_read_b128 v[32:35], v14 offset:4096
    ds_read_b128 v[36:39], v14 offset:5120
    ds_read_b128 v[40:43], v14 offset:6144
    ds_read_b128 v[44:47], v14 offset:7168
    v_perm_b32 v144, v98, v96, s27
    v_perm_b32 v145, v102, v100, s27
    v_perm_b32 v146, v106, v104, s27
    v_perm_b32 v147, v110, v108, s27
    v_perm_b32 v148, v98, v96, s28
    v_perm_b32 v149, v102, v100, s28
    v_perm_b32 v150, v106, v104, s28
    v_perm_b32 v151, v110, v108, s28
    v_perm_b32 v152, v99, v97, s27
    v_perm_b32 v153, v103, v101, s27
    v_perm_b32 v154, v107, v105, s27
    v_perm_b32 v155, v111, v109, s27
    v_perm_b32 v156, v99, v97, s28
    v_perm_b32 v157, v103, v101, s28
    v_perm_b32 v158, v107, v105, s28
    v_perm_b32 v159, v111, v109, s28
    s_waitcnt lgkmcnt(0)
    v_mfma_f32_16x16x32_bf16 v[160:163], v[32:35], v[144:147], v[160:163]
    v_mfma_f32_16x16x32_bf16 v[164:167], v[32:35], v[148:151], v[164:167]
    v_mfma_f32_16x16x32_bf16 v[168:171], v[32:35], v[152:155], v[168:171]
    v_mfma_f32_16x16x32_bf16 v[172:175], v[32:35], v[156:159], v[172:175]
    v_mfma_f32_16x16x32_bf16 v[176:179], v[36:39], v[144:147], v[176:179]
    v_mfma_f32_16x16x32_bf16 v[180:183], v[36:39], v[148:151], v[180:183]
    v_mfma_f32_16x16x32_bf16 v[184:187], v[36:39], v[152:155], v[184:187]
    v_mfma_f32_16x16x32_bf16 v[188:191], v[36:39], v[156:159], v[188:191]
    v_mfma_f32_16x16x32_bf16 v[192:195], v[40:43], v[144:147], v[192:195]
    v_mfma_f32_16x16x32_bf16 v[196:199], v[40:43], v[148:151], v[196:199]
    v_mfma_f32_16x16x32_bf16 v[200:203], v[40:43], v[152:155], v[200:203]
    v_mfma_f32_16x16x32_bf16 v[204:207], v[40:43], v[156:159], v[204:207]
    v_mfma_f32_16x16x32_bf16 v[208:211], v[44:47], v[144:147], v[208:211]
    v_mfma_f32_16x16x32_bf16 v[212:215], v[44:47], v[148:151], v[212:215]
    v_mfma_f32_16x16x32_bf16 v[216:219], v[44:47], v[152:155], v[216:219]
    v_mfma_f32_16x16x32_bf16 v[220:223], v[44:47], v[156:159], v[220:223]
    s_nop 7
    s_waitcnt vmcnt(12)
    ds_read_b128 v[16:19], v14 offset:8192
    ds_read_b128 v[20:23], v14 offset:9216
    ds_read_b128 v[24:27], v14 offset:10240
    ds_read_b128 v[28:31], v14 offset:11264
    v_perm_b32 v144, v114, v112, s27
    v_perm_b32 v145, v118, v116, s27
    v_perm_b32 v146, v122, v120, s27
    v_perm_b32 v147, v126, v124, s27
    v_perm_b32 v148, v114, v112, s28
    v_perm_b32 v149, v118, v116, s28
    v_perm_b32 v150, v122, v120, s28
    v_perm_b32 v151, v126, v124, s28
    v_perm_b32 v152, v115, v113, s27
    v_perm_b32 v153, v119, v117, s27
    v_perm_b32 v154, v123, v121, s27
    v_perm_b32 v155, v127, v125, s27
    v_perm_b32 v156, v115, v113, s28
    v_perm_b32 v157, v119, v117, s28
    v_perm_b32 v158, v123, v121, s28
    v_perm_b32 v159, v127, v125, s28
    s_waitcnt lgkmcnt(0)
    v_mfma_f32_16x16x32_bf16 v[160:163], v[16:19], v[144:147], v[160:163]
    v_mfma_f32_16x16x32_bf16 v[164:167], v[16:19], v[148:151], v[164:167]
    v_mfma_f32_16x16x32_bf16 v[168:171], v[16:19], v[152:155], v[168:171]
    v_mfma_f32_16x16x32_bf16 v[172:175], v[16:19], v[156:159], v[172:175]
    v_mfma_f32_16x16x32_bf16 v[176:179], v[20:23], v[144:147], v[176:179]
    v_mfma_f32_16x16x32_bf16 v[180:183], v[20:23], v[148:151], v[180:183]
    v_mfma_f32_16x16x32_bf16 v[184:187], v[20:23], v[152:155], v[184:187]
    v_mfma_f32_16x16x32_bf16 v[188:191], v[20:23], v[156:159], v[188:191]
    v_mfma_f32_16x16x32_bf16 v[192:195], v[24:27], v[144:147], v[192:195]
    v_mfma_f32_16x16x32_bf16 v[196:199], v[24:27], v[148:151], v[196:199]
    v_mfma_f32_16x16x32_bf16 v[200:203], v[24:27], v[152:155], v[200:203]
    v_mfma_f32_16x16x32_bf16 v[204:207], v[24:27], v[156:159], v[204:207]
    v_mfma_f32_16x16x32_bf16 v[208:211], v[28:31], v[144:147], v[208:211]
    v_mfma_f32_16x16x32_bf16 v[212:215], v[28:31], v[148:151], v[212:215]
    v_mfma_f32_16x16x32_bf16 v[216:219], v[28:31], v[152:155], v[216:219]
    v_mfma_f32_16x16x32_bf16 v[220:223], v[28:31], v[156:159], v[220:223]
    s_nop 7
    s_waitcnt vmcnt(0)
    ds_read_b128 v[32:35], v14 offset:12288
    ds_read_b128 v[36:39], v14 offset:13312
    ds_read_b128 v[40:43], v14 offset:14336
    ds_read_b128 v[44:47], v14 offset:15360
    v_perm_b32 v144, v130, v128, s27
    v_perm_b32 v145, v134, v132, s27
    v_perm_b32 v146, v138, v136, s27
    v_perm_b32 v147, v142, v140, s27
    v_perm_b32 v148, v130, v128, s28
    v_perm_b32 v149, v134, v132, s28
    v_perm_b32 v150, v138, v136, s28
    v_perm_b32 v151, v142, v140, s28
    v_perm_b32 v152, v131, v129, s27
    v_perm_b32 v153, v135, v133, s27
    v_perm_b32 v154, v139, v137, s27
    v_perm_b32 v155, v143, v141, s27
    v_perm_b32 v156, v131, v129, s28
    v_perm_b32 v157, v135, v133, s28
    v_perm_b32 v158, v139, v137, s28
    v_perm_b32 v159, v143, v141, s28
    s_waitcnt lgkmcnt(0)
    v_mfma_f32_16x16x32_bf16 v[160:163], v[32:35], v[144:147], v[160:163]
    v_mfma_f32_16x16x32_bf16 v[164:167], v[32:35], v[148:151], v[164:167]
    v_mfma_f32_16x16x32_bf16 v[168:171], v[32:35], v[152:155], v[168:171]
    v_mfma_f32_16x16x32_bf16 v[172:175], v[32:35], v[156:159], v[172:175]
    v_mfma_f32_16x16x32_bf16 v[176:179], v[36:39], v[144:147], v[176:179]
    v_mfma_f32_16x16x32_bf16 v[180:183], v[36:39], v[148:151], v[180:183]
    v_mfma_f32_16x16x32_bf16 v[184:187], v[36:39], v[152:155], v[184:187]
    v_mfma_f32_16x16x32_bf16 v[188:191], v[36:39], v[156:159], v[188:191]
    v_mfma_f32_16x16x32_bf16 v[192:195], v[40:43], v[144:147], v[192:195]
    v_mfma_f32_16x16x32_bf16 v[196:199], v[40:43], v[148:151], v[196:199]
    v_mfma_f32_16x16x32_bf16 v[200:203], v[40:43], v[152:155], v[200:203]
    v_mfma_f32_16x16x32_bf16 v[204:207], v[40:43], v[156:159], v[204:207]
    v_mfma_f32_16x16x32_bf16 v[208:211], v[44:47], v[144:147], v[208:211]
    v_mfma_f32_16x16x32_bf16 v[212:215], v[44:47], v[148:151], v[212:215]
    v_mfma_f32_16x16x32_bf16 v[216:219], v[44:47], v[152:155], v[216:219]
    v_mfma_f32_16x16x32_bf16 v[220:223], v[44:47], v[156:159], v[220:223]
    s_nop 7
    s_nop 7
    s_lshl_b32 s20, s3, 14
    v_mul_u32_u24 v4, 576, v2
    v_lshl_add_u32 v4, v3, 3, v4
    v_add_u32 v4, s20, v4
    v_cvt_pk_bf16_f32 v16, v160, v161
    v_cvt_pk_bf16_f32 v17, v162, v163
    ds_write_b64 v4, v[16:17] offset:0
    v_cvt_pk_bf16_f32 v18, v164, v165
    v_cvt_pk_bf16_f32 v19, v166, v167
    ds_write_b64 v4, v[18:19] offset:144
    v_cvt_pk_bf16_f32 v20, v168, v169
    v_cvt_pk_bf16_f32 v21, v170, v171
    ds_write_b64 v4, v[20:21] offset:288
    v_cvt_pk_bf16_f32 v22, v172, v173
    v_cvt_pk_bf16_f32 v23, v174, v175
    ds_write_b64 v4, v[22:23] offset:432
    v_cvt_pk_bf16_f32 v16, v176, v177
    v_cvt_pk_bf16_f32 v17, v178, v179
    ds_write_b64 v4, v[16:17] offset:32
    v_cvt_pk_bf16_f32 v18, v180, v181
    v_cvt_pk_bf16_f32 v19, v182, v183
    ds_write_b64 v4, v[18:19] offset:176
    v_cvt_pk_bf16_f32 v20, v184, v185
    v_cvt_pk_bf16_f32 v21, v186, v187
    ds_write_b64 v4, v[20:21] offset:320
    v_cvt_pk_bf16_f32 v22, v188, v189
    v_cvt_pk_bf16_f32 v23, v190, v191
    ds_write_b64 v4, v[22:23] offset:464
    v_cvt_pk_bf16_f32 v16, v192, v193
    v_cvt_pk_bf16_f32 v17, v194, v195
    ds_write_b64 v4, v[16:17] offset:64
    v_cvt_pk_bf16_f32 v18, v196, v197
    v_cvt_pk_bf16_f32 v19, v198, v199
    ds_write_b64 v4, v[18:19] offset:208
    v_cvt_pk_bf16_f32 v20, v200, v201
    v_cvt_pk_bf16_f32 v21, v202, v203
    ds_write_b64 v4, v[20:21] offset:352
    v_cvt_pk_bf16_f32 v22, v204, v205
    v_cvt_pk_bf16_f32 v23, v206, v207
    ds_write_b64 v4, v[22:23] offset:496
    v_cvt_pk_bf16_f32 v16, v208, v209
    v_cvt_pk_bf16_f32 v17, v210, v211
    ds_write_b64 v4, v[16:17] offset:96
    v_cvt_pk_bf16_f32 v18, v212, v213
    v_cvt_pk_bf16_f32 v19, v214, v215
    ds_write_b64 v4, v[18:19] offset:240
    v_cvt_pk_bf16_f32 v20, v216, v217
    v_cvt_pk_bf16_f32 v21, v218, v219
    ds_write_b64 v4, v[20:21] offset:384
    v_cvt_pk_bf16_f32 v22, v220, v221
    v_cvt_pk_bf16_f32 v23, v222, v223
    ds_write_b64 v4, v[22:23] offset:528
    v_mul_u32_u24 v7, 144, v2
    v_add_u32 v7, s20, v7
    v_lshl_add_u32 v5, v3, 4, v7
    v_lshrrev_b32 v6, 1, v3
    v_lshlrev_b32 v6, 5, v6
    v_and_b32 v8, 1, v3
    v_lshl_add_u32 v6, v8, 3, v6
    v_add_u32 v6, v6, v7
    s_waitcnt lgkmcnt(0)
    ds_read_b128 v[32:35], v5 offset:0
    ds_read_b128 v[36:39], v5 offset:64
    ds_read_b64 v[40:41], v6 offset:0
    ds_read_b64 v[42:43], v6 offset:16
    ds_read_b64 v[44:45], v6 offset:64
    ds_read_b64 v[46:47], v6 offset:80
    ds_read_b128 v[48:51], v5 offset:2304
    ds_read_b128 v[52:55], v5 offset:2368
    ds_read_b64 v[56:57], v6 offset:2304
    ds_read_b64 v[58:59], v6 offset:2320
    ds_read_b64 v[60:61], v6 offset:2368
    ds_read_b64 v[62:63], v6 offset:2384
    ds_read_b128 v[64:67], v5 offset:4608
    ds_read_b128 v[68:71], v5 offset:4672
    ds_read_b64 v[72:73], v6 offset:4608
    ds_read_b64 v[74:75], v6 offset:4624
    ds_read_b64 v[76:77], v6 offset:4672
    ds_read_b64 v[78:79], v6 offset:4688
    ds_read_b128 v[80:83], v5 offset:6912
    ds_read_b128 v[84:87], v5 offset:6976
    ds_read_b64 v[88:89], v6 offset:6912
    ds_read_b64 v[90:91], v6 offset:6928
    ds_read_b64 v[92:93], v6 offset:6976
    ds_read_b64 v[94:95], v6 offset:6992
    s_lshl_b32 s20, s7, 6
    s_add_u32 s20, s20, 0
    v_add_u32 v7, s20, v2
    v_mul_u32_u24 v10, 2341, v7
    v_lshrrev_b32 v10, 16, v10
    v_mul_u32_u24 v11, 28, v10
    v_sub_u32 v11, v7, v11
    v_lshrrev_b32 v8, 4, v11
    v_lshl_add_u32 v8, v10, 1, v8
    s_lshl_b32 s20, s5, 5
    v_add_u32 v8, s20, v8
    v_mul_u32_u24 v8, 14, v8
    s_lshl_b32 s20, s6, 1
    v_add_u32 v8, s20, v8
    v_lshlrev_b32 v8, 10, v8
    v_and_b32 v9, 15, v11
    v_lshl_add_u32 v8, v9, 4, v8
    v_lshl_add_u32 v8, v3, 8, v8
    v_add_u32 v8, 19267584, v8
    s_and_b32 s20, s5, 3
    s_mul_i32 s20, s20, 28
    v_add_u32 v11, s20, v11
    s_lshr_b32 s20, s5, 2
    v_lshlrev_b32 v10, 2, v10
    v_add_u32 v10, s20, v10
    v_mul_u32_u24 v10, 7, v10
    v_lshrrev_b32 v12, 4, v11
    v_add_u32 v10, v10, v12
    v_mul_u32_u24 v10, 7, v10
    v_add_u32 v10, s6, v10
    v_lshlrev_b32 v10, 11, v10
    v_and_b32 v11, 15, v11
    v_lshl_add_u32 v10, v11, 4, v10
    v_lshl_add_u32 v9, v3, 8, v10
    v_add_u32 v9, 6422528, v9
    s_waitcnt lgkmcnt(15)
    v_swap_b32 v41, v42
    v_swap_b32 v45, v46
    buffer_store_dwordx4 v[32:35], v8, s[16:19], 0 offen offset:0
    buffer_store_dwordx4 v[36:39], v8, s[16:19], 0 offen offset:1024
    buffer_store_dwordx4 v[40:43], v9, s[16:19], 0 offen offset:0
    buffer_store_dwordx4 v[44:47], v9, s[16:19], 0 offen offset:1024
    s_nop 1
    s_lshl_b32 s20, s7, 6
    s_add_u32 s20, s20, 16
    v_add_u32 v7, s20, v2
    v_mul_u32_u24 v10, 2341, v7
    v_lshrrev_b32 v10, 16, v10
    v_mul_u32_u24 v11, 28, v10
    v_sub_u32 v11, v7, v11
    v_lshrrev_b32 v8, 4, v11
    v_lshl_add_u32 v8, v10, 1, v8
    s_lshl_b32 s20, s5, 5
    v_add_u32 v8, s20, v8
    v_mul_u32_u24 v8, 14, v8
    s_lshl_b32 s20, s6, 1
    v_add_u32 v8, s20, v8
    v_lshlrev_b32 v8, 10, v8
    v_and_b32 v9, 15, v11
    v_lshl_add_u32 v8, v9, 4, v8
    v_lshl_add_u32 v8, v3, 8, v8
    v_add_u32 v8, 19267584, v8
    s_and_b32 s20, s5, 3
    s_mul_i32 s20, s20, 28
    v_add_u32 v11, s20, v11
    s_lshr_b32 s20, s5, 2
    v_lshlrev_b32 v10, 2, v10
    v_add_u32 v10, s20, v10
    v_mul_u32_u24 v10, 7, v10
    v_lshrrev_b32 v12, 4, v11
    v_add_u32 v10, v10, v12
    v_mul_u32_u24 v10, 7, v10
    v_add_u32 v10, s6, v10
    v_lshlrev_b32 v10, 11, v10
    v_and_b32 v11, 15, v11
    v_lshl_add_u32 v10, v11, 4, v10
    v_lshl_add_u32 v9, v3, 8, v10
    v_add_u32 v9, 6422528, v9
    s_waitcnt lgkmcnt(12)
    v_swap_b32 v57, v58
    v_swap_b32 v61, v62
    buffer_store_dwordx4 v[48:51], v8, s[16:19], 0 offen offset:0
    buffer_store_dwordx4 v[52:55], v8, s[16:19], 0 offen offset:1024
    buffer_store_dwordx4 v[56:59], v9, s[16:19], 0 offen offset:0
    buffer_store_dwordx4 v[60:63], v9, s[16:19], 0 offen offset:1024
    s_nop 1
    s_lshl_b32 s20, s7, 6
    s_add_u32 s20, s20, 32
    v_add_u32 v7, s20, v2
    v_mul_u32_u24 v10, 2341, v7
    v_lshrrev_b32 v10, 16, v10
    v_mul_u32_u24 v11, 28, v10
    v_sub_u32 v11, v7, v11
    v_lshrrev_b32 v8, 4, v11
    v_lshl_add_u32 v8, v10, 1, v8
    s_lshl_b32 s20, s5, 5
    v_add_u32 v8, s20, v8
    v_mul_u32_u24 v8, 14, v8
    s_lshl_b32 s20, s6, 1
    v_add_u32 v8, s20, v8
    v_lshlrev_b32 v8, 10, v8
    v_and_b32 v9, 15, v11
    v_lshl_add_u32 v8, v9, 4, v8
    v_lshl_add_u32 v8, v3, 8, v8
    v_add_u32 v8, 19267584, v8
    s_and_b32 s20, s5, 3
    s_mul_i32 s20, s20, 28
    v_add_u32 v11, s20, v11
    s_lshr_b32 s20, s5, 2
    v_lshlrev_b32 v10, 2, v10
    v_add_u32 v10, s20, v10
    v_mul_u32_u24 v10, 7, v10
    v_lshrrev_b32 v12, 4, v11
    v_add_u32 v10, v10, v12
    v_mul_u32_u24 v10, 7, v10
    v_add_u32 v10, s6, v10
    v_lshlrev_b32 v10, 11, v10
    v_and_b32 v11, 15, v11
    v_lshl_add_u32 v10, v11, 4, v10
    v_lshl_add_u32 v9, v3, 8, v10
    v_add_u32 v9, 6422528, v9
    s_waitcnt lgkmcnt(6)
    v_swap_b32 v73, v74
    v_swap_b32 v77, v78
    buffer_store_dwordx4 v[64:67], v8, s[16:19], 0 offen offset:0
    buffer_store_dwordx4 v[68:71], v8, s[16:19], 0 offen offset:1024
    buffer_store_dwordx4 v[72:75], v9, s[16:19], 0 offen offset:0
    buffer_store_dwordx4 v[76:79], v9, s[16:19], 0 offen offset:1024
    s_nop 1
    s_lshl_b32 s20, s7, 6
    s_add_u32 s20, s20, 48
    v_add_u32 v7, s20, v2
    v_mul_u32_u24 v10, 2341, v7
    v_lshrrev_b32 v10, 16, v10
    v_mul_u32_u24 v11, 28, v10
    v_sub_u32 v11, v7, v11
    v_lshrrev_b32 v8, 4, v11
    v_lshl_add_u32 v8, v10, 1, v8
    s_lshl_b32 s20, s5, 5
    v_add_u32 v8, s20, v8
    v_mul_u32_u24 v8, 14, v8
    s_lshl_b32 s20, s6, 1
    v_add_u32 v8, s20, v8
    v_lshlrev_b32 v8, 10, v8
    v_and_b32 v9, 15, v11
    v_lshl_add_u32 v8, v9, 4, v8
    v_lshl_add_u32 v8, v3, 8, v8
    v_add_u32 v8, 19267584, v8
    s_and_b32 s20, s5, 3
    s_mul_i32 s20, s20, 28
    v_add_u32 v11, s20, v11
    s_lshr_b32 s20, s5, 2
    v_lshlrev_b32 v10, 2, v10
    v_add_u32 v10, s20, v10
    v_mul_u32_u24 v10, 7, v10
    v_lshrrev_b32 v12, 4, v11
    v_add_u32 v10, v10, v12
    v_mul_u32_u24 v10, 7, v10
    v_add_u32 v10, s6, v10
    v_lshlrev_b32 v10, 11, v10
    v_and_b32 v11, 15, v11
    v_lshl_add_u32 v10, v11, 4, v10
    v_lshl_add_u32 v9, v3, 8, v10
    v_add_u32 v9, 6422528, v9
    s_waitcnt lgkmcnt(0)
    v_swap_b32 v89, v90
    v_swap_b32 v93, v94
    buffer_store_dwordx4 v[80:83], v8, s[16:19], 0 offen offset:0
    buffer_store_dwordx4 v[84:87], v8, s[16:19], 0 offen offset:1024
    buffer_store_dwordx4 v[88:91], v9, s[16:19], 0 offen offset:0
    buffer_store_dwordx4 v[92:95], v9, s[16:19], 0 offen offset:1024
    s_nop 1
    s_endpgm
prep_aux:
    s_sub_u32 s2, s2, 392
    s_and_b32 s4, s2, 63
    s_lshr_b32 s44, s2, 6
    v_mov_b32 v31, 0x7ffffff0
    s_load_dwordx2 s[16:17], s[0:1], 152
    s_waitcnt lgkmcnt(0)
    s_and_b32 s17, s17, 0xffff
    s_mov_b32 s18, 37379072
    s_mov_b32 s19, 0x20000
    s_load_dwordx2 s[8:9], s[0:1], 0
    s_waitcnt lgkmcnt(0)
    s_and_b32 s9, s9, 0xffff
    s_mov_b32 s10, 1835008
    s_mov_b32 s11, 0x20000
    s_load_dwordx2 s[12:13], s[0:1], 128
    s_waitcnt lgkmcnt(0)
    s_and_b32 s13, s13, 0xffff
    s_mov_b32 s14, 896
    s_mov_b32 s15, 0x20000
    s_load_dwordx2 s[20:21], s[0:1], 80
    s_waitcnt lgkmcnt(0)
    s_and_b32 s21, s21, 0xffff
    s_mov_b32 s22, 7168
    s_mov_b32 s23, 0x20000
    s_cmp_eq_u32 s44, 1
    s_cbranch_scc1 prep_xa
    s_cmp_eq_u32 s44, 2
    s_cbranch_scc1 prep_xa
    s_cmp_eq_u32 s44, 3
    s_cbranch_scc1 prep_g
    s_lshl_b32 s5, s4, 8
    v_add_u32 v4, s5, v0
    v_mov_b32 v8, -1
    v_mov_b32 v9, -1
    v_mov_b32 v10, -1
    v_mov_b32 v11, -1
    s_mov_b32 s24, 98368
    v_add_u32 v5, 0, v4
    v_cmp_gt_u32 vcc, s24, v5
    v_lshlrev_b32 v5, 4, v5
    v_add_u32 v5, 35789824, v5
    v_cndmask_b32 v5, v31, v5, vcc
    buffer_store_dwordx4 v[8:11], v5, s[16:19], 0 offen
    s_nop 1
    v_add_u32 v5, 16384, v4
    v_cmp_gt_u32 vcc, s24, v5
    v_lshlrev_b32 v5, 4, v5
    v_add_u32 v5, 35789824, v5
    v_cndmask_b32 v5, v31, v5, vcc
    buffer_store_dwordx4 v[8:11], v5, s[16:19], 0 offen
    s_nop 1
    v_add_u32 v5, 32768, v4
    v_cmp_gt_u32 vcc, s24, v5
    v_lshlrev_b32 v5, 4, v5
    v_add_u32 v5, 35789824, v5
    v_cndmask_b32 v5, v31, v5, vcc
    buffer_store_dwordx4 v[8:11], v5, s[16:19], 0 offen
    s_nop 1
    v_add_u32 v5, 49152, v4
    v_cmp_gt_u32 vcc, s24, v5
    v_lshlrev_b32 v5, 4, v5
    v_add_u32 v5, 35789824, v5
    v_cndmask_b32 v5, v31, v5, vcc
    buffer_store_dwordx4 v[8:11], v5, s[16:19], 0 offen
    s_nop 1
    v_add_u32 v5, 65536, v4
    v_cmp_gt_u32 vcc, s24, v5
    v_lshlrev_b32 v5, 4, v5
    v_add_u32 v5, 35789824, v5
    v_cndmask_b32 v5, v31, v5, vcc
    buffer_store_dwordx4 v[8:11], v5, s[16:19], 0 offen
    s_nop 1
    v_add_u32 v5, 81920, v4
    v_cmp_gt_u32 vcc, s24, v5
    v_lshlrev_b32 v5, 4, v5
    v_add_u32 v5, 35789824, v5
    v_cndmask_b32 v5, v31, v5, vcc
    buffer_store_dwordx4 v[8:11], v5, s[16:19], 0 offen
    s_nop 1
    v_add_u32 v5, 98304, v4
    v_cmp_gt_u32 vcc, s24, v5
    v_lshlrev_b32 v5, 4, v5
    v_add_u32 v5, 35789824, v5
    v_cndmask_b32 v5, v31, v5, vcc
    buffer_store_dwordx4 v[8:11], v5, s[16:19], 0 offen
    s_nop 1
    s_cmp_lg_u32 s4, 0
    s_cbranch_scc1 prep_end
    v_lshlrev_b32 v5, 4, v0
    buffer_load_dwordx4 v[12:15], v5, s[20:23], 0 offen
    v_add_u32 v6, 4096, v5
    buffer_load_dwordx4 v[16:19], v6, s[20:23], 0 offen
    s_waitcnt vmcnt(0)
    v_add_u32 v5, 35782656, v5
    buffer_store_dwordx4 v[12:15], v5, s[16:19], 0 offen
    s_mov_b32 s24, 7168
    v_cmp_gt_u32 vcc, s24, v6
    v_add_u32 v6, 35782656, v6
    s_nop 0
    v_cndmask_b32 v6, v31, v6, vcc
    buffer_store_dwordx4 v[16:19], v6, s[16:19], 0 offen
    v_add_u32 v5, 1581056, v5
    v_add_u32 v6, 1581056, v6
    s_nop 0
    v_cndmask_b32 v6, v31, v6, vcc
    buffer_store_dwordx4 v[12:15], v5, s[16:19], 0 offen
    buffer_store_dwordx4 v[16:19], v6, s[16:19], 0 offen
    s_endpgm
prep_xa:
    s_cmp_eq_u32 s44, 2
    s_cbranch_scc1 prep_xf
    s_lshr_b32 s5, s3, 1
    s_lshl_b32 s6, s4, 1
    s_add_u32 s6, s6, s5
    s_and_b32 s5, s3, 1
    s_mul_i32 s5, s5, 7
    s_lshl_b32 s7, s6, 4
    v_add_u32 v4, s7, v2
    v_mul_u32_u24 v4, 896, v4
    v_lshl_add_u32 v4, v3, 4, v4
    s_lshl_b32 s7, s5, 6
    v_add_u32 v4, s7, v4
    buffer_load_dwordx4 v[32:35], v4, s[8:11], 0 offen offset:0
    buffer_load_dwordx4 v[36:39], v4, s[8:11], 0 offen offset:64
    buffer_load_dwordx4 v[40:43], v4, s[8:11], 0 offen offset:128
    buffer_load_dwordx4 v[44:47], v4, s[8:11], 0 offen offset:192
    buffer_load_dwordx4 v[48:51], v4, s[8:11], 0 offen offset:256
    buffer_load_dwordx4 v[52:55], v4, s[8:11], 0 offen offset:320
    buffer_load_dwordx4 v[56:59], v4, s[8:11], 0 offen offset:384
    s_mul_i32 s7, s6, 14
    s_add_u32 s7, s7, s5
    s_lshl_b32 s7, s7, 10
    s_add_u32 s7, s7, 28442624
    v_lshlrev_b32 v5, 4, v1
    v_add_u32 v5, s7, v5
    s_lshr_b32 s7, s3, 1
    s_lshl_b32 s7, s7, 4
    s_lshl_b32 s24, s4, 5
    s_add_u32 s7, s7, s24
    v_add_u32 v6, s7, v2
    v_mul_u32_u24 v6, 896, v6
    v_lshl_add_u32 v6, v3, 3, v6
    s_lshl_b32 s7, s5, 6
    v_add_u32 v6, s7, v6
    buffer_load_dwordx2 v[96:97], v6, s[8:11], 0 offen offset:0
    buffer_load_dwordx2 v[98:99], v6, s[8:11], 0 offen offset:32
    buffer_load_dwordx2 v[100:101], v6, s[8:11], 0 offen offset:64
    buffer_load_dwordx2 v[102:103], v6, s[8:11], 0 offen offset:96
    buffer_load_dwordx2 v[104:105], v6, s[8:11], 0 offen offset:128
    buffer_load_dwordx2 v[106:107], v6, s[8:11], 0 offen offset:160
    buffer_load_dwordx2 v[108:109], v6, s[8:11], 0 offen offset:192
    buffer_load_dwordx2 v[110:111], v6, s[8:11], 0 offen offset:224
    buffer_load_dwordx2 v[112:113], v6, s[8:11], 0 offen offset:256
    buffer_load_dwordx2 v[114:115], v6, s[8:11], 0 offen offset:288
    buffer_load_dwordx2 v[116:117], v6, s[8:11], 0 offen offset:320
    buffer_load_dwordx2 v[118:119], v6, s[8:11], 0 offen offset:352
    buffer_load_dwordx2 v[120:121], v6, s[8:11], 0 offen offset:384
    buffer_load_dwordx2 v[122:123], v6, s[8:11], 0 offen offset:416
    s_lshl_b32 s7, s4, 1
    s_lshr_b32 s24, s3, 1
    s_add_u32 s7, s7, s24
    s_mul_i32 s7, s7, 14
    s_add_u32 s7, s7, s5
    s_lshl_b32 s7, s7, 10
    s_add_u32 s7, s7, 30277632
    v_lshlrev_b32 v6, 4, v1
    v_add_u32 v6, s7, v6
    s_waitcnt vmcnt(0)
    s_mov_b32 s7, 0
    buffer_store_dwordx4 v[96:99], v6, s[16:19], s7 offen
    buffer_store_dwordx4 v[32:35], v5, s[16:19], s7 offen
    s_mov_b32 s7, 1024
    buffer_store_dwordx4 v[100:103], v6, s[16:19], s7 offen
    buffer_store_dwordx4 v[36:39], v5, s[16:19], s7 offen
    s_mov_b32 s7, 2048
    buffer_store_dwordx4 v[104:107], v6, s[16:19], s7 offen
    buffer_store_dwordx4 v[40:43], v5, s[16:19], s7 offen
    s_mov_b32 s7, 3072
    buffer_store_dwordx4 v[108:111], v6, s[16:19], s7 offen
    buffer_store_dwordx4 v[44:47], v5, s[16:19], s7 offen
    s_mov_b32 s7, 4096
    buffer_store_dwordx4 v[112:115], v6, s[16:19], s7 offen
    buffer_store_dwordx4 v[48:51], v5, s[16:19], s7 offen
    s_mov_b32 s7, 5120
    buffer_store_dwordx4 v[116:119], v6, s[16:19], s7 offen
    buffer_store_dwordx4 v[52:55], v5, s[16:19], s7 offen
    s_mov_b32 s7, 6144
    buffer_store_dwordx4 v[120:123], v6, s[16:19], s7 offen
    buffer_store_dwordx4 v[56:59], v5, s[16:19], s7 offen
    s_endpgm
prep_xf:
    s_lshl_b32 s7, s4, 5
    v_add_u32 v6, s7, v2
    v_mul_u32_u24 v6, 896, v6
    v_lshl_add_u32 v6, v3, 3, v6
    s_mul_i32 s7, s3, 224
    v_add_u32 v6, s7, v6
    v_add_u32 v7, 14336, v6
    buffer_load_dwordx2 v[64:65], v6, s[8:11], 0 offen offset:0
    buffer_load_dwordx2 v[66:67], v6, s[8:11], 0 offen offset:32
    buffer_load_dwordx2 v[68:69], v6, s[8:11], 0 offen offset:64
    buffer_load_dwordx2 v[70:71], v6, s[8:11], 0 offen offset:96
    buffer_load_dwordx2 v[72:73], v6, s[8:11], 0 offen offset:128
    buffer_load_dwordx2 v[74:75], v6, s[8:11], 0 offen offset:160
    buffer_load_dwordx2 v[76:77], v6, s[8:11], 0 offen offset:192
    buffer_load_dwordx2 v[78:79], v7, s[8:11], 0 offen offset:0
    buffer_load_dwordx2 v[80:81], v7, s[8:11], 0 offen offset:32
    buffer_load_dwordx2 v[82:83], v7, s[8:11], 0 offen offset:64
    buffer_load_dwordx2 v[84:85], v7, s[8:11], 0 offen offset:96
    buffer_load_dwordx2 v[86:87], v7, s[8:11], 0 offen offset:128
    buffer_load_dwordx2 v[88:89], v7, s[8:11], 0 offen offset:160
    buffer_load_dwordx2 v[90:91], v7, s[8:11], 0 offen offset:192
    s_lshl_b32 s7, s4, 2
    s_add_u32 s7, s7, s3
    s_mul_i32 s7, s7, 7168
    s_add_u32 s7, s7, 26607616
    v_lshlrev_b32 v5, 3, v1
    v_add_u32 v5, s7, v5
    v_lshlrev_b32 v6, 4, v1
    v_add_u32 v6, s7, v6
    s_waitcnt vmcnt(0)
    s_mov_b32 s7, 0
    buffer_store_dwordx2 v[64:65], v5, s[16:19], s7 offen
    s_mov_b32 s7, 512
    buffer_store_dwordx4 v[66:69], v6, s[16:19], s7 offen
    s_mov_b32 s7, 1536
    buffer_store_dwordx4 v[70:73], v6, s[16:19], s7 offen
    s_mov_b32 s7, 2560
    buffer_store_dwordx4 v[74:77], v6, s[16:19], s7 offen
    s_mov_b32 s7, 3584
    buffer_store_dwordx2 v[78:79], v5, s[16:19], s7 offen
    s_mov_b32 s7, 4096
    buffer_store_dwordx4 v[80:83], v6, s[16:19], s7 offen
    s_mov_b32 s7, 5120
    buffer_store_dwordx4 v[84:87], v6, s[16:19], s7 offen
    s_mov_b32 s7, 6144
    buffer_store_dwordx4 v[88:91], v6, s[16:19], s7 offen
    s_endpgm
prep_g:
    v_lshlrev_b32 v4, 4, v1
    v_mov_b32 v30, 896
    v_cmp_gt_u32 vcc, 56, v1
    s_nop 1
    v_cndmask_b32 v4, v30, v4, vcc
    buffer_load_dwordx4 v[12:15], v4, s[12:15], 0 offen
    s_lshl_b32 s5, s4, 2
    s_add_u32 s5, s5, s3
    s_lshl_b32 s5, s5, 3
    s_add_u32 s6, s5, 0
    s_mul_i32 s6, s6, 896
    v_add_u32 v5, s6, v4
    s_nop 0
    v_cndmask_b32 v5, v31, v5, vcc
    buffer_load_dwordx4 v[32:35], v5, s[8:11], 0 offen
    s_add_u32 s6, s5, 1
    s_mul_i32 s6, s6, 896
    v_add_u32 v5, s6, v4
    s_nop 0
    v_cndmask_b32 v5, v31, v5, vcc
    buffer_load_dwordx4 v[36:39], v5, s[8:11], 0 offen
    s_add_u32 s6, s5, 2
    s_mul_i32 s6, s6, 896
    v_add_u32 v5, s6, v4
    s_nop 0
    v_cndmask_b32 v5, v31, v5, vcc
    buffer_load_dwordx4 v[40:43], v5, s[8:11], 0 offen
    s_add_u32 s6, s5, 3
    s_mul_i32 s6, s6, 896
    v_add_u32 v5, s6, v4
    s_nop 0
    v_cndmask_b32 v5, v31, v5, vcc
    buffer_load_dwordx4 v[44:47], v5, s[8:11], 0 offen
    s_add_u32 s6, s5, 4
    s_mul_i32 s6, s6, 896
    v_add_u32 v5, s6, v4
    s_nop 0
    v_cndmask_b32 v5, v31, v5, vcc
    buffer_load_dwordx4 v[48:51], v5, s[8:11], 0 offen
    s_add_u32 s6, s5, 5
    s_mul_i32 s6, s6, 896
    v_add_u32 v5, s6, v4
    s_nop 0
    v_cndmask_b32 v5, v31, v5, vcc
    buffer_load_dwordx4 v[52:55], v5, s[8:11], 0 offen
    s_add_u32 s6, s5, 6
    s_mul_i32 s6, s6, 896
    v_add_u32 v5, s6, v4
    s_nop 0
    v_cndmask_b32 v5, v31, v5, vcc
    buffer_load_dwordx4 v[56:59], v5, s[8:11], 0 offen
    s_add_u32 s6, s5, 7
    s_mul_i32 s6, s6, 896
    v_add_u32 v5, s6, v4
    s_nop 0
    v_cndmask_b32 v5, v31, v5, vcc
    buffer_load_dwordx4 v[60:63], v5, s[8:11], 0 offen
    s_waitcnt vmcnt(0)
    v_lshlrev_b32 v20, 16, v12
    v_and_b32 v21, 0xffff0000, v12
    v_lshlrev_b32 v22, 16, v13
    v_and_b32 v23, 0xffff0000, v13
    v_lshlrev_b32 v24, 16, v14
    v_and_b32 v25, 0xffff0000, v14
    v_lshlrev_b32 v26, 16, v15
    v_and_b32 v27, 0xffff0000, v15
    v_mov_b32 v6, 0
    v_lshlrev_b32 v7, 16, v32
    v_fmac_f32 v6, v7, v20
    v_and_b32 v7, 0xffff0000, v32
    v_fmac_f32 v6, v7, v21
    v_lshlrev_b32 v7, 16, v33
    v_fmac_f32 v6, v7, v22
    v_and_b32 v7, 0xffff0000, v33
    v_fmac_f32 v6, v7, v23
    v_lshlrev_b32 v7, 16, v34
    v_fmac_f32 v6, v7, v24
    v_and_b32 v7, 0xffff0000, v34
    v_fmac_f32 v6, v7, v25
    v_lshlrev_b32 v7, 16, v35
    v_fmac_f32 v6, v7, v26
    v_and_b32 v7, 0xffff0000, v35
    v_fmac_f32 v6, v7, v27
    s_nop 1
    v_add_f32_dpp v6, v6, v6 quad_perm:[1,0,3,2] row_mask:0xf bank_mask:0xf
    s_nop 1
    v_add_f32_dpp v6, v6, v6 quad_perm:[2,3,0,1] row_mask:0xf bank_mask:0xf
    s_nop 1
    v_add_f32_dpp v6, v6, v6 row_half_mirror row_mask:0xf bank_mask:0xf
    s_nop 1
    v_add_f32_dpp v6, v6, v6 row_mirror row_mask:0xf bank_mask:0xf
    s_nop 1
    v_readlane_b32 s6, v6, 0
    v_readlane_b32 s7, v6, 16
    v_readlane_b32 s24, v6, 32
    v_readlane_b32 s25, v6, 48
    s_nop 1
    v_mov_b32 v7, s6
    v_add_f32 v7, s7, v7
    v_add_f32 v7, s24, v7
    v_add_f32 v7, s25, v7
    v_cvt_pk_bf16_f32 v7, v7, v7
    v_lshlrev_b32 v7, 16, v7
    v_mul_f32 v7, 0xbfb8aa3b, v7
    v_exp_f32 v7, v7
    s_nop 0
    v_add_f32 v7, 1.0, v7
    v_rcp_f32 v7, v7
    s_nop 0
    v_cvt_pk_bf16_f32 v7, v7, v7
    v_lshlrev_b32 v7, 16, v7
    v_mov_b32 v72, v7
    v_mov_b32 v6, 0
    v_lshlrev_b32 v7, 16, v36
    v_fmac_f32 v6, v7, v20
    v_and_b32 v7, 0xffff0000, v36
    v_fmac_f32 v6, v7, v21
    v_lshlrev_b32 v7, 16, v37
    v_fmac_f32 v6, v7, v22
    v_and_b32 v7, 0xffff0000, v37
    v_fmac_f32 v6, v7, v23
    v_lshlrev_b32 v7, 16, v38
    v_fmac_f32 v6, v7, v24
    v_and_b32 v7, 0xffff0000, v38
    v_fmac_f32 v6, v7, v25
    v_lshlrev_b32 v7, 16, v39
    v_fmac_f32 v6, v7, v26
    v_and_b32 v7, 0xffff0000, v39
    v_fmac_f32 v6, v7, v27
    s_nop 1
    v_add_f32_dpp v6, v6, v6 quad_perm:[1,0,3,2] row_mask:0xf bank_mask:0xf
    s_nop 1
    v_add_f32_dpp v6, v6, v6 quad_perm:[2,3,0,1] row_mask:0xf bank_mask:0xf
    s_nop 1
    v_add_f32_dpp v6, v6, v6 row_half_mirror row_mask:0xf bank_mask:0xf
    s_nop 1
    v_add_f32_dpp v6, v6, v6 row_mirror row_mask:0xf bank_mask:0xf
    s_nop 1
    v_readlane_b32 s6, v6, 0
    v_readlane_b32 s7, v6, 16
    v_readlane_b32 s24, v6, 32
    v_readlane_b32 s25, v6, 48
    s_nop 1
    v_mov_b32 v7, s6
    v_add_f32 v7, s7, v7
    v_add_f32 v7, s24, v7
    v_add_f32 v7, s25, v7
    v_cvt_pk_bf16_f32 v7, v7, v7
    v_lshlrev_b32 v7, 16, v7
    v_mul_f32 v7, 0xbfb8aa3b, v7
    v_exp_f32 v7, v7
    s_nop 0
    v_add_f32 v7, 1.0, v7
    v_rcp_f32 v7, v7
    s_nop 0
    v_cvt_pk_bf16_f32 v7, v7, v7
    v_lshlrev_b32 v7, 16, v7
    v_mov_b32 v73, v7
    v_mov_b32 v6, 0
    v_lshlrev_b32 v7, 16, v40
    v_fmac_f32 v6, v7, v20
    v_and_b32 v7, 0xffff0000, v40
    v_fmac_f32 v6, v7, v21
    v_lshlrev_b32 v7, 16, v41
    v_fmac_f32 v6, v7, v22
    v_and_b32 v7, 0xffff0000, v41
    v_fmac_f32 v6, v7, v23
    v_lshlrev_b32 v7, 16, v42
    v_fmac_f32 v6, v7, v24
    v_and_b32 v7, 0xffff0000, v42
    v_fmac_f32 v6, v7, v25
    v_lshlrev_b32 v7, 16, v43
    v_fmac_f32 v6, v7, v26
    v_and_b32 v7, 0xffff0000, v43
    v_fmac_f32 v6, v7, v27
    s_nop 1
    v_add_f32_dpp v6, v6, v6 quad_perm:[1,0,3,2] row_mask:0xf bank_mask:0xf
    s_nop 1
    v_add_f32_dpp v6, v6, v6 quad_perm:[2,3,0,1] row_mask:0xf bank_mask:0xf
    s_nop 1
    v_add_f32_dpp v6, v6, v6 row_half_mirror row_mask:0xf bank_mask:0xf
    s_nop 1
    v_add_f32_dpp v6, v6, v6 row_mirror row_mask:0xf bank_mask:0xf
    s_nop 1
    v_readlane_b32 s6, v6, 0
    v_readlane_b32 s7, v6, 16
    v_readlane_b32 s24, v6, 32
    v_readlane_b32 s25, v6, 48
    s_nop 1
    v_mov_b32 v7, s6
    v_add_f32 v7, s7, v7
    v_add_f32 v7, s24, v7
    v_add_f32 v7, s25, v7
    v_cvt_pk_bf16_f32 v7, v7, v7
    v_lshlrev_b32 v7, 16, v7
    v_mul_f32 v7, 0xbfb8aa3b, v7
    v_exp_f32 v7, v7
    s_nop 0
    v_add_f32 v7, 1.0, v7
    v_rcp_f32 v7, v7
    s_nop 0
    v_cvt_pk_bf16_f32 v7, v7, v7
    v_lshlrev_b32 v7, 16, v7
    v_mov_b32 v74, v7
    v_mov_b32 v6, 0
    v_lshlrev_b32 v7, 16, v44
    v_fmac_f32 v6, v7, v20
    v_and_b32 v7, 0xffff0000, v44
    v_fmac_f32 v6, v7, v21
    v_lshlrev_b32 v7, 16, v45
    v_fmac_f32 v6, v7, v22
    v_and_b32 v7, 0xffff0000, v45
    v_fmac_f32 v6, v7, v23
    v_lshlrev_b32 v7, 16, v46
    v_fmac_f32 v6, v7, v24
    v_and_b32 v7, 0xffff0000, v46
    v_fmac_f32 v6, v7, v25
    v_lshlrev_b32 v7, 16, v47
    v_fmac_f32 v6, v7, v26
    v_and_b32 v7, 0xffff0000, v47
    v_fmac_f32 v6, v7, v27
    s_nop 1
    v_add_f32_dpp v6, v6, v6 quad_perm:[1,0,3,2] row_mask:0xf bank_mask:0xf
    s_nop 1
    v_add_f32_dpp v6, v6, v6 quad_perm:[2,3,0,1] row_mask:0xf bank_mask:0xf
    s_nop 1
    v_add_f32_dpp v6, v6, v6 row_half_mirror row_mask:0xf bank_mask:0xf
    s_nop 1
    v_add_f32_dpp v6, v6, v6 row_mirror row_mask:0xf bank_mask:0xf
    s_nop 1
    v_readlane_b32 s6, v6, 0
    v_readlane_b32 s7, v6, 16
    v_readlane_b32 s24, v6, 32
    v_readlane_b32 s25, v6, 48
    s_nop 1
    v_mov_b32 v7, s6
    v_add_f32 v7, s7, v7
    v_add_f32 v7, s24, v7
    v_add_f32 v7, s25, v7
    v_cvt_pk_bf16_f32 v7, v7, v7
    v_lshlrev_b32 v7, 16, v7
    v_mul_f32 v7, 0xbfb8aa3b, v7
    v_exp_f32 v7, v7
    s_nop 0
    v_add_f32 v7, 1.0, v7
    v_rcp_f32 v7, v7
    s_nop 0
    v_cvt_pk_bf16_f32 v7, v7, v7
    v_lshlrev_b32 v7, 16, v7
    v_mov_b32 v75, v7
    v_mov_b32 v6, 0
    v_lshlrev_b32 v7, 16, v48
    v_fmac_f32 v6, v7, v20
    v_and_b32 v7, 0xffff0000, v48
    v_fmac_f32 v6, v7, v21
    v_lshlrev_b32 v7, 16, v49
    v_fmac_f32 v6, v7, v22
    v_and_b32 v7, 0xffff0000, v49
    v_fmac_f32 v6, v7, v23
    v_lshlrev_b32 v7, 16, v50
    v_fmac_f32 v6, v7, v24
    v_and_b32 v7, 0xffff0000, v50
    v_fmac_f32 v6, v7, v25
    v_lshlrev_b32 v7, 16, v51
    v_fmac_f32 v6, v7, v26
    v_and_b32 v7, 0xffff0000, v51
    v_fmac_f32 v6, v7, v27
    s_nop 1
    v_add_f32_dpp v6, v6, v6 quad_perm:[1,0,3,2] row_mask:0xf bank_mask:0xf
    s_nop 1
    v_add_f32_dpp v6, v6, v6 quad_perm:[2,3,0,1] row_mask:0xf bank_mask:0xf
    s_nop 1
    v_add_f32_dpp v6, v6, v6 row_half_mirror row_mask:0xf bank_mask:0xf
    s_nop 1
    v_add_f32_dpp v6, v6, v6 row_mirror row_mask:0xf bank_mask:0xf
    s_nop 1
    v_readlane_b32 s6, v6, 0
    v_readlane_b32 s7, v6, 16
    v_readlane_b32 s24, v6, 32
    v_readlane_b32 s25, v6, 48
    s_nop 1
    v_mov_b32 v7, s6
    v_add_f32 v7, s7, v7
    v_add_f32 v7, s24, v7
    v_add_f32 v7, s25, v7
    v_cvt_pk_bf16_f32 v7, v7, v7
    v_lshlrev_b32 v7, 16, v7
    v_mul_f32 v7, 0xbfb8aa3b, v7
    v_exp_f32 v7, v7
    s_nop 0
    v_add_f32 v7, 1.0, v7
    v_rcp_f32 v7, v7
    s_nop 0
    v_cvt_pk_bf16_f32 v7, v7, v7
    v_lshlrev_b32 v7, 16, v7
    v_mov_b32 v76, v7
    v_mov_b32 v6, 0
    v_lshlrev_b32 v7, 16, v52
    v_fmac_f32 v6, v7, v20
    v_and_b32 v7, 0xffff0000, v52
    v_fmac_f32 v6, v7, v21
    v_lshlrev_b32 v7, 16, v53
    v_fmac_f32 v6, v7, v22
    v_and_b32 v7, 0xffff0000, v53
    v_fmac_f32 v6, v7, v23
    v_lshlrev_b32 v7, 16, v54
    v_fmac_f32 v6, v7, v24
    v_and_b32 v7, 0xffff0000, v54
    v_fmac_f32 v6, v7, v25
    v_lshlrev_b32 v7, 16, v55
    v_fmac_f32 v6, v7, v26
    v_and_b32 v7, 0xffff0000, v55
    v_fmac_f32 v6, v7, v27
    s_nop 1
    v_add_f32_dpp v6, v6, v6 quad_perm:[1,0,3,2] row_mask:0xf bank_mask:0xf
    s_nop 1
    v_add_f32_dpp v6, v6, v6 quad_perm:[2,3,0,1] row_mask:0xf bank_mask:0xf
    s_nop 1
    v_add_f32_dpp v6, v6, v6 row_half_mirror row_mask:0xf bank_mask:0xf
    s_nop 1
    v_add_f32_dpp v6, v6, v6 row_mirror row_mask:0xf bank_mask:0xf
    s_nop 1
    v_readlane_b32 s6, v6, 0
    v_readlane_b32 s7, v6, 16
    v_readlane_b32 s24, v6, 32
    v_readlane_b32 s25, v6, 48
    s_nop 1
    v_mov_b32 v7, s6
    v_add_f32 v7, s7, v7
    v_add_f32 v7, s24, v7
    v_add_f32 v7, s25, v7
    v_cvt_pk_bf16_f32 v7, v7, v7
    v_lshlrev_b32 v7, 16, v7
    v_mul_f32 v7, 0xbfb8aa3b, v7
    v_exp_f32 v7, v7
    s_nop 0
    v_add_f32 v7, 1.0, v7
    v_rcp_f32 v7, v7
    s_nop 0
    v_cvt_pk_bf16_f32 v7, v7, v7
    v_lshlrev_b32 v7, 16, v7
    v_mov_b32 v77, v7
    v_mov_b32 v6, 0
    v_lshlrev_b32 v7, 16, v56
    v_fmac_f32 v6, v7, v20
    v_and_b32 v7, 0xffff0000, v56
    v_fmac_f32 v6, v7, v21
    v_lshlrev_b32 v7, 16, v57
    v_fmac_f32 v6, v7, v22
    v_and_b32 v7, 0xffff0000, v57
    v_fmac_f32 v6, v7, v23
    v_lshlrev_b32 v7, 16, v58
    v_fmac_f32 v6, v7, v24
    v_and_b32 v7, 0xffff0000, v58
    v_fmac_f32 v6, v7, v25
    v_lshlrev_b32 v7, 16, v59
    v_fmac_f32 v6, v7, v26
    v_and_b32 v7, 0xffff0000, v59
    v_fmac_f32 v6, v7, v27
    s_nop 1
    v_add_f32_dpp v6, v6, v6 quad_perm:[1,0,3,2] row_mask:0xf bank_mask:0xf
    s_nop 1
    v_add_f32_dpp v6, v6, v6 quad_perm:[2,3,0,1] row_mask:0xf bank_mask:0xf
    s_nop 1
    v_add_f32_dpp v6, v6, v6 row_half_mirror row_mask:0xf bank_mask:0xf
    s_nop 1
    v_add_f32_dpp v6, v6, v6 row_mirror row_mask:0xf bank_mask:0xf
    s_nop 1
    v_readlane_b32 s6, v6, 0
    v_readlane_b32 s7, v6, 16
    v_readlane_b32 s24, v6, 32
    v_readlane_b32 s25, v6, 48
    s_nop 1
    v_mov_b32 v7, s6
    v_add_f32 v7, s7, v7
    v_add_f32 v7, s24, v7
    v_add_f32 v7, s25, v7
    v_cvt_pk_bf16_f32 v7, v7, v7
    v_lshlrev_b32 v7, 16, v7
    v_mul_f32 v7, 0xbfb8aa3b, v7
    v_exp_f32 v7, v7
    s_nop 0
    v_add_f32 v7, 1.0, v7
    v_rcp_f32 v7, v7
    s_nop 0
    v_cvt_pk_bf16_f32 v7, v7, v7
    v_lshlrev_b32 v7, 16, v7
    v_mov_b32 v78, v7
    v_mov_b32 v6, 0
    v_lshlrev_b32 v7, 16, v60
    v_fmac_f32 v6, v7, v20
    v_and_b32 v7, 0xffff0000, v60
    v_fmac_f32 v6, v7, v21
    v_lshlrev_b32 v7, 16, v61
    v_fmac_f32 v6, v7, v22
    v_and_b32 v7, 0xffff0000, v61
    v_fmac_f32 v6, v7, v23
    v_lshlrev_b32 v7, 16, v62
    v_fmac_f32 v6, v7, v24
    v_and_b32 v7, 0xffff0000, v62
    v_fmac_f32 v6, v7, v25
    v_lshlrev_b32 v7, 16, v63
    v_fmac_f32 v6, v7, v26
    v_and_b32 v7, 0xffff0000, v63
    v_fmac_f32 v6, v7, v27
    s_nop 1
    v_add_f32_dpp v6, v6, v6 quad_perm:[1,0,3,2] row_mask:0xf bank_mask:0xf
    s_nop 1
    v_add_f32_dpp v6, v6, v6 quad_perm:[2,3,0,1] row_mask:0xf bank_mask:0xf
    s_nop 1
    v_add_f32_dpp v6, v6, v6 row_half_mirror row_mask:0xf bank_mask:0xf
    s_nop 1
    v_add_f32_dpp v6, v6, v6 row_mirror row_mask:0xf bank_mask:0xf
    s_nop 1
    v_readlane_b32 s6, v6, 0
    v_readlane_b32 s7, v6, 16
    v_readlane_b32 s24, v6, 32
    v_readlane_b32 s25, v6, 48
    s_nop 1
    v_mov_b32 v7, s6
    v_add_f32 v7, s7, v7
    v_add_f32 v7, s24, v7
    v_add_f32 v7, s25, v7
    v_cvt_pk_bf16_f32 v7, v7, v7
    v_lshlrev_b32 v7, 16, v7
    v_mul_f32 v7, 0xbfb8aa3b, v7
    v_exp_f32 v7, v7
    s_nop 0
    v_add_f32 v7, 1.0, v7
    v_rcp_f32 v7, v7
    s_nop 0
    v_cvt_pk_bf16_f32 v7, v7, v7
    v_lshlrev_b32 v7, 16, v7
    v_mov_b32 v79, v7
    v_mov_b32 v7, v72
    v_cmp_eq_u32 vcc, 1, v1
    s_nop 1
    v_cndmask_b32 v7, v7, v73, vcc
    v_cmp_eq_u32 vcc, 2, v1
    s_nop 1
    v_cndmask_b32 v7, v7, v74, vcc
    v_cmp_eq_u32 vcc, 3, v1
    s_nop 1
    v_cndmask_b32 v7, v7, v75, vcc
    v_cmp_eq_u32 vcc, 4, v1
    s_nop 1
    v_cndmask_b32 v7, v7, v76, vcc
    v_cmp_eq_u32 vcc, 5, v1
    s_nop 1
    v_cndmask_b32 v7, v7, v77, vcc
    v_cmp_eq_u32 vcc, 6, v1
    s_nop 1
    v_cndmask_b32 v7, v7, v78, vcc
    v_cmp_eq_u32 vcc, 7, v1
    s_nop 1
    v_cndmask_b32 v7, v7, v79, vcc
    v_add_u32 v5, s5, v1
    v_lshlrev_b32 v5, 2, v5
    v_add_u32 v5, 37370880, v5
    v_cmp_gt_u32 vcc, 8, v1
    s_nop 1
    v_cndmask_b32 v5, v31, v5, vcc
    buffer_store_dword v7, v5, s[16:19], 0 offen
prep_end:
    s_endpgm
.globl chain_kernel
.p2align 8
.type chain_kernel,@function
chain_kernel:
    s_cmp_ge_u32 s2, 256
    s_cbranch_scc1 chain_end
    v_and_b32 v1, 63, v0
    v_and_b32 v2, 15, v0
    v_lshrrev_b32 v3, 4, v1
    v_lshrrev_b32 v4, 6, v0
    s_nop 0
    v_readfirstlane_b32 s5, v4
    s_load_dwordx2 s[8:9], s[0:1], 144
    s_getreg_b32 s10, hwreg(HW_REG_XCC_ID, 0, 4)
    s_and_b32 s10, s10, 7
    s_waitcnt lgkmcnt(0)
    v_cmp_eq_u32 vcc, 0, v0
    s_and_saveexec_b64 s[12:13], vcc
    s_cbranch_execz el_done
    s_lshl_b32 s11, s10, 2
    v_mov_b32 v4, s11
    v_mov_b32 v5, 1
    global_atomic_add v6, v4, v5, s[8:9] sc0
    s_waitcnt vmcnt(0)
    v_mov_b32 v4, 64
    s_add_u32 s11, s10, 1
    v_cmp_eq_u32 vcc, 31, v6
    s_cbranch_vccz el_nocas
    v_mov_b32 v8, s11
    v_mov_b32 v9, 0
    global_atomic_cmpswap v4, v[8:9], s[8:9]
    s_waitcnt vmcnt(0)
el_nocas:
    v_mov_b32 v7, -1
    v_cmp_gt_u32 vcc, 32, v6
    s_cbranch_vccz el_write
    s_mov_b32 s14, 400000
el_poll:
    global_load_dword v8, v4, s[8:9] sc1
    s_waitcnt vmcnt(0)
    v_cmp_ne_u32 vcc, 0, v8
    s_cbranch_vccnz el_got
    s_sleep 2
    s_sub_u32 s14, s14, 1
    s_cmp_lg_u32 s14, 0
    s_cbranch_scc1 el_poll
    s_branch el_write
el_got:
    v_cmp_eq_u32 vcc, s11, v8
    s_nop 1
    v_cndmask_b32 v7, v7, v6, vcc
el_write:
    v_mov_b32 v4, 49152
    ds_write_b32 v4, v7
    s_waitcnt lgkmcnt(0)
el_done:
    s_mov_b64 exec, s[12:13]
    s_barrier
    v_mov_b32 v4, 49152
    ds_read_b32 v5, v4
    s_waitcnt lgkmcnt(0)
    s_nop 0
    v_readfirstlane_b32 s4, v5
    s_nop 3
    s_cmp_ge_u32 s4, 32
    s_cbranch_scc1 wk_entry
    s_load_dwordx2 s[12:13], s[0:1], 152
    s_waitcnt lgkmcnt(0)
    s_add_u32 s12, s12, 35782656
    s_addc_u32 s13, s13, 0
    s_and_b32 s13, s13, 0xffff
    s_mov_b32 s14, 1581056
    s_mov_b32 s15, 0x20000
    s_load_dwordx2 s[8:9], s[0:1], 152
    s_waitcnt lgkmcnt(0)
    s_and_b32 s9, s9, 0xffff
    s_mov_b32 s10, 12845056
    s_mov_b32 s11, 0x20000
    s_lshl_b32 s16, s4, 2
    s_add_u32 s16, s16, s5
    s_mul_i32 s16, s16, 100352
    v_lshlrev_b32 v4, 4, v1
    v_add_u32 v4, s16, v4
    s_mov_b32 s17, 0
    buffer_load_dwordx4 a[0:3], v4, s[8:11], s17 offen
    s_mov_b32 s17, 1024
    buffer_load_dwordx4 a[4:7], v4, s[8:11], s17 offen
    s_mov_b32 s17, 2048
    buffer_load_dwordx4 a[8:11], v4, s[8:11], s17 offen
    s_mov_b32 s17, 3072
    buffer_load_dwordx4 a[12:15], v4, s[8:11], s17 offen
    s_mov_b32 s17, 4096
    buffer_load_dwordx4 a[16:19], v4, s[8:11], s17 offen
    s_mov_b32 s17, 5120
    buffer_load_dwordx4 a[20:23], v4, s[8:11], s17 offen
    s_mov_b32 s17, 6144
    buffer_load_dwordx4 a[24:27], v4, s[8:11], s17 offen
    s_mov_b32 s17, 7168
    buffer_load_dwordx4 a[28:31], v4, s[8:11], s17 offen
    s_mov_b32 s17, 8192
    buffer_load_dwordx4 a[32:35], v4, s[8:11], s17 offen
    s_mov_b32 s17, 9216
    buffer_load_dwordx4 a[36:39], v4, s[8:11], s17 offen
    s_mov_b32 s17, 10240
    buffer_load_dwordx4 a[40:43], v4, s[8:11], s17 offen
    s_mov_b32 s17, 11264
    buffer_load_dwordx4 a[44:47], v4, s[8:11], s17 offen
    s_mov_b32 s17, 12288
    buffer_load_dwordx4 a[48:51], v4, s[8:11], s17 offen
    s_mov_b32 s17, 13312
    buffer_load_dwordx4 a[52:55], v4, s[8:11], s17 offen
    s_mov_b32 s17, 14336
    buffer_load_dwordx4 a[56:59], v4, s[8:11], s17 offen
    s_mov_b32 s17, 15360
    buffer_load_dwordx4 a[60:63], v4, s[8:11], s17 offen
    s_mov_b32 s17, 16384
    buffer_load_dwordx4 a[64:67], v4, s[8:11], s17 offen
    s_mov_b32 s17, 17408
    buffer_load_dwordx4 a[68:71], v4, s[8:11], s17 offen
    s_mov_b32 s17, 18432
    buffer_load_dwordx4 a[72:75], v4, s[8:11], s17 offen
    s_mov_b32 s17, 19456
    buffer_load_dwordx4 a[76:79], v4, s[8:11], s17 offen
    s_mov_b32 s17, 20480
    buffer_load_dwordx4 a[80:83], v4, s[8:11], s17 offen
    s_mov_b32 s17, 21504
    buffer_load_dwordx4 a[84:87], v4, s[8:11], s17 offen
    s_mov_b32 s17, 22528
    buffer_load_dwordx4 a[88:91], v4, s[8:11], s17 offen
    s_mov_b32 s17, 23552
    buffer_load_dwordx4 a[92:95], v4, s[8:11], s17 offen
    s_mov_b32 s17, 24576
    buffer_load_dwordx4 a[96:99], v4, s[8:11], s17 offen
    s_mov_b32 s17, 25600
    buffer_load_dwordx4 a[100:103], v4, s[8:11], s17 offen
    s_mov_b32 s17, 26624
    buffer_load_dwordx4 a[104:107], v4, s[8:11], s17 offen
    s_mov_b32 s17, 27648
    buffer_load_dwordx4 a[108:111], v4, s[8:11], s17 offen
    s_mov_b32 s17, 28672
    buffer_load_dwordx4 a[112:115], v4, s[8:11], s17 offen
    s_mov_b32 s17, 29696
    buffer_load_dwordx4 a[116:119], v4, s[8:11], s17 offen
    s_mov_b32 s17, 30720
    buffer_load_dwordx4 a[120:123], v4, s[8:11], s17 offen
    s_mov_b32 s17, 31744
    buffer_load_dwordx4 a[124:127], v4, s[8:11], s17 offen
    s_waitcnt vmcnt(31)
    s_mov_b32 s17, 32768
    buffer_load_dwordx4 a[128:131], v4, s[8:11], s17 offen
    s_mov_b32 s17, 33792
    buffer_load_dwordx4 a[132:135], v4, s[8:11], s17 offen
    s_mov_b32 s17, 34816
    buffer_load_dwordx4 a[136:139], v4, s[8:11], s17 offen
    s_mov_b32 s17, 35840
    buffer_load_dwordx4 a[140:143], v4, s[8:11], s17 offen
    s_mov_b32 s17, 36864
    buffer_load_dwordx4 a[144:147], v4, s[8:11], s17 offen
    s_mov_b32 s17, 37888
    buffer_load_dwordx4 a[148:151], v4, s[8:11], s17 offen
    s_mov_b32 s17, 38912
    buffer_load_dwordx4 a[152:155], v4, s[8:11], s17 offen
    s_mov_b32 s17, 39936
    buffer_load_dwordx4 a[156:159], v4, s[8:11], s17 offen
    s_mov_b32 s17, 40960
    buffer_load_dwordx4 a[160:163], v4, s[8:11], s17 offen
    s_mov_b32 s17, 41984
    buffer_load_dwordx4 a[164:167], v4, s[8:11], s17 offen
    s_mov_b32 s17, 43008
    buffer_load_dwordx4 a[168:171], v4, s[8:11], s17 offen
    s_mov_b32 s17, 44032
    buffer_load_dwordx4 a[172:175], v4, s[8:11], s17 offen
    s_mov_b32 s17, 45056
    buffer_load_dwordx4 a[176:179], v4, s[8:11], s17 offen
    s_mov_b32 s17, 46080
    buffer_load_dwordx4 a[180:183], v4, s[8:11], s17 offen
    s_mov_b32 s17, 47104
    buffer_load_dwordx4 a[184:187], v4, s[8:11], s17 offen
    s_mov_b32 s17, 48128
    buffer_load_dwordx4 a[188:191], v4, s[8:11], s17 offen
    s_mov_b32 s17, 49152
    buffer_load_dwordx4 a[192:195], v4, s[8:11], s17 offen
    s_mov_b32 s17, 50176
    buffer_load_dwordx4 a[196:199], v4, s[8:11], s17 offen
    s_mov_b32 s17, 51200
    buffer_load_dwordx4 a[200:203], v4, s[8:11], s17 offen
    s_mov_b32 s17, 52224
    buffer_load_dwordx4 a[204:207], v4, s[8:11], s17 offen
    s_mov_b32 s17, 53248
    buffer_load_dwordx4 a[208:211], v4, s[8:11], s17 offen
    s_mov_b32 s17, 54272
    buffer_load_dwordx4 a[212:215], v4, s[8:11], s17 offen
    s_mov_b32 s17, 55296
    buffer_load_dwordx4 a[216:219], v4, s[8:11], s17 offen
    s_mov_b32 s17, 56320
    buffer_load_dwordx4 a[220:223], v4, s[8:11], s17 offen
    s_mov_b32 s17, 57344
    buffer_load_dwordx4 a[224:227], v4, s[8:11], s17 offen
    s_mov_b32 s17, 58368
    buffer_load_dwordx4 a[228:231], v4, s[8:11], s17 offen
    s_mov_b32 s17, 59392
    buffer_load_dwordx4 a[232:235], v4, s[8:11], s17 offen
    s_mov_b32 s17, 60416
    buffer_load_dwordx4 a[236:239], v4, s[8:11], s17 offen
    s_mov_b32 s17, 61440
    buffer_load_dwordx4 a[240:243], v4, s[8:11], s17 offen
    s_mov_b32 s17, 62464
    buffer_load_dwordx4 a[244:247], v4, s[8:11], s17 offen
    s_mov_b32 s17, 63488
    buffer_load_dwordx4 a[248:251], v4, s[8:11], s17 offen
    s_mov_b32 s17, 64512
    buffer_load_dwordx4 a[252:255], v4, s[8:11], s17 offen
    s_waitcnt vmcnt(31)
    s_mov_b32 s17, 65536
    buffer_load_dwordx4 v[120:123], v4, s[8:11], s17 offen
    s_mov_b32 s17, 66560
    buffer_load_dwordx4 v[124:127], v4, s[8:11], s17 offen
    s_mov_b32 s17, 67584
    buffer_load_dwordx4 v[128:131], v4, s[8:11], s17 offen
    s_mov_b32 s17, 68608
    buffer_load_dwordx4 v[132:135], v4, s[8:11], s17 offen
    s_mov_b32 s17, 69632
    buffer_load_dwordx4 v[136:139], v4, s[8:11], s17 offen
    s_mov_b32 s17, 70656
    buffer_load_dwordx4 v[140:143], v4, s[8:11], s17 offen
    s_mov_b32 s17, 71680
    buffer_load_dwordx4 v[144:147], v4, s[8:11], s17 offen
    s_mov_b32 s17, 72704
    buffer_load_dwordx4 v[148:151], v4, s[8:11], s17 offen
    s_mov_b32 s17, 73728
    buffer_load_dwordx4 v[152:155], v4, s[8:11], s17 offen
    s_mov_b32 s17, 74752
    buffer_load_dwordx4 v[156:159], v4, s[8:11], s17 offen
    s_mov_b32 s17, 75776
    buffer_load_dwordx4 v[160:163], v4, s[8:11], s17 offen
    s_mov_b32 s17, 76800
    buffer_load_dwordx4 v[164:167], v4, s[8:11], s17 offen
    s_mov_b32 s17, 77824
    buffer_load_dwordx4 v[168:171], v4, s[8:11], s17 offen
    s_mov_b32 s17, 78848
    buffer_load_dwordx4 v[172:175], v4, s[8:11], s17 offen
    s_mov_b32 s17, 79872
    buffer_load_dwordx4 v[176:179], v4, s[8:11], s17 offen
    s_mov_b32 s17, 80896
    buffer_load_dwordx4 v[180:183], v4, s[8:11], s17 offen
    s_mov_b32 s17, 81920
    buffer_load_dwordx4 v[184:187], v4, s[8:11], s17 offen
    s_mov_b32 s17, 82944
    buffer_load_dwordx4 v[188:191], v4, s[8:11], s17 offen
    s_mov_b32 s17, 83968
    buffer_load_dwordx4 v[192:195], v4, s[8:11], s17 offen
    s_mov_b32 s17, 84992
    buffer_load_dwordx4 v[196:199], v4, s[8:11], s17 offen
    s_mov_b32 s17, 86016
    buffer_load_dwordx4 v[200:203], v4, s[8:11], s17 offen
    s_mov_b32 s17, 87040
    buffer_load_dwordx4 v[204:207], v4, s[8:11], s17 offen
    s_mov_b32 s17, 88064
    buffer_load_dwordx4 v[208:211], v4, s[8:11], s17 offen
    s_mov_b32 s17, 89088
    buffer_load_dwordx4 v[212:215], v4, s[8:11], s17 offen
    s_mov_b32 s17, 90112
    buffer_load_dwordx4 v[216:219], v4, s[8:11], s17 offen
    s_mov_b32 s17, 91136
    buffer_load_dwordx4 v[220:223], v4, s[8:11], s17 offen
    s_mov_b32 s17, 92160
    buffer_load_dwordx4 v[224:227], v4, s[8:11], s17 offen
    s_mov_b32 s17, 93184
    buffer_load_dwordx4 v[228:231], v4, s[8:11], s17 offen
    s_mov_b32 s17, 94208
    buffer_load_dwordx4 v[232:235], v4, s[8:11], s17 offen
    s_mov_b32 s17, 95232
    buffer_load_dwordx4 v[236:239], v4, s[8:11], s17 offen
    s_mov_b32 s17, 96256
    buffer_load_dwordx4 v[240:243], v4, s[8:11], s17 offen
    s_mov_b32 s17, 97280
    buffer_load_dwordx4 v[244:247], v4, s[8:11], s17 offen
    s_waitcnt vmcnt(31)
    s_mov_b32 s17, 98304
    buffer_load_dwordx4 v[248:251], v4, s[8:11], s17 offen
    s_mov_b32 s17, 99328
    buffer_load_dwordx4 v[252:255], v4, s[8:11], s17 offen
    v_mul_u32_u24 v6, 1171, v0
    v_lshrrev_b32 v6, 16, v6
    v_mul_u32_u24 v7, 56, v6
    v_sub_u32 v7, v0, v7
    v_lshlrev_b32 v4, 4, v0
    v_mul_u32_u24 v5, 912, v6
    v_lshlrev_b32 v7, 4, v7
    v_add_u32 v5, v5, v7
    s_movk_i32 s16, 224
    v_cmp_gt_u32 vcc, s16, v0
    s_nop 4
    s_mov_b64 s[26:27], vcc
    v_and_b32 v6, 7, v2
    v_mul_u32_u24 v6, 912, v6
    v_lshlrev_b32 v7, 5, v3
    v_add_u32 v6, v6, v7
    v_lshrrev_b32 v7, 3, v2
    v_lshlrev_b32 v36, 4, v7
    v_add_u32 v6, v6, v36
    v_mov_b32 v36, 0x44444444
    v_mov_b32 v37, 0xeeeeeeee
    v_cmp_eq_u32 vcc, 1, v7
    s_nop 1
    v_cndmask_b32 v36, v36, v37, vcc
    s_mov_b32 s6, 0
    s_mov_b32 s7, 0
    s_mov_b32 s24, 466944
    s_cmp_ge_u32 s4, 16
    s_cbranch_scc1 chain_v
    s_load_dwordx2 s[16:17], s[0:1], 152
    s_waitcnt lgkmcnt(0)
    s_add_u32 s16, s16, 26607616
    s_addc_u32 s17, s17, 0
    s_and_b32 s17, s17, 0xffff
    s_mov_b32 s18, 1835008
    s_mov_b32 s19, 0x20000
    s_mul_i32 s28, s5, 224
    v_and_b32 v7, 7, v2
    v_mul_u32_u24 v7, 912, v7
    v_lshlrev_b32 v39, 3, v3
    v_add_u32 v7, v7, v39
    v_add_u32 v7, s28, v7
    s_mul_i32 s28, s5, 7168
    v_lshlrev_b32 v39, 3, v1
    v_add_u32 v39, s28, v39
    s_mul_i32 s29, s5, 4608
    s_add_u32 s29, s29, 8192
    v_mul_u32_u24 v37, 40, v2
    v_lshlrev_b32 v38, 3, v3
    v_add_u32 v37, v37, v38
    v_add_u32 v37, s29, v37
    v_lshrrev_b32 v38, 2, v2
    v_lshl_add_u32 v38, v3, 2, v38
    v_mul_u32_u24 v38, 40, v38
    v_and_b32 v116, 3, v2
    v_lshl_add_u32 v38, v116, 3, v38
    v_add_u32 v38, s29, v38
    s_mul_i32 s29, s5, 3264
    s_add_u32 s29, s29, 32768
    v_mul_u32_u24 v116, 272, v3
    v_lshl_add_u32 v116, v2, 4, v116
    v_add_u32 v116, s29, v116
    v_and_b32 v8, 31, v1
    v_lshrrev_b32 v9, 5, v1
    s_lshl_b32 s29, s5, 1
    v_add_u32 v9, s29, v9
    v_min_u32 v10, 19, v8
    v_lshrrev_b32 v11, 3, v10
    v_mul_u32_u24 v117, 1088, v11
    v_and_b32 v11, 7, v10
    v_lshrrev_b32 v12, 1, v11
    v_mul_u32_u24 v12, 272, v12
    v_add_u32 v117, v117, v12
    v_and_b32 v11, 1, v11
    v_lshlrev_b32 v11, 3, v11
    v_lshl_add_u32 v11, v9, 4, v11
    v_add_u32 v117, v117, v11
    v_add_u32 v117, 32768, v117
    v_cmp_gt_u32 vcc, 20, v8
    s_nop 4
    s_mov_b64 s[30:31], vcc
    s_mul_i32 s29, s4, 640
    v_mul_u32_u24 v9, 80, v9
    v_lshl_add_u32 v9, v8, 2, v9
    v_add_u32 v2, s29, v9
    v_lshlrev_b32 v3, 4, v1
    v_add_u32 v3, s28, v3
    v_min_u32 v0, 55, v1
    v_lshlrev_b32 v0, 7, v0
    v_add_u32 v0, s28, v0
    s_mov_b32 s25, 0
    buffer_load_dwordx2 v[40:41], v39, s[16:19], s25 offen offset:0
    buffer_load_dwordx4 v[42:45], v3, s[16:19], s25 offen offset:512
    buffer_load_dwordx4 v[46:49], v3, s[16:19], s25 offen offset:1536
    buffer_load_dwordx4 v[50:53], v3, s[16:19], s25 offen offset:2560
    buffer_load_dwordx2 v[54:55], v39, s[16:19], s25 offen offset:3584
    s_add_u32 s29, s25, 4096
    buffer_load_dwordx4 v[56:59], v3, s[16:19], s29 offen
    s_add_u32 s29, s25, 5120
    buffer_load_dwordx4 v[60:63], v3, s[16:19], s29 offen
    s_add_u32 s29, s25, 6144
    buffer_load_dwordx4 v[64:67], v3, s[16:19], s29 offen
    s_waitcnt vmcnt(0)
a_loop:
    s_mov_b32 s35, 400000
    s_mov_b64 exec, s[26:27]
    buffer_load_dwordx4 v[96:99], v4, s[12:15], s7 offen sc1
    buffer_load_dwordx4 v[100:103], v4, s[12:15], s7 offen offset:3584 sc1
gm_a:
    buffer_load_dwordx4 v[104:107], v4, s[12:15], s7 offen sc1
    buffer_load_dwordx4 v[108:111], v4, s[12:15], s7 offen offset:3584 sc1
    s_waitcnt vmcnt(2)
    v_max3_u32 v119, v96, v97, v98
    v_max3_u32 v118, v99, v100, v101
    v_max3_u32 v119, v119, v102, v103
    v_max_u32 v119, v119, v118
    v_cmp_eq_u32 vcc, -1, v119
    s_cbranch_vccz gd_a
    buffer_load_dwordx4 v[96:99], v4, s[12:15], s7 offen sc1
    buffer_load_dwordx4 v[100:103], v4, s[12:15], s7 offen offset:3584 sc1
    s_waitcnt vmcnt(2)
    v_max3_u32 v119, v104, v105, v106
    v_max3_u32 v118, v107, v108, v109
    v_max3_u32 v119, v119, v110, v111
    v_max_u32 v119, v119, v118
    v_cmp_eq_u32 vcc, -1, v119
    s_cbranch_vccz ge_a
    s_sub_u32 s35, s35, 1
    s_cmp_lg_u32 s35, 0
    s_cbranch_scc1 gm_a
    s_branch chain_end
ge_a:
    ds_write_b128 v5, v[104:107]
    ds_write_b128 v5, v[108:111] offset:3648
    s_mov_b32 s35, 1
    s_branch gf_a
gd_a:
    ds_write_b128 v5, v[96:99]
    ds_write_b128 v5, v[100:103] offset:3648
    s_mov_b32 s35, 0
gf_a:
    s_mov_b64 exec, -1
    s_waitcnt lgkmcnt(0)
    s_barrier
    ds_read_b128 v[8:11], v6 offset:0
    ds_read_b128 v[12:15], v6 offset:128
    ds_read_b128 v[16:19], v6 offset:256
    ds_read_b128 v[20:23], v6 offset:384
    ds_read_b128 v[24:27], v6 offset:512
    ds_read_b128 v[28:31], v6 offset:640
    ds_read_b128 v[32:35], v6 offset:768
    v_mov_b32 v82, 0
    v_mov_b32 v83, 0
    v_mov_b32 v84, 0
    v_mov_b32 v85, 0
    v_mov_b32 v86, 0
    v_mov_b32 v87, 0
    v_mov_b32 v88, 0
    v_mov_b32 v89, 0
    s_waitcnt lgkmcnt(6)
    v_smfmac_f32_16x16x64_bf16 v[82:85], v[8:11], a[0:7], v36
    s_waitcnt lgkmcnt(5)
    v_smfmac_f32_16x16x64_bf16 v[82:85], v[12:15], a[8:15], v36
    s_waitcnt lgkmcnt(4)
    v_smfmac_f32_16x16x64_bf16 v[82:85], v[16:19], a[16:23], v36
    s_waitcnt lgkmcnt(3)
    v_smfmac_f32_16x16x64_bf16 v[82:85], v[20:23], a[24:31], v36
    s_waitcnt lgkmcnt(2)
    v_smfmac_f32_16x16x64_bf16 v[82:85], v[24:27], a[32:39], v36
    s_waitcnt lgkmcnt(1)
    v_smfmac_f32_16x16x64_bf16 v[82:85], v[28:31], a[40:47], v36
    s_waitcnt lgkmcnt(0)
    v_smfmac_f32_16x16x64_bf16 v[82:85], v[32:35], a[48:55], v36
    v_smfmac_f32_16x16x64_bf16 v[86:89], v[8:11], a[56:63], v36
    ds_read_b64 v[68:69], v7 offset:0
    ds_read_b64 v[70:71], v7 offset:32
    v_smfmac_f32_16x16x64_bf16 v[86:89], v[12:15], a[64:71], v36
    ds_read_b64 v[72:73], v7 offset:64
    ds_read_b64 v[74:75], v7 offset:96
    v_smfmac_f32_16x16x64_bf16 v[86:89], v[16:19], a[72:79], v36
    v_cvt_pk_bf16_f32 v118, v82, v83
    v_cvt_pk_bf16_f32 v119, v84, v85
    ds_write_b64 v37, v[118:119] offset:0
    ds_read_b64_tr_b16 v[90:91], v38 offset:0
    v_smfmac_f32_16x16x64_bf16 v[86:89], v[20:23], a[80:87], v36
    v_smfmac_f32_16x16x64_bf16 v[86:89], v[24:27], a[88:95], v36
    v_mov_b64 v[82:83], 0
    v_mov_b64 v[84:85], 0
    v_smfmac_f32_16x16x64_bf16 v[86:89], v[28:31], a[96:103], v36
    ds_read_b64 v[76:77], v7 offset:128
    ds_read_b64 v[78:79], v7 offset:160
    v_smfmac_f32_16x16x64_bf16 v[86:89], v[32:35], a[104:111], v36
    ds_read_b64 v[80:81], v7 offset:192
    v_smfmac_f32_16x16x64_bf16 v[82:85], v[8:11], a[112:119], v36
    v_smfmac_f32_16x16x64_bf16 v[82:85], v[12:15], a[120:127], v36
    v_smfmac_f32_16x16x64_bf16 v[82:85], v[16:19], a[128:135], v36
    v_cvt_pk_bf16_f32 v118, v86, v87
    v_cvt_pk_bf16_f32 v119, v88, v89
    ds_write_b64 v37, v[118:119] offset:640
    ds_read_b64_tr_b16 v[92:93], v38 offset:640
    v_smfmac_f32_16x16x64_bf16 v[82:85], v[20:23], a[136:143], v36
    v_smfmac_f32_16x16x64_bf16 v[82:85], v[24:27], a[144:151], v36
    v_mov_b64 v[86:87], 0
    v_mov_b64 v[88:89], 0
    v_smfmac_f32_16x16x64_bf16 v[82:85], v[28:31], a[152:159], v36
    s_waitcnt vmcnt(0)
    s_waitcnt lgkmcnt(2)
    v_mfma_f32_16x16x16_bf16 v[104:107], v[40:41], v[90:91], 0
    v_mfma_f32_16x16x16_bf16 v[108:111], v[54:55], v[90:91], 0
    v_mfma_f32_16x16x16_bf16 v[112:115], v[68:69], v[90:91], 0
    v_smfmac_f32_16x16x64_bf16 v[82:85], v[32:35], a[160:167], v36
    v_smfmac_f32_16x16x64_bf16 v[86:89], v[8:11], a[168:175], v36
    s_add_u32 s29, s25, 28672
    s_min_u32 s29, s29, 1806336
    buffer_load_dword v1, v0, s[16:19], s29 offen
    v_smfmac_f32_16x16x64_bf16 v[86:89], v[12:15], a[176:183], v36
    v_smfmac_f32_16x16x64_bf16 v[86:89], v[16:19], a[184:191], v36
    v_cvt_pk_bf16_f32 v118, v82, v83
    v_cvt_pk_bf16_f32 v119, v84, v85
    ds_write_b64 v37, v[118:119] offset:1280
    ds_read_b64_tr_b16 v[94:95], v38 offset:1280
    v_smfmac_f32_16x16x64_bf16 v[86:89], v[20:23], a[192:199], v36
    v_smfmac_f32_16x16x64_bf16 v[86:89], v[24:27], a[200:207], v36
    v_mov_b64 v[82:83], 0
    v_mov_b64 v[84:85], 0
    v_smfmac_f32_16x16x64_bf16 v[86:89], v[28:31], a[208:215], v36
    v_smfmac_f32_16x16x64_bf16 v[86:89], v[32:35], a[216:223], v36
    v_smfmac_f32_16x16x64_bf16 v[82:85], v[8:11], a[224:231], v36
    v_smfmac_f32_16x16x64_bf16 v[82:85], v[12:15], a[232:239], v36
    v_smfmac_f32_16x16x64_bf16 v[82:85], v[16:19], a[240:247], v36
    v_cvt_pk_bf16_f32 v118, v86, v87
    v_cvt_pk_bf16_f32 v119, v88, v89
    ds_write_b64 v37, v[118:119] offset:1920
    ds_read_b64_tr_b16 v[96:97], v38 offset:1920
    v_smfmac_f32_16x16x64_bf16 v[82:85], v[20:23], a[248:255], v36
    v_smfmac_f32_16x16x64_bf16 v[82:85], v[24:27], v[120:127], v36
    v_mov_b64 v[86:87], 0
    v_mov_b64 v[88:89], 0
    v_smfmac_f32_16x16x64_bf16 v[82:85], v[28:31], v[128:135], v36
    s_waitcnt lgkmcnt(2)
    v_mfma_f32_16x16x32_bf16 v[104:107], v[42:45], v[92:95], v[104:107]
    v_mfma_f32_16x16x32_bf16 v[108:111], v[56:59], v[92:95], v[108:111]
    v_mfma_f32_16x16x32_bf16 v[112:115], v[70:73], v[92:95], v[112:115]
    v_smfmac_f32_16x16x64_bf16 v[82:85], v[32:35], v[136:143], v36
    v_smfmac_f32_16x16x64_bf16 v[86:89], v[8:11], v[144:151], v36
    v_smfmac_f32_16x16x64_bf16 v[86:89], v[12:15], v[152:159], v36
    v_smfmac_f32_16x16x64_bf16 v[86:89], v[16:19], v[160:167], v36
    v_cvt_pk_bf16_f32 v118, v82, v83
    v_cvt_pk_bf16_f32 v119, v84, v85
    ds_write_b64 v37, v[118:119] offset:2560
    ds_read_b64_tr_b16 v[98:99], v38 offset:2560
    v_smfmac_f32_16x16x64_bf16 v[86:89], v[20:23], v[168:175], v36
    v_smfmac_f32_16x16x64_bf16 v[86:89], v[24:27], v[176:183], v36
    v_mov_b64 v[82:83], 0
    v_mov_b64 v[84:85], 0
    v_smfmac_f32_16x16x64_bf16 v[86:89], v[28:31], v[184:191], v36
    v_smfmac_f32_16x16x64_bf16 v[86:89], v[32:35], v[192:199], v36
    v_smfmac_f32_16x16x64_bf16 v[82:85], v[8:11], v[200:207], v36
    v_smfmac_f32_16x16x64_bf16 v[82:85], v[12:15], v[208:215], v36
    v_smfmac_f32_16x16x64_bf16 v[82:85], v[16:19], v[216:223], v36
    v_cvt_pk_bf16_f32 v118, v86, v87
    v_cvt_pk_bf16_f32 v119, v88, v89
    ds_write_b64 v37, v[118:119] offset:3200
    ds_read_b64_tr_b16 v[100:101], v38 offset:3200
    v_smfmac_f32_16x16x64_bf16 v[82:85], v[20:23], v[224:231], v36
    v_smfmac_f32_16x16x64_bf16 v[82:85], v[24:27], v[232:239], v36
    v_mov_b64 v[86:87], 0
    v_mov_b64 v[88:89], 0
    v_smfmac_f32_16x16x64_bf16 v[82:85], v[28:31], v[240:247], v36
    s_waitcnt lgkmcnt(2)
    v_mfma_f32_16x16x32_bf16 v[104:107], v[46:49], v[96:99], v[104:107]
    v_mfma_f32_16x16x32_bf16 v[108:111], v[60:63], v[96:99], v[108:111]
    v_mfma_f32_16x16x32_bf16 v[112:115], v[74:77], v[96:99], v[112:115]
    v_smfmac_f32_16x16x64_bf16 v[82:85], v[32:35], v[248:255], v36
    s_nop 7
    v_cvt_pk_bf16_f32 v118, v82, v83
    v_cvt_pk_bf16_f32 v119, v84, v85
    ds_write_b64 v37, v[118:119] offset:3840
    ds_read_b64_tr_b16 v[102:103], v38 offset:3840
    s_waitcnt lgkmcnt(0)
    v_mfma_f32_16x16x32_bf16 v[104:107], v[50:53], v[100:103], v[104:107]
    v_mfma_f32_16x16x32_bf16 v[108:111], v[64:67], v[100:103], v[108:111]
    v_mfma_f32_16x16x32_bf16 v[112:115], v[78:81], v[100:103], v[112:115]
    s_add_u32 s25, s25, 28672
    s_nop 7
    ds_write_b128 v116, v[104:107] offset:0
    ds_write_b128 v116, v[108:111] offset:1088
    ds_write_b128 v116, v[112:115] offset:2176
    s_waitcnt lgkmcnt(0)
    s_barrier
    ds_read_b64 v[8:9], v117 offset:0
    ds_read_b64 v[10:11], v117 offset:128
    ds_read_b64 v[12:13], v117 offset:3264
    ds_read_b64 v[14:15], v117 offset:3392
    ds_read_b64 v[16:17], v117 offset:6528
    ds_read_b64 v[18:19], v117 offset:6656
    ds_read_b64 v[20:21], v117 offset:9792
    ds_read_b64 v[22:23], v117 offset:9920
    s_waitcnt lgkmcnt(6)
    v_pk_add_f32 v[8:9], v[8:9], v[10:11]
    s_waitcnt lgkmcnt(4)
    v_pk_add_f32 v[12:13], v[12:13], v[14:15]
    s_waitcnt lgkmcnt(2)
    v_pk_add_f32 v[16:17], v[16:17], v[18:19]
    v_pk_add_f32 v[8:9], v[8:9], v[12:13]
    s_waitcnt lgkmcnt(0)
    v_pk_add_f32 v[20:21], v[20:21], v[22:23]
    v_pk_add_f32 v[8:9], v[8:9], v[16:17]
    v_mov_b32 v24, 0xff800000
    v_pk_add_f32 v[8:9], v[8:9], v[20:21]
    v_max_f32 v25, v8, v9
    v_cndmask_b32 v25, v24, v25, s[30:31]
    s_nop 1
    v_max_f32_dpp v25, v25, v25 quad_perm:[1,0,3,2] row_mask:0xf bank_mask:0xf
    s_nop 1
    v_max_f32_dpp v25, v25, v25 quad_perm:[2,3,0,1] row_mask:0xf bank_mask:0xf
    s_nop 1
    v_max_f32_dpp v25, v25, v25 row_half_mirror row_mask:0xf bank_mask:0xf
    s_nop 1
    v_max_f32_dpp v25, v25, v25 row_mirror row_mask:0xf bank_mask:0xf
    v_mov_b32 v26, v25
    s_nop 1
    v_permlane16_swap_b32 v25, v26
    s_nop 0
    v_max_f32 v25, v25, v26
    v_mul_f32 v25, 0xbfb8aa3b, v25
    s_mov_b32 s29, 0x3fb8aa3b
    v_fma_f32 v8, v8, s29, v25
    v_fma_f32 v9, v9, s29, v25
    v_exp_f32 v8, v8
    v_exp_f32 v9, v9
    s_nop 0
    v_add_f32 v25, v8, v9
    v_cndmask_b32 v25, 0, v25, s[30:31]
    s_nop 1
    v_add_f32_dpp v25, v25, v25 quad_perm:[1,0,3,2] row_mask:0xf bank_mask:0xf
    s_nop 1
    v_add_f32_dpp v25, v25, v25 quad_perm:[2,3,0,1] row_mask:0xf bank_mask:0xf
    s_nop 1
    v_add_f32_dpp v25, v25, v25 row_half_mirror row_mask:0xf bank_mask:0xf
    s_nop 1
    v_add_f32_dpp v25, v25, v25 row_mirror row_mask:0xf bank_mask:0xf
    v_mov_b32 v26, v25
    s_nop 1
    v_permlane16_swap_b32 v25, v26
    s_nop 0
    v_add_f32 v25, v25, v26
    v_rcp_f32 v25, v25
    s_nop 0
    v_mul_f32 v8, v8, v25
    v_mul_f32 v9, v9, v25
    v_cvt_pk_bf16_f32 v8, v8, v9
    s_mov_b64 exec, s[30:31]
    buffer_store_dword v8, v2, s[12:15], s24 offen
    s_mov_b64 exec, -1
    s_cmp_lt_u32 s6, 63
    s_cbranch_scc0 a_nox
    buffer_load_dwordx2 v[40:41], v39, s[16:19], s25 offen offset:0
    buffer_load_dwordx4 v[42:45], v3, s[16:19], s25 offen offset:512
    buffer_load_dwordx4 v[46:49], v3, s[16:19], s25 offen offset:1536
    buffer_load_dwordx4 v[50:53], v3, s[16:19], s25 offen offset:2560
    buffer_load_dwordx2 v[54:55], v39, s[16:19], s25 offen offset:3584
    s_add_u32 s29, s25, 4096
    buffer_load_dwordx4 v[56:59], v3, s[16:19], s29 offen
    s_add_u32 s29, s25, 5120
    buffer_load_dwordx4 v[60:63], v3, s[16:19], s29 offen
    s_add_u32 s29, s25, 6144
    buffer_load_dwordx4 v[64:67], v3, s[16:19], s29 offen
a_nox:
    s_add_u32 s6, s6, 1
    s_add_u32 s7, s7, 7168
    s_add_u32 s24, s24, 10240
    s_cmp_lt_u32 s6, 64
    s_cbranch_scc1 a_loop
    s_branch chain_end
chain_v:
    s_sub_u32 s4, s4, 16
    s_load_dwordx2 s[16:17], s[0:1], 152
    s_waitcnt lgkmcnt(0)
    s_add_u32 s16, s16, 64347136
    s_addc_u32 s17, s17, 0
    s_and_b32 s17, s17, 0xffff
    s_mov_b32 s18, 33554432
    s_mov_b32 s19, 0x20000
    s_load_dwordx2 s[20:21], s[0:1], 152
    s_waitcnt lgkmcnt(0)
    s_add_u32 s20, s20, 44948480
    s_addc_u32 s21, s21, 0
    s_and_b32 s21, s21, 0xffff
    s_mov_b32 s22, 16777216
    s_mov_b32 s23, 0x20000
    s_mul_i32 s29, s5, 5632
    s_add_u32 s29, s29, 8192
    v_mul_u32_u24 v37, 48, v2
    v_lshl_add_u32 v37, v3, 3, v37
    v_add_u32 v37, s29, v37
    v_mul_u32_u24 v38, 28, v3
    v_add_u32 v38, v38, v2
    v_mul_u32_u24 v38, 48, v38
    v_add_u32 v38, s29, v38
    s_lshl_b32 s29, s4, 4
    s_lshl_b32 s28, s5, 2
    s_add_u32 s29, s29, s28
    s_lshl_b32 s29, s29, 11
    v_lshlrev_b32 v39, 4, v1
    v_add_u32 v39, s29, v39
    s_lshl_b32 s29, s4, 2
    s_add_u32 s29, s29, s5
    s_lshl_b32 s29, s29, 12
    v_lshlrev_b32 v109, 4, v1
    v_add_u32 v109, s29, v109
    s_mul_i32 s29, s5, 2560
    v_and_b32 v110, 7, v2
    v_mul_u32_u24 v110, 80, v110
    v_add_u32 v110, s29, v110
    v_lshl_add_u32 v104, v3, 4, v110
    v_mul_u32_u24 v105, 640, v3
    v_add_u32 v105, v105, v110
    v_add_u32 v105, 64, v105
    s_lshl_b32 s29, s5, 11
    s_add_u32 s29, s29, 32768
    v_lshlrev_b32 v106, 4, v1
    v_add_u32 v106, s29, v106
    v_and_b32 v110, 7, v1
    v_lshrrev_b32 v111, 3, v1
    v_lshrrev_b32 v112, 2, v111
    v_lshlrev_b32 v107, 10, v112
    v_and_b32 v112, 3, v111
    v_lshl_add_u32 v107, v112, 8, v107
    v_lshl_add_u32 v107, v110, 4, v107
    v_add_u32 v107, 32768, v107
    s_mul_i32 s29, s4, 56
    v_mul_u32_u24 v108, 896, v110
    v_lshl_add_u32 v108, v111, 3, v108
    v_add_u32 v108, s29, v108
    v_add_u32 v108, 7168, v108
    v_cmp_gt_u32 vcc, 7, v111
    s_nop 4
    s_mov_b64 s[30:31], vcc
    v_and_b32 v110, 8, v1
    v_cmp_eq_u32 vcc, 0, v110
    s_nop 4
    s_mov_b64 s[32:33], vcc
    s_mov_b32 s25, 0
    s_mov_b32 s34, 0
    s_mov_b32 s36, 1581056
    s_load_dwordx2 s[42:43], s[0:1], 144
    s_waitcnt lgkmcnt(0)
    s_mov_b32 s38, 0
v_loop:
    s_lshr_b32 s29, s6, 2
    s_cmp_lt_u32 s29, s38
    s_cbranch_scc1 v_xok
    v_and_b32 v110, 15, v1
    v_mov_b32 v112, 16
    v_mov_b32 v113, 64
    v_cmp_gt_u32 vcc, 3, v110
    v_lshlrev_b32 v110, 2, v110
    v_add_u32 v110, 128, v110
    v_cndmask_b32 v112, v112, v113, vcc
    s_mov_b32 s35, 400000
v_xm:
    global_load_dword v111, v110, s[42:43] sc1
    s_waitcnt vmcnt(0)
    v_and_b32 v111, 0xff, v111
    v_cmp_lt_u32 vcc, v111, v112
    s_nop 4
    s_ff1_i32_b32 s38, vcc_lo
    s_cmp_lt_i32 s38, 0
    s_cselect_b32 s38, 16, s38
    s_cmp_lt_u32 s29, s38
    s_cbranch_scc1 v_xok
    s_sub_u32 s35, s35, 1
    s_cmp_lg_u32 s35, 0
    s_cbranch_scc1 v_xm
    s_branch chain_end
v_xok:
    s_mov_b32 s35, 400000
    s_mov_b64 exec, s[26:27]
gm_v:
    buffer_load_dwordx4 v[40:43], v4, s[12:15], s7 offen sc1
    buffer_load_dwordx4 v[44:47], v4, s[12:15], s7 offen offset:3584 sc1
    s_waitcnt vmcnt(0)
    v_max3_u32 v119, v40, v41, v42
    v_max3_u32 v118, v43, v44, v45
    v_max3_u32 v119, v119, v46, v47
    v_max_u32 v119, v119, v118
    v_cmp_eq_u32 vcc, -1, v119
    s_cbranch_vccz gd_v
    s_sub_u32 s35, s35, 1
    s_cmp_lg_u32 s35, 0
    s_cbranch_scc1 gm_v
    s_branch chain_end
gd_v:
    ds_write_b128 v5, v[40:43]
    ds_write_b128 v5, v[44:47] offset:3648
    s_mov_b64 exec, -1
    s_waitcnt lgkmcnt(0)
    s_barrier
    s_and_b32 s29, s6, 15
    s_cmp_lg_u32 s29, s4
    s_cbranch_scc1 v_nopub
    s_cmp_eq_u32 s6, 0
    s_cbranch_scc1 v_nopub
    s_mov_b64 exec, s[26:27]
    s_waitcnt vmcnt(0)
    buffer_store_dwordx4 v[40:43], v4, s[12:15], s36 offen sc1
    buffer_store_dwordx4 v[44:47], v4, s[12:15], s36 offen offset:3584 sc1
    s_mov_b64 exec, -1
v_nopub:
    ds_read_b128 v[8:11], v6 offset:0
    ds_read_b128 v[12:15], v6 offset:128
    ds_read_b128 v[16:19], v6 offset:256
    ds_read_b128 v[20:23], v6 offset:384
    ds_read_b128 v[24:27], v6 offset:512
    ds_read_b128 v[28:31], v6 offset:640
    ds_read_b128 v[32:35], v6 offset:768
    s_add_u32 s29, s25, 4096
    buffer_load_dwordx4 v[40:43], v39, s[16:19], s25 offen offset:0 sc1
    buffer_load_dwordx4 v[44:47], v39, s[16:19], s25 offen offset:1024 sc1
    v_mov_b32 v88, 0
    v_mov_b32 v89, 0
    v_mov_b32 v90, 0
    v_mov_b32 v91, 0
    v_mov_b32 v92, 0
    v_mov_b32 v93, 0
    v_mov_b32 v94, 0
    v_mov_b32 v95, 0
    s_waitcnt lgkmcnt(6)
    v_smfmac_f32_16x16x64_bf16 v[88:91], v[8:11], a[0:7], v36
    s_waitcnt lgkmcnt(5)
    v_smfmac_f32_16x16x64_bf16 v[88:91], v[12:15], a[8:15], v36
    buffer_load_dwordx4 v[48:51], v39, s[16:19], s25 offen offset:2048 sc1
    s_waitcnt lgkmcnt(4)
    v_smfmac_f32_16x16x64_bf16 v[88:91], v[16:19], a[16:23], v36
    s_waitcnt lgkmcnt(3)
    v_smfmac_f32_16x16x64_bf16 v[88:91], v[20:23], a[24:31], v36
    s_waitcnt lgkmcnt(2)
    v_smfmac_f32_16x16x64_bf16 v[88:91], v[24:27], a[32:39], v36
    buffer_load_dwordx4 v[52:55], v39, s[16:19], s25 offen offset:3072 sc1
    s_waitcnt lgkmcnt(1)
    v_smfmac_f32_16x16x64_bf16 v[88:91], v[28:31], a[40:47], v36
    s_waitcnt lgkmcnt(0)
    v_smfmac_f32_16x16x64_bf16 v[88:91], v[32:35], a[48:55], v36
    v_smfmac_f32_16x16x64_bf16 v[92:95], v[8:11], a[56:63], v36
    buffer_load_dwordx4 v[56:59], v39, s[16:19], s29 offen offset:0 sc1
    v_smfmac_f32_16x16x64_bf16 v[92:95], v[12:15], a[64:71], v36
    v_smfmac_f32_16x16x64_bf16 v[92:95], v[16:19], a[72:79], v36
    v_cvt_pk_bf16_f32 v118, v88, v89
    v_cvt_pk_bf16_f32 v119, v90, v91
    ds_write_b64 v37, v[118:119] offset:0
    v_smfmac_f32_16x16x64_bf16 v[92:95], v[20:23], a[80:87], v36
    buffer_load_dwordx4 v[60:63], v39, s[16:19], s29 offen offset:1024 sc1
    v_smfmac_f32_16x16x64_bf16 v[92:95], v[24:27], a[88:95], v36
    v_mov_b64 v[88:89], 0
    v_mov_b64 v[90:91], 0
    v_smfmac_f32_16x16x64_bf16 v[92:95], v[28:31], a[96:103], v36
    v_smfmac_f32_16x16x64_bf16 v[92:95], v[32:35], a[104:111], v36
    buffer_load_dwordx4 v[64:67], v39, s[16:19], s29 offen offset:2048 sc1
    v_smfmac_f32_16x16x64_bf16 v[88:91], v[8:11], a[112:119], v36
    v_smfmac_f32_16x16x64_bf16 v[88:91], v[12:15], a[120:127], v36
    v_smfmac_f32_16x16x64_bf16 v[88:91], v[16:19], a[128:135], v36
    buffer_load_dwordx4 v[68:71], v39, s[16:19], s29 offen offset:3072 sc1
    v_cvt_pk_bf16_f32 v118, v92, v93
    v_cvt_pk_bf16_f32 v119, v94, v95
    ds_write_b64 v37, v[118:119] offset:768
    v_smfmac_f32_16x16x64_bf16 v[88:91], v[20:23], a[136:143], v36
    v_smfmac_f32_16x16x64_bf16 v[88:91], v[24:27], a[144:151], v36
    v_mov_b64 v[92:93], 0
    v_mov_b64 v[94:95], 0
    v_smfmac_f32_16x16x64_bf16 v[88:91], v[28:31], a[152:159], v36
    buffer_store_dwordx4 v[72:75], v109, s[20:23], s34 offen offset:0 sc1
    v_smfmac_f32_16x16x64_bf16 v[88:91], v[32:35], a[160:167], v36
    v_smfmac_f32_16x16x64_bf16 v[92:95], v[8:11], a[168:175], v36
    v_smfmac_f32_16x16x64_bf16 v[92:95], v[12:15], a[176:183], v36
    buffer_store_dwordx4 v[76:79], v109, s[20:23], s34 offen offset:1024 sc1
    v_smfmac_f32_16x16x64_bf16 v[92:95], v[16:19], a[184:191], v36
    v_cvt_pk_bf16_f32 v118, v88, v89
    v_cvt_pk_bf16_f32 v119, v90, v91
    ds_write_b64 v37, v[118:119] offset:1536
    v_smfmac_f32_16x16x64_bf16 v[92:95], v[20:23], a[192:199], v36
    v_smfmac_f32_16x16x64_bf16 v[92:95], v[24:27], a[200:207], v36
    buffer_store_dwordx4 v[80:83], v109, s[20:23], s34 offen offset:2048 sc1
    v_mov_b64 v[88:89], 0
    v_mov_b64 v[90:91], 0
    v_smfmac_f32_16x16x64_bf16 v[92:95], v[28:31], a[208:215], v36
    v_smfmac_f32_16x16x64_bf16 v[92:95], v[32:35], a[216:223], v36
    v_smfmac_f32_16x16x64_bf16 v[88:91], v[8:11], a[224:231], v36
    buffer_store_dwordx4 v[84:87], v109, s[20:23], s34 offen offset:3072 sc1
    v_smfmac_f32_16x16x64_bf16 v[88:91], v[12:15], a[232:239], v36
    v_smfmac_f32_16x16x64_bf16 v[88:91], v[16:19], a[240:247], v36
    v_cvt_pk_bf16_f32 v118, v92, v93
    v_cvt_pk_bf16_f32 v119, v94, v95
    ds_write_b64 v37, v[118:119] offset:2304
    v_smfmac_f32_16x16x64_bf16 v[88:91], v[20:23], a[248:255], v36
    v_smfmac_f32_16x16x64_bf16 v[88:91], v[24:27], v[120:127], v36
    v_mov_b64 v[92:93], 0
    v_mov_b64 v[94:95], 0
    v_smfmac_f32_16x16x64_bf16 v[88:91], v[28:31], v[128:135], v36
    v_smfmac_f32_16x16x64_bf16 v[88:91], v[32:35], v[136:143], v36
    v_smfmac_f32_16x16x64_bf16 v[92:95], v[8:11], v[144:151], v36
    v_smfmac_f32_16x16x64_bf16 v[92:95], v[12:15], v[152:159], v36
    v_smfmac_f32_16x16x64_bf16 v[92:95], v[16:19], v[160:167], v36
    v_cvt_pk_bf16_f32 v118, v88, v89
    v_cvt_pk_bf16_f32 v119, v90, v91
    ds_write_b64 v37, v[118:119] offset:3072
    v_smfmac_f32_16x16x64_bf16 v[92:95], v[20:23], v[168:175], v36
    v_smfmac_f32_16x16x64_bf16 v[92:95], v[24:27], v[176:183], v36
    v_mov_b64 v[88:89], 0
    v_mov_b64 v[90:91], 0
    v_smfmac_f32_16x16x64_bf16 v[92:95], v[28:31], v[184:191], v36
    v_smfmac_f32_16x16x64_bf16 v[92:95], v[32:35], v[192:199], v36
    v_smfmac_f32_16x16x64_bf16 v[88:91], v[8:11], v[200:207], v36
    v_smfmac_f32_16x16x64_bf16 v[88:91], v[12:15], v[208:215], v36
    v_smfmac_f32_16x16x64_bf16 v[88:91], v[16:19], v[216:223], v36
    v_cvt_pk_bf16_f32 v118, v92, v93
    v_cvt_pk_bf16_f32 v119, v94, v95
    ds_write_b64 v37, v[118:119] offset:3840
    v_smfmac_f32_16x16x64_bf16 v[88:91], v[20:23], v[224:231], v36
    v_smfmac_f32_16x16x64_bf16 v[88:91], v[24:27], v[232:239], v36
    v_mov_b64 v[92:93], 0
    v_mov_b64 v[94:95], 0
    v_smfmac_f32_16x16x64_bf16 v[88:91], v[28:31], v[240:247], v36
    v_smfmac_f32_16x16x64_bf16 v[88:91], v[32:35], v[248:255], v36
    s_nop 7
    v_cvt_pk_bf16_f32 v118, v88, v89
    v_cvt_pk_bf16_f32 v119, v90, v91
    ds_write_b64 v37, v[118:119] offset:4608
    ds_read_b128 v[72:75], v38 offset:0
    ds_read_b128 v[76:79], v38 offset:16
    ds_read_b128 v[80:83], v38 offset:768
    ds_read_b128 v[84:87], v38 offset:784
    s_waitcnt lgkmcnt(0)
    s_mov_b32 s35, 400000
    s_mov_b64 exec, s[32:33]
v_pp:
    buffer_load_dwordx4 v[8:11], v104, s[12:15], s24 offen offset:0 sc1
    buffer_load_dwordx4 v[12:15], v104, s[12:15], s24 offen offset:640 sc1
    buffer_load_dwordx4 v[16:19], v104, s[12:15], s24 offen offset:1280 sc1
    buffer_load_dwordx4 v[20:23], v104, s[12:15], s24 offen offset:1920 sc1
    buffer_load_dwordx4 v[24:27], v105, s[12:15], s24 offen sc1
    s_waitcnt vmcnt(0)
    v_max3_u32 v110, v8, v9, v10
    v_max3_u32 v111, v11, v12, v13
    v_max3_u32 v112, v14, v15, v16
    v_max3_u32 v113, v17, v18, v19
    v_max3_u32 v114, v20, v21, v22
    v_max3_u32 v115, v23, v24, v25
    v_max3_u32 v110, v110, v111, v112
    v_max3_u32 v113, v113, v114, v115
    v_max3_u32 v110, v110, v26, v27
    v_max_u32 v110, v110, v113
    v_cmp_eq_u32 vcc, -1, v110
    s_cbranch_vccz v_pd
    s_sub_u32 s35, s35, 1
    s_cmp_lg_u32 s35, 0
    s_cbranch_scc1 v_pp
    s_branch chain_end
v_pd:
    s_mov_b64 exec, -1
    s_nop 3
    v_mfma_f32_16x16x32_bf16 v[96:99], v[40:43], v[8:11], 0
    v_mfma_f32_16x16x32_bf16 v[100:103], v[44:47], v[8:11], 0
    v_mfma_f32_16x16x32_bf16 v[96:99], v[48:51], v[12:15], v[96:99]
    v_mfma_f32_16x16x32_bf16 v[100:103], v[52:55], v[12:15], v[100:103]
    v_mfma_f32_16x16x32_bf16 v[96:99], v[56:59], v[16:19], v[96:99]
    v_mfma_f32_16x16x32_bf16 v[100:103], v[60:63], v[16:19], v[100:103]
    v_mfma_f32_16x16x32_bf16 v[96:99], v[64:67], v[20:23], v[96:99]
    v_mfma_f32_16x16x32_bf16 v[100:103], v[68:71], v[20:23], v[100:103]
    v_mfma_f32_16x16x32_bf16 v[96:99], v[72:75], v[24:27], v[96:99]
    v_mfma_f32_16x16x32_bf16 v[100:103], v[80:83], v[24:27], v[100:103]
    v_mfma_f32_16x16x32_bf16 v[96:99], v[76:79], v[24:27], v[96:99]
    v_mfma_f32_16x16x32_bf16 v[100:103], v[84:87], v[24:27], v[100:103]
    s_nop 7
    ds_write_b128 v106, v[96:99]
    ds_write_b128 v106, v[100:103] offset:1024
    s_waitcnt lgkmcnt(0)
    s_barrier
    s_cmp_lg_u32 s5, 0
    s_cbranch_scc1 v_next
    s_mov_b64 exec, s[30:31]
    ds_read_b128 v[8:11], v107 offset:0
    ds_read_b128 v[12:15], v107 offset:2048
    ds_read_b128 v[16:19], v107 offset:4096
    ds_read_b128 v[20:23], v107 offset:6144
    s_waitcnt lgkmcnt(2)
    v_pk_add_f32 v[8:9], v[8:9], v[12:13]
    v_pk_add_f32 v[10:11], v[10:11], v[14:15]
    s_waitcnt lgkmcnt(0)
    v_pk_add_f32 v[16:17], v[16:17], v[20:21]
    v_pk_add_f32 v[18:19], v[18:19], v[22:23]
    v_pk_add_f32 v[8:9], v[8:9], v[16:17]
    v_pk_add_f32 v[10:11], v[10:11], v[18:19]
    v_cvt_pk_bf16_f32 v8, v8, v9
    v_cvt_pk_bf16_f32 v9, v10, v11
    buffer_store_dwordx2 v[8:9], v108, s[12:15], s7 offen
    s_mov_b64 exec, -1
v_next:
    s_add_u32 s6, s6, 1
    s_add_u32 s7, s7, 7168
    s_add_u32 s24, s24, 10240
    s_add_u32 s25, s25, 524288
    s_sub_u32 s36, s36, 7168
    s_add_u32 s34, s34, 262144
    s_cmp_eq_u32 s6, 1
    s_cselect_b32 s34, 0, s34
    s_cmp_lt_u32 s6, 64
    s_cbranch_scc1 v_loop
    buffer_store_dwordx4 v[72:75], v109, s[20:23], s34 offen offset:0 sc1
    buffer_store_dwordx4 v[76:79], v109, s[20:23], s34 offen offset:1024 sc1
    buffer_store_dwordx4 v[80:83], v109, s[20:23], s34 offen offset:2048 sc1
    buffer_store_dwordx4 v[84:87], v109, s[20:23], s34 offen offset:3072 sc1
    s_waitcnt vmcnt(0)
    s_barrier
    v_cmp_eq_u32 vcc, 0, v0
    s_and_saveexec_b64 s[30:31], vcc
    v_mov_b32 v8, 72
    v_mov_b32 v9, 1
    global_atomic_add v8, v9, s[42:43] sc1
    s_mov_b64 exec, s[30:31]
    s_branch chain_end
wk_entry:
    s_load_dwordx2 s[42:43], s[0:1], 144
    s_waitcnt lgkmcnt(0)
    s_mov_b32 s41, -1
wk_loop:
    v_and_b32 v1, 63, v0
    v_and_b32 v2, 15, v0
    v_lshrrev_b32 v3, 4, v1
    v_lshrrev_b32 v4, 6, v0
    s_nop 0
    v_readfirstlane_b32 s3, v4
    s_waitcnt vmcnt(0) lgkmcnt(0)
    s_barrier
    v_cmp_eq_u32 vcc, 0, v0
    s_and_saveexec_b64 s[12:13], vcc
    s_cbranch_execz wk_t
    s_cmp_lt_i32 s41, 0
    s_cbranch_scc1 wk_nc
    v_mov_b32 v4, s41
    v_mov_b32 v5, s53
    global_atomic_add v4, v5, s[42:43] sc1
wk_nc:
    v_mov_b32 v5, 1
    v_mov_b32 v4, 68
    global_atomic_add v6, v4, v5, s[42:43] sc0 sc1
    s_waitcnt vmcnt(0)
    v_mov_b32 v4, 0
    ds_write_b32 v4, v6
    s_waitcnt lgkmcnt(0)
wk_t:
    s_mov_b64 exec, s[12:13]
    s_barrier
    v_mov_b32 v4, 0
    ds_read_b32 v5, v4
    s_waitcnt lgkmcnt(0)
    s_nop 0
    v_readfirstlane_b32 s40, v5
    s_barrier
    s_nop 3
    s_cmp_lt_u32 s40, 192
    s_cbranch_scc0 wk_n0
    s_bfe_u32 s54, s40, 0x20004
    s_lshl_b32 s54, s54, 2
    s_lshr_b32 s41, s40, 6
    s_and_b32 s40, s40, 15
    s_lshl_b32 s20, s41, 4
    s_add_u32 s40, s40, s20
    s_lshl_b32 s41, s41, 2
    s_add_u32 s41, s41, 128
    s_mov_b32 s53, 1
    s_and_b32 s4, s40, 15
    s_lshr_b32 s5, s40, 4
    s_lshl_b32 s5, s5, 2
    s_add_u32 s5, s5, s3
    s_load_dwordx2 s[8:9], s[0:1], 152
    s_waitcnt lgkmcnt(0)
    s_add_u32 s8, s8, 28442624
    s_addc_u32 s9, s9, 0
    s_and_b32 s9, s9, 0xffff
    s_mov_b32 s10, 1835008
    s_mov_b32 s11, 0x20000
    s_mul_i32 s20, s5, 28672
    v_lshlrev_b32 v4, 4, v1
    v_add_u32 v4, s20, v4
    s_mov_b32 s20, 0
    buffer_load_dwordx4 v[16:19], v4, s[8:11], s20 offen
    s_mov_b32 s20, 1024
    buffer_load_dwordx4 v[20:23], v4, s[8:11], s20 offen
    s_mov_b32 s20, 2048
    buffer_load_dwordx4 v[24:27], v4, s[8:11], s20 offen
    s_mov_b32 s20, 3072
    buffer_load_dwordx4 v[28:31], v4, s[8:11], s20 offen
    s_mov_b32 s20, 4096
    buffer_load_dwordx4 v[32:35], v4, s[8:11], s20 offen
    s_mov_b32 s20, 5120
    buffer_load_dwordx4 v[36:39], v4, s[8:11], s20 offen
    s_mov_b32 s20, 6144
    buffer_load_dwordx4 v[40:43], v4, s[8:11], s20 offen
    s_mov_b32 s20, 7168
    buffer_load_dwordx4 v[44:47], v4, s[8:11], s20 offen
    s_mov_b32 s20, 8192
    buffer_load_dwordx4 v[48:51], v4, s[8:11], s20 offen
    s_mov_b32 s20, 9216
    buffer_load_dwordx4 v[52:55], v4, s[8:11], s20 offen
    s_mov_b32 s20, 10240
    buffer_load_dwordx4 v[56:59], v4, s[8:11], s20 offen
    s_mov_b32 s20, 11264
    buffer_load_dwordx4 v[60:63], v4, s[8:11], s20 offen
    s_mov_b32 s20, 12288
    buffer_load_dwordx4 v[64:67], v4, s[8:11], s20 offen
    s_mov_b32 s20, 13312
    buffer_load_dwordx4 v[68:71], v4, s[8:11], s20 offen
    s_mov_b32 s20, 14336
    buffer_load_dwordx4 v[72:75], v4, s[8:11], s20 offen
    s_mov_b32 s20, 15360
    buffer_load_dwordx4 v[76:79], v4, s[8:11], s20 offen
    s_mov_b32 s20, 16384
    buffer_load_dwordx4 v[80:83], v4, s[8:11], s20 offen
    s_mov_b32 s20, 17408
    buffer_load_dwordx4 v[84:87], v4, s[8:11], s20 offen
    s_mov_b32 s20, 18432
    buffer_load_dwordx4 v[88:91], v4, s[8:11], s20 offen
    s_mov_b32 s20, 19456
    buffer_load_dwordx4 v[92:95], v4, s[8:11], s20 offen
    s_mov_b32 s20, 20480
    buffer_load_dwordx4 v[96:99], v4, s[8:11], s20 offen
    s_mov_b32 s20, 21504
    buffer_load_dwordx4 v[100:103], v4, s[8:11], s20 offen
    s_mov_b32 s20, 22528
    buffer_load_dwordx4 v[104:107], v4, s[8:11], s20 offen
    s_mov_b32 s20, 23552
    buffer_load_dwordx4 v[108:111], v4, s[8:11], s20 offen
    s_mov_b32 s20, 24576
    buffer_load_dwordx4 v[112:115], v4, s[8:11], s20 offen
    s_mov_b32 s20, 25600
    buffer_load_dwordx4 v[116:119], v4, s[8:11], s20 offen
    s_mov_b32 s20, 26624
    buffer_load_dwordx4 v[120:123], v4, s[8:11], s20 offen
    s_mov_b32 s20, 27648
    buffer_load_dwordx4 v[124:127], v4, s[8:11], s20 offen
    s_load_dwordx2 s[12:13], s[0:1], 152
    s_waitcnt lgkmcnt(0)
    s_add_u32 s12, s12, 19267584
    s_addc_u32 s13, s13, 0
    s_and_b32 s13, s13, 0xffff
    s_mov_b32 s14, 7340032
    s_mov_b32 s15, 0x20000
    s_load_dwordx2 s[16:17], s[0:1], 152
    s_waitcnt lgkmcnt(0)
    s_add_u32 s16, s16, 64347136
    s_addc_u32 s17, s17, 0
    s_and_b32 s17, s17, 0xffff
    s_mov_b32 s18, 33554432
    s_mov_b32 s19, 0x20000
    s_mul_i32 s29, s4, 458752
    s_mul_i32 s20, s54, 28672
    s_add_u32 s29, s29, s20
    s_lshl_b32 s20, s5, 8
    s_add_u32 s20, s20, s4
    s_lshl_b32 s20, s20, 11
    v_lshrrev_b32 v7, 1, v3
    v_lshlrev_b32 v7, 8, v7
    v_lshlrev_b32 v8, 4, v2
    v_add_u32 v7, v7, v8
    v_and_b32 v8, 1, v3
    v_lshlrev_b32 v8, 3, v8
    v_add_u32 v7, v7, v8
    v_add_u32 v7, s20, v7
    v_lshlrev_b32 v6, 4, v1
    v_lshlrev_b32 v9, 4, v1
    s_mul_i32 s30, s3, 7168
    s_mov_b32 s6, 0
    s_mov_b32 s7, 0
    s_mov_b32 s26, 1
    s_mov_b32 s27, 28672
    s_mul_i32 s23, s6, 28672
    s_add_u32 s23, s23, s29
    s_add_u32 s23, s23, s30
    s_add_u32 s24, s7, s30
    s_add_u32 m0, s24, 0
    s_add_u32 s25, s23, 0
    buffer_load_dwordx4 v6, s[12:15], s25 offen lds
    s_add_u32 m0, s24, 1024
    s_add_u32 s25, s23, 1024
    buffer_load_dwordx4 v6, s[12:15], s25 offen lds
    s_add_u32 m0, s24, 2048
    s_add_u32 s25, s23, 2048
    buffer_load_dwordx4 v6, s[12:15], s25 offen lds
    s_add_u32 m0, s24, 3072
    s_add_u32 s25, s23, 3072
    buffer_load_dwordx4 v6, s[12:15], s25 offen lds
    s_add_u32 m0, s24, 4096
    s_add_u32 s25, s23, 4096
    buffer_load_dwordx4 v6, s[12:15], s25 offen lds
    s_add_u32 m0, s24, 5120
    s_add_u32 s25, s23, 5120
    buffer_load_dwordx4 v6, s[12:15], s25 offen lds
    s_add_u32 m0, s24, 6144
    s_add_u32 s25, s23, 6144
    buffer_load_dwordx4 v6, s[12:15], s25 offen lds
    s_mul_i32 s23, s26, 28672
    s_add_u32 s23, s23, s29
    s_add_u32 s23, s23, s30
    s_add_u32 s24, s27, s30
    s_add_u32 m0, s24, 0
    s_add_u32 s25, s23, 0
    buffer_load_dwordx4 v6, s[12:15], s25 offen lds
    s_add_u32 m0, s24, 1024
    s_add_u32 s25, s23, 1024
    buffer_load_dwordx4 v6, s[12:15], s25 offen lds
    s_add_u32 m0, s24, 2048
    s_add_u32 s25, s23, 2048
    buffer_load_dwordx4 v6, s[12:15], s25 offen lds
    s_add_u32 m0, s24, 3072
    s_add_u32 s25, s23, 3072
    buffer_load_dwordx4 v6, s[12:15], s25 offen lds
    s_add_u32 m0, s24, 4096
    s_add_u32 s25, s23, 4096
    buffer_load_dwordx4 v6, s[12:15], s25 offen lds
    s_add_u32 m0, s24, 5120
    s_add_u32 s25, s23, 5120
    buffer_load_dwordx4 v6, s[12:15], s25 offen lds
    s_add_u32 m0, s24, 6144
    s_add_u32 s25, s23, 6144
    buffer_load_dwordx4 v6, s[12:15], s25 offen lds
    s_waitcnt vmcnt(7)
wq_loop:
    s_barrier
    s_add_u32 s27, s7, 57344
    s_cmp_ge_u32 s27, 86016
    s_cselect_b32 s28, 86016, 0
    s_sub_u32 s27, s27, s28
    s_add_u32 s26, s6, 2
    s_cmp_lt_u32 s26, 4
    s_cbranch_scc0 wq_nodma
    s_mul_i32 s23, s26, 28672
    s_add_u32 s23, s23, s29
    s_add_u32 s23, s23, s30
    s_add_u32 s24, s27, s30
    s_add_u32 m0, s24, 0
    s_add_u32 s25, s23, 0
    buffer_load_dwordx4 v6, s[12:15], s25 offen lds
    s_add_u32 m0, s24, 1024
    s_add_u32 s25, s23, 1024
    buffer_load_dwordx4 v6, s[12:15], s25 offen lds
    s_add_u32 m0, s24, 2048
    s_add_u32 s25, s23, 2048
    buffer_load_dwordx4 v6, s[12:15], s25 offen lds
    s_add_u32 m0, s24, 3072
    s_add_u32 s25, s23, 3072
    buffer_load_dwordx4 v6, s[12:15], s25 offen lds
    s_add_u32 m0, s24, 4096
    s_add_u32 s25, s23, 4096
    buffer_load_dwordx4 v6, s[12:15], s25 offen lds
    s_add_u32 m0, s24, 5120
    s_add_u32 s25, s23, 5120
    buffer_load_dwordx4 v6, s[12:15], s25 offen lds
    s_add_u32 m0, s24, 6144
    s_add_u32 s25, s23, 6144
    buffer_load_dwordx4 v6, s[12:15], s25 offen lds
wq_nodma:
    v_add_u32 v10, s7, v9
    ds_read_b128 v[128:131], v10 offset:0
    ds_read_b128 v[132:135], v10 offset:1024
    ds_read_b128 v[136:139], v10 offset:2048
    ds_read_b128 v[140:143], v10 offset:3072
    ds_read_b128 v[144:147], v10 offset:4096
    ds_read_b128 v[148:151], v10 offset:5120
    ds_read_b128 v[152:155], v10 offset:6144
    ds_read_b128 v[156:159], v10 offset:7168
    ds_read_b128 v[160:163], v10 offset:8192
    ds_read_b128 v[164:167], v10 offset:9216
    ds_read_b128 v[168:171], v10 offset:10240
    ds_read_b128 v[172:175], v10 offset:11264
    ds_read_b128 v[176:179], v10 offset:12288
    ds_read_b128 v[180:183], v10 offset:13312
    ds_read_b128 v[184:187], v10 offset:14336
    s_waitcnt lgkmcnt(14)
    v_mfma_f32_16x16x32_bf16 v[240:243], v[16:19], v[128:131], 0
    v_mfma_f32_16x16x32_bf16 v[244:247], v[72:75], v[128:131], 0
    ds_read_b128 v[188:191], v10 offset:15360
    s_waitcnt lgkmcnt(14)
    v_mfma_f32_16x16x32_bf16 v[240:243], v[20:23], v[132:135], v[240:243]
    v_mfma_f32_16x16x32_bf16 v[244:247], v[76:79], v[132:135], v[244:247]
    ds_read_b128 v[192:195], v10 offset:16384
    s_waitcnt lgkmcnt(14)
    v_mfma_f32_16x16x32_bf16 v[240:243], v[24:27], v[136:139], v[240:243]
    v_mfma_f32_16x16x32_bf16 v[244:247], v[80:83], v[136:139], v[244:247]
    ds_read_b128 v[196:199], v10 offset:17408
    s_waitcnt lgkmcnt(14)
    v_mfma_f32_16x16x32_bf16 v[240:243], v[28:31], v[140:143], v[240:243]
    v_mfma_f32_16x16x32_bf16 v[244:247], v[84:87], v[140:143], v[244:247]
    ds_read_b128 v[200:203], v10 offset:18432
    s_waitcnt lgkmcnt(14)
    v_mfma_f32_16x16x32_bf16 v[240:243], v[32:35], v[144:147], v[240:243]
    v_mfma_f32_16x16x32_bf16 v[244:247], v[88:91], v[144:147], v[244:247]
    ds_read_b128 v[204:207], v10 offset:19456
    s_waitcnt lgkmcnt(14)
    v_mfma_f32_16x16x32_bf16 v[240:243], v[36:39], v[148:151], v[240:243]
    v_mfma_f32_16x16x32_bf16 v[244:247], v[92:95], v[148:151], v[244:247]
    ds_read_b128 v[208:211], v10 offset:20480
    s_waitcnt lgkmcnt(14)
    v_mfma_f32_16x16x32_bf16 v[240:243], v[40:43], v[152:155], v[240:243]
    v_mfma_f32_16x16x32_bf16 v[244:247], v[96:99], v[152:155], v[244:247]
    ds_read_b128 v[212:215], v10 offset:21504
    s_waitcnt lgkmcnt(14)
    v_mfma_f32_16x16x32_bf16 v[240:243], v[44:47], v[156:159], v[240:243]
    v_mfma_f32_16x16x32_bf16 v[244:247], v[100:103], v[156:159], v[244:247]
    ds_read_b128 v[216:219], v10 offset:22528
    s_waitcnt lgkmcnt(14)
    v_mfma_f32_16x16x32_bf16 v[240:243], v[48:51], v[160:163], v[240:243]
    v_mfma_f32_16x16x32_bf16 v[244:247], v[104:107], v[160:163], v[244:247]
    ds_read_b128 v[220:223], v10 offset:23552
    s_waitcnt lgkmcnt(14)
    v_mfma_f32_16x16x32_bf16 v[240:243], v[52:55], v[164:167], v[240:243]
    v_mfma_f32_16x16x32_bf16 v[244:247], v[108:111], v[164:167], v[244:247]
    ds_read_b128 v[224:227], v10 offset:24576
    s_waitcnt lgkmcnt(14)
    v_mfma_f32_16x16x32_bf16 v[240:243], v[56:59], v[168:171], v[240:243]
    v_mfma_f32_16x16x32_bf16 v[244:247], v[112:115], v[168:171], v[244:247]
    ds_read_b128 v[228:231], v10 offset:25600
    s_waitcnt lgkmcnt(14)
    v_mfma_f32_16x16x32_bf16 v[240:243], v[60:63], v[172:175], v[240:243]
    v_mfma_f32_16x16x32_bf16 v[244:247], v[116:119], v[172:175], v[244:247]
    ds_read_b128 v[232:235], v10 offset:26624
    s_waitcnt lgkmcnt(14)
    v_mfma_f32_16x16x32_bf16 v[240:243], v[64:67], v[176:179], v[240:243]
    v_mfma_f32_16x16x32_bf16 v[244:247], v[120:123], v[176:179], v[244:247]
    ds_read_b128 v[236:239], v10 offset:27648
    s_waitcnt lgkmcnt(14)
    v_mfma_f32_16x16x32_bf16 v[240:243], v[68:71], v[180:183], v[240:243]
    v_mfma_f32_16x16x32_bf16 v[244:247], v[124:127], v[180:183], v[244:247]
    s_waitcnt lgkmcnt(13)
    v_mfma_f32_16x16x32_bf16 v[248:251], v[16:19], v[184:187], 0
    v_mfma_f32_16x16x32_bf16 v[252:255], v[72:75], v[184:187], 0
    s_waitcnt lgkmcnt(12)
    v_mfma_f32_16x16x32_bf16 v[248:251], v[20:23], v[188:191], v[248:251]
    v_mfma_f32_16x16x32_bf16 v[252:255], v[76:79], v[188:191], v[252:255]
    s_waitcnt lgkmcnt(11)
    v_mfma_f32_16x16x32_bf16 v[248:251], v[24:27], v[192:195], v[248:251]
    v_mfma_f32_16x16x32_bf16 v[252:255], v[80:83], v[192:195], v[252:255]
    s_waitcnt lgkmcnt(10)
    v_mfma_f32_16x16x32_bf16 v[248:251], v[28:31], v[196:199], v[248:251]
    v_mfma_f32_16x16x32_bf16 v[252:255], v[84:87], v[196:199], v[252:255]
    s_waitcnt lgkmcnt(9)
    v_mfma_f32_16x16x32_bf16 v[248:251], v[32:35], v[200:203], v[248:251]
    v_mfma_f32_16x16x32_bf16 v[252:255], v[88:91], v[200:203], v[252:255]
    s_waitcnt lgkmcnt(8)
    v_mfma_f32_16x16x32_bf16 v[248:251], v[36:39], v[204:207], v[248:251]
    v_mfma_f32_16x16x32_bf16 v[252:255], v[92:95], v[204:207], v[252:255]
    s_waitcnt lgkmcnt(7)
    v_mfma_f32_16x16x32_bf16 v[248:251], v[40:43], v[208:211], v[248:251]
    v_mfma_f32_16x16x32_bf16 v[252:255], v[96:99], v[208:211], v[252:255]
    s_waitcnt lgkmcnt(6)
    v_mfma_f32_16x16x32_bf16 v[248:251], v[44:47], v[212:215], v[248:251]
    v_mfma_f32_16x16x32_bf16 v[252:255], v[100:103], v[212:215], v[252:255]
    s_waitcnt lgkmcnt(5)
    v_mfma_f32_16x16x32_bf16 v[248:251], v[48:51], v[216:219], v[248:251]
    v_mfma_f32_16x16x32_bf16 v[252:255], v[104:107], v[216:219], v[252:255]
    s_waitcnt lgkmcnt(4)
    v_mfma_f32_16x16x32_bf16 v[248:251], v[52:55], v[220:223], v[248:251]
    v_mfma_f32_16x16x32_bf16 v[252:255], v[108:111], v[220:223], v[252:255]
    s_waitcnt lgkmcnt(3)
    v_mfma_f32_16x16x32_bf16 v[248:251], v[56:59], v[224:227], v[248:251]
    v_mfma_f32_16x16x32_bf16 v[252:255], v[112:115], v[224:227], v[252:255]
    s_waitcnt lgkmcnt(2)
    v_mfma_f32_16x16x32_bf16 v[248:251], v[60:63], v[228:231], v[248:251]
    v_mfma_f32_16x16x32_bf16 v[252:255], v[116:119], v[228:231], v[252:255]
    s_waitcnt lgkmcnt(1)
    v_mfma_f32_16x16x32_bf16 v[248:251], v[64:67], v[232:235], v[248:251]
    v_mfma_f32_16x16x32_bf16 v[252:255], v[120:123], v[232:235], v[252:255]
    s_waitcnt lgkmcnt(0)
    v_mfma_f32_16x16x32_bf16 v[248:251], v[68:71], v[236:239], v[248:251]
    v_mfma_f32_16x16x32_bf16 v[252:255], v[124:127], v[236:239], v[252:255]
    s_add_u32 s31, s6, s54
    s_lshl_b32 s31, s31, 15
    s_nop 7
    v_cvt_pk_bf16_f32 v10, v240, v241
    v_cvt_pk_bf16_f32 v11, v242, v243
    buffer_store_dwordx2 v[10:11], v7, s[16:19], s31 offen offset:0 sc1
    s_nop 0
    v_cvt_pk_bf16_f32 v12, v244, v245
    v_cvt_pk_bf16_f32 v13, v246, v247
    buffer_store_dwordx2 v[12:13], v7, s[16:19], s31 offen offset:512 sc1
    s_nop 0
    v_cvt_pk_bf16_f32 v10, v248, v249
    v_cvt_pk_bf16_f32 v11, v250, v251
    buffer_store_dwordx2 v[10:11], v7, s[16:19], s31 offen offset:1024 sc1
    s_nop 0
    v_cvt_pk_bf16_f32 v12, v252, v253
    v_cvt_pk_bf16_f32 v13, v254, v255
    buffer_store_dwordx2 v[12:13], v7, s[16:19], s31 offen offset:1536 sc1
    s_nop 0
    s_add_u32 s7, s7, 28672
    s_cmp_ge_u32 s7, 86016
    s_cselect_b32 s28, 86016, 0
    s_sub_u32 s7, s7, s28
    s_add_u32 s6, s6, 1
    s_add_u32 s26, s6, 1
    s_cmp_lt_u32 s26, 4
    s_cbranch_scc1 wq_w7
    s_waitcnt vmcnt(0)
    s_branch wq_w
    wq_w7:
    s_waitcnt vmcnt(11)
    wq_w:
    s_cmp_lt_u32 s6, 4
    s_cbranch_scc1 wq_loop
    s_branch wk_loop
wk_n0:
    s_sub_u32 s40, s40, 144
    s_cmp_lt_u32 s40, 256
    s_cbranch_scc0 wk_n1
    s_lshr_b32 s41, s40, 4
    s_lshl_b32 s41, s41, 2
    s_add_u32 s41, s41, 128
    s_mov_b32 s53, 1
    s_and_b32 s4, s40, 15
    s_lshr_b32 s5, s40, 4
    s_lshl_b32 s5, s5, 2
    s_add_u32 s5, s5, s3
    s_load_dwordx2 s[8:9], s[0:1], 152
    s_waitcnt lgkmcnt(0)
    s_add_u32 s8, s8, 28442624
    s_addc_u32 s9, s9, 0
    s_and_b32 s9, s9, 0xffff
    s_mov_b32 s10, 1835008
    s_mov_b32 s11, 0x20000
    s_mul_i32 s20, s5, 28672
    v_lshlrev_b32 v4, 4, v1
    v_add_u32 v4, s20, v4
    s_mov_b32 s20, 0
    buffer_load_dwordx4 v[16:19], v4, s[8:11], s20 offen
    s_mov_b32 s20, 1024
    buffer_load_dwordx4 v[20:23], v4, s[8:11], s20 offen
    s_mov_b32 s20, 2048
    buffer_load_dwordx4 v[24:27], v4, s[8:11], s20 offen
    s_mov_b32 s20, 3072
    buffer_load_dwordx4 v[28:31], v4, s[8:11], s20 offen
    s_mov_b32 s20, 4096
    buffer_load_dwordx4 v[32:35], v4, s[8:11], s20 offen
    s_mov_b32 s20, 5120
    buffer_load_dwordx4 v[36:39], v4, s[8:11], s20 offen
    s_mov_b32 s20, 6144
    buffer_load_dwordx4 v[40:43], v4, s[8:11], s20 offen
    s_mov_b32 s20, 7168
    buffer_load_dwordx4 v[44:47], v4, s[8:11], s20 offen
    s_mov_b32 s20, 8192
    buffer_load_dwordx4 v[48:51], v4, s[8:11], s20 offen
    s_mov_b32 s20, 9216
    buffer_load_dwordx4 v[52:55], v4, s[8:11], s20 offen
    s_mov_b32 s20, 10240
    buffer_load_dwordx4 v[56:59], v4, s[8:11], s20 offen
    s_mov_b32 s20, 11264
    buffer_load_dwordx4 v[60:63], v4, s[8:11], s20 offen
    s_mov_b32 s20, 12288
    buffer_load_dwordx4 v[64:67], v4, s[8:11], s20 offen
    s_mov_b32 s20, 13312
    buffer_load_dwordx4 v[68:71], v4, s[8:11], s20 offen
    s_mov_b32 s20, 14336
    buffer_load_dwordx4 v[72:75], v4, s[8:11], s20 offen
    s_mov_b32 s20, 15360
    buffer_load_dwordx4 v[76:79], v4, s[8:11], s20 offen
    s_mov_b32 s20, 16384
    buffer_load_dwordx4 v[80:83], v4, s[8:11], s20 offen
    s_mov_b32 s20, 17408
    buffer_load_dwordx4 v[84:87], v4, s[8:11], s20 offen
    s_mov_b32 s20, 18432
    buffer_load_dwordx4 v[88:91], v4, s[8:11], s20 offen
    s_mov_b32 s20, 19456
    buffer_load_dwordx4 v[92:95], v4, s[8:11], s20 offen
    s_mov_b32 s20, 20480
    buffer_load_dwordx4 v[96:99], v4, s[8:11], s20 offen
    s_mov_b32 s20, 21504
    buffer_load_dwordx4 v[100:103], v4, s[8:11], s20 offen
    s_mov_b32 s20, 22528
    buffer_load_dwordx4 v[104:107], v4, s[8:11], s20 offen
    s_mov_b32 s20, 23552
    buffer_load_dwordx4 v[108:111], v4, s[8:11], s20 offen
    s_mov_b32 s20, 24576
    buffer_load_dwordx4 v[112:115], v4, s[8:11], s20 offen
    s_mov_b32 s20, 25600
    buffer_load_dwordx4 v[116:119], v4, s[8:11], s20 offen
    s_mov_b32 s20, 26624
    buffer_load_dwordx4 v[120:123], v4, s[8:11], s20 offen
    s_mov_b32 s20, 27648
    buffer_load_dwordx4 v[124:127], v4, s[8:11], s20 offen
    s_load_dwordx2 s[12:13], s[0:1], 152
    s_waitcnt lgkmcnt(0)
    s_add_u32 s12, s12, 19267584
    s_addc_u32 s13, s13, 0
    s_and_b32 s13, s13, 0xffff
    s_mov_b32 s14, 7340032
    s_mov_b32 s15, 0x20000
    s_load_dwordx2 s[16:17], s[0:1], 152
    s_waitcnt lgkmcnt(0)
    s_add_u32 s16, s16, 64347136
    s_addc_u32 s17, s17, 0
    s_and_b32 s17, s17, 0xffff
    s_mov_b32 s18, 33554432
    s_mov_b32 s19, 0x20000
    s_mul_i32 s29, s4, 458752
    s_lshl_b32 s20, s5, 8
    s_add_u32 s20, s20, s4
    s_lshl_b32 s20, s20, 11
    v_lshrrev_b32 v7, 1, v3
    v_lshlrev_b32 v7, 8, v7
    v_lshlrev_b32 v8, 4, v2
    v_add_u32 v7, v7, v8
    v_and_b32 v8, 1, v3
    v_lshlrev_b32 v8, 3, v8
    v_add_u32 v7, v7, v8
    v_add_u32 v7, s20, v7
    v_lshlrev_b32 v6, 4, v1
    v_lshlrev_b32 v9, 4, v1
    s_mul_i32 s30, s3, 7168
    s_mov_b32 s6, 0
    s_mov_b32 s7, 0
    s_mov_b32 s26, 1
    s_mov_b32 s27, 28672
    s_mul_i32 s23, s6, 28672
    s_add_u32 s23, s23, s29
    s_add_u32 s23, s23, s30
    s_add_u32 s24, s7, s30
    s_add_u32 m0, s24, 0
    s_add_u32 s25, s23, 0
    buffer_load_dwordx4 v6, s[12:15], s25 offen lds
    s_add_u32 m0, s24, 1024
    s_add_u32 s25, s23, 1024
    buffer_load_dwordx4 v6, s[12:15], s25 offen lds
    s_add_u32 m0, s24, 2048
    s_add_u32 s25, s23, 2048
    buffer_load_dwordx4 v6, s[12:15], s25 offen lds
    s_add_u32 m0, s24, 3072
    s_add_u32 s25, s23, 3072
    buffer_load_dwordx4 v6, s[12:15], s25 offen lds
    s_add_u32 m0, s24, 4096
    s_add_u32 s25, s23, 4096
    buffer_load_dwordx4 v6, s[12:15], s25 offen lds
    s_add_u32 m0, s24, 5120
    s_add_u32 s25, s23, 5120
    buffer_load_dwordx4 v6, s[12:15], s25 offen lds
    s_add_u32 m0, s24, 6144
    s_add_u32 s25, s23, 6144
    buffer_load_dwordx4 v6, s[12:15], s25 offen lds
    s_mul_i32 s23, s26, 28672
    s_add_u32 s23, s23, s29
    s_add_u32 s23, s23, s30
    s_add_u32 s24, s27, s30
    s_add_u32 m0, s24, 0
    s_add_u32 s25, s23, 0
    buffer_load_dwordx4 v6, s[12:15], s25 offen lds
    s_add_u32 m0, s24, 1024
    s_add_u32 s25, s23, 1024
    buffer_load_dwordx4 v6, s[12:15], s25 offen lds
    s_add_u32 m0, s24, 2048
    s_add_u32 s25, s23, 2048
    buffer_load_dwordx4 v6, s[12:15], s25 offen lds
    s_add_u32 m0, s24, 3072
    s_add_u32 s25, s23, 3072
    buffer_load_dwordx4 v6, s[12:15], s25 offen lds
    s_add_u32 m0, s24, 4096
    s_add_u32 s25, s23, 4096
    buffer_load_dwordx4 v6, s[12:15], s25 offen lds
    s_add_u32 m0, s24, 5120
    s_add_u32 s25, s23, 5120
    buffer_load_dwordx4 v6, s[12:15], s25 offen lds
    s_add_u32 m0, s24, 6144
    s_add_u32 s25, s23, 6144
    buffer_load_dwordx4 v6, s[12:15], s25 offen lds
    s_waitcnt vmcnt(7)
wx_loop:
    s_barrier
    s_add_u32 s27, s7, 57344
    s_cmp_ge_u32 s27, 86016
    s_cselect_b32 s28, 86016, 0
    s_sub_u32 s27, s27, s28
    s_add_u32 s26, s6, 2
    s_cmp_lt_u32 s26, 16
    s_cbranch_scc0 wx_nodma
    s_mul_i32 s23, s26, 28672
    s_add_u32 s23, s23, s29
    s_add_u32 s23, s23, s30
    s_add_u32 s24, s27, s30
    s_add_u32 m0, s24, 0
    s_add_u32 s25, s23, 0
    buffer_load_dwordx4 v6, s[12:15], s25 offen lds
    s_add_u32 m0, s24, 1024
    s_add_u32 s25, s23, 1024
    buffer_load_dwordx4 v6, s[12:15], s25 offen lds
    s_add_u32 m0, s24, 2048
    s_add_u32 s25, s23, 2048
    buffer_load_dwordx4 v6, s[12:15], s25 offen lds
    s_add_u32 m0, s24, 3072
    s_add_u32 s25, s23, 3072
    buffer_load_dwordx4 v6, s[12:15], s25 offen lds
    s_add_u32 m0, s24, 4096
    s_add_u32 s25, s23, 4096
    buffer_load_dwordx4 v6, s[12:15], s25 offen lds
    s_add_u32 m0, s24, 5120
    s_add_u32 s25, s23, 5120
    buffer_load_dwordx4 v6, s[12:15], s25 offen lds
    s_add_u32 m0, s24, 6144
    s_add_u32 s25, s23, 6144
    buffer_load_dwordx4 v6, s[12:15], s25 offen lds
wx_nodma:
    v_add_u32 v10, s7, v9
    ds_read_b128 v[128:131], v10 offset:0
    ds_read_b128 v[132:135], v10 offset:1024
    ds_read_b128 v[136:139], v10 offset:2048
    ds_read_b128 v[140:143], v10 offset:3072
    ds_read_b128 v[144:147], v10 offset:4096
    ds_read_b128 v[148:151], v10 offset:5120
    ds_read_b128 v[152:155], v10 offset:6144
    ds_read_b128 v[156:159], v10 offset:7168
    ds_read_b128 v[160:163], v10 offset:8192
    ds_read_b128 v[164:167], v10 offset:9216
    ds_read_b128 v[168:171], v10 offset:10240
    ds_read_b128 v[172:175], v10 offset:11264
    ds_read_b128 v[176:179], v10 offset:12288
    ds_read_b128 v[180:183], v10 offset:13312
    ds_read_b128 v[184:187], v10 offset:14336
    s_waitcnt lgkmcnt(14)
    v_mfma_f32_16x16x32_bf16 v[240:243], v[16:19], v[128:131], 0
    v_mfma_f32_16x16x32_bf16 v[244:247], v[72:75], v[128:131], 0
    ds_read_b128 v[188:191], v10 offset:15360
    s_waitcnt lgkmcnt(14)
    v_mfma_f32_16x16x32_bf16 v[240:243], v[20:23], v[132:135], v[240:243]
    v_mfma_f32_16x16x32_bf16 v[244:247], v[76:79], v[132:135], v[244:247]
    ds_read_b128 v[192:195], v10 offset:16384
    s_waitcnt lgkmcnt(14)
    v_mfma_f32_16x16x32_bf16 v[240:243], v[24:27], v[136:139], v[240:243]
    v_mfma_f32_16x16x32_bf16 v[244:247], v[80:83], v[136:139], v[244:247]
    ds_read_b128 v[196:199], v10 offset:17408
    s_waitcnt lgkmcnt(14)
    v_mfma_f32_16x16x32_bf16 v[240:243], v[28:31], v[140:143], v[240:243]
    v_mfma_f32_16x16x32_bf16 v[244:247], v[84:87], v[140:143], v[244:247]
    ds_read_b128 v[200:203], v10 offset:18432
    s_waitcnt lgkmcnt(14)
    v_mfma_f32_16x16x32_bf16 v[240:243], v[32:35], v[144:147], v[240:243]
    v_mfma_f32_16x16x32_bf16 v[244:247], v[88:91], v[144:147], v[244:247]
    ds_read_b128 v[204:207], v10 offset:19456
    s_waitcnt lgkmcnt(14)
    v_mfma_f32_16x16x32_bf16 v[240:243], v[36:39], v[148:151], v[240:243]
    v_mfma_f32_16x16x32_bf16 v[244:247], v[92:95], v[148:151], v[244:247]
    ds_read_b128 v[208:211], v10 offset:20480
    s_waitcnt lgkmcnt(14)
    v_mfma_f32_16x16x32_bf16 v[240:243], v[40:43], v[152:155], v[240:243]
    v_mfma_f32_16x16x32_bf16 v[244:247], v[96:99], v[152:155], v[244:247]
    ds_read_b128 v[212:215], v10 offset:21504
    s_waitcnt lgkmcnt(14)
    v_mfma_f32_16x16x32_bf16 v[240:243], v[44:47], v[156:159], v[240:243]
    v_mfma_f32_16x16x32_bf16 v[244:247], v[100:103], v[156:159], v[244:247]
    ds_read_b128 v[216:219], v10 offset:22528
    s_waitcnt lgkmcnt(14)
    v_mfma_f32_16x16x32_bf16 v[240:243], v[48:51], v[160:163], v[240:243]
    v_mfma_f32_16x16x32_bf16 v[244:247], v[104:107], v[160:163], v[244:247]
    ds_read_b128 v[220:223], v10 offset:23552
    s_waitcnt lgkmcnt(14)
    v_mfma_f32_16x16x32_bf16 v[240:243], v[52:55], v[164:167], v[240:243]
    v_mfma_f32_16x16x32_bf16 v[244:247], v[108:111], v[164:167], v[244:247]
    ds_read_b128 v[224:227], v10 offset:24576
    s_waitcnt lgkmcnt(14)
    v_mfma_f32_16x16x32_bf16 v[240:243], v[56:59], v[168:171], v[240:243]
    v_mfma_f32_16x16x32_bf16 v[244:247], v[112:115], v[168:171], v[244:247]
    ds_read_b128 v[228:231], v10 offset:25600
    s_waitcnt lgkmcnt(14)
    v_mfma_f32_16x16x32_bf16 v[240:243], v[60:63], v[172:175], v[240:243]
    v_mfma_f32_16x16x32_bf16 v[244:247], v[116:119], v[172:175], v[244:247]
    ds_read_b128 v[232:235], v10 offset:26624
    s_waitcnt lgkmcnt(14)
    v_mfma_f32_16x16x32_bf16 v[240:243], v[64:67], v[176:179], v[240:243]
    v_mfma_f32_16x16x32_bf16 v[244:247], v[120:123], v[176:179], v[244:247]
    ds_read_b128 v[236:239], v10 offset:27648
    s_waitcnt lgkmcnt(14)
    v_mfma_f32_16x16x32_bf16 v[240:243], v[68:71], v[180:183], v[240:243]
    v_mfma_f32_16x16x32_bf16 v[244:247], v[124:127], v[180:183], v[244:247]
    s_waitcnt lgkmcnt(13)
    v_mfma_f32_16x16x32_bf16 v[248:251], v[16:19], v[184:187], 0
    v_mfma_f32_16x16x32_bf16 v[252:255], v[72:75], v[184:187], 0
    s_waitcnt lgkmcnt(12)
    v_mfma_f32_16x16x32_bf16 v[248:251], v[20:23], v[188:191], v[248:251]
    v_mfma_f32_16x16x32_bf16 v[252:255], v[76:79], v[188:191], v[252:255]
    s_waitcnt lgkmcnt(11)
    v_mfma_f32_16x16x32_bf16 v[248:251], v[24:27], v[192:195], v[248:251]
    v_mfma_f32_16x16x32_bf16 v[252:255], v[80:83], v[192:195], v[252:255]
    s_waitcnt lgkmcnt(10)
    v_mfma_f32_16x16x32_bf16 v[248:251], v[28:31], v[196:199], v[248:251]
    v_mfma_f32_16x16x32_bf16 v[252:255], v[84:87], v[196:199], v[252:255]
    s_waitcnt lgkmcnt(9)
    v_mfma_f32_16x16x32_bf16 v[248:251], v[32:35], v[200:203], v[248:251]
    v_mfma_f32_16x16x32_bf16 v[252:255], v[88:91], v[200:203], v[252:255]
    s_waitcnt lgkmcnt(8)
    v_mfma_f32_16x16x32_bf16 v[248:251], v[36:39], v[204:207], v[248:251]
    v_mfma_f32_16x16x32_bf16 v[252:255], v[92:95], v[204:207], v[252:255]
    s_waitcnt lgkmcnt(7)
    v_mfma_f32_16x16x32_bf16 v[248:251], v[40:43], v[208:211], v[248:251]
    v_mfma_f32_16x16x32_bf16 v[252:255], v[96:99], v[208:211], v[252:255]
    s_waitcnt lgkmcnt(6)
    v_mfma_f32_16x16x32_bf16 v[248:251], v[44:47], v[212:215], v[248:251]
    v_mfma_f32_16x16x32_bf16 v[252:255], v[100:103], v[212:215], v[252:255]
    s_waitcnt lgkmcnt(5)
    v_mfma_f32_16x16x32_bf16 v[248:251], v[48:51], v[216:219], v[248:251]
    v_mfma_f32_16x16x32_bf16 v[252:255], v[104:107], v[216:219], v[252:255]
    s_waitcnt lgkmcnt(4)
    v_mfma_f32_16x16x32_bf16 v[248:251], v[52:55], v[220:223], v[248:251]
    v_mfma_f32_16x16x32_bf16 v[252:255], v[108:111], v[220:223], v[252:255]
    s_waitcnt lgkmcnt(3)
    v_mfma_f32_16x16x32_bf16 v[248:251], v[56:59], v[224:227], v[248:251]
    v_mfma_f32_16x16x32_bf16 v[252:255], v[112:115], v[224:227], v[252:255]
    s_waitcnt lgkmcnt(2)
    v_mfma_f32_16x16x32_bf16 v[248:251], v[60:63], v[228:231], v[248:251]
    v_mfma_f32_16x16x32_bf16 v[252:255], v[116:119], v[228:231], v[252:255]
    s_waitcnt lgkmcnt(1)
    v_mfma_f32_16x16x32_bf16 v[248:251], v[64:67], v[232:235], v[248:251]
    v_mfma_f32_16x16x32_bf16 v[252:255], v[120:123], v[232:235], v[252:255]
    s_waitcnt lgkmcnt(0)
    v_mfma_f32_16x16x32_bf16 v[248:251], v[68:71], v[236:239], v[248:251]
    v_mfma_f32_16x16x32_bf16 v[252:255], v[124:127], v[236:239], v[252:255]
    s_lshl_b32 s31, s6, 15
    s_nop 7
    v_cvt_pk_bf16_f32 v10, v240, v241
    v_cvt_pk_bf16_f32 v11, v242, v243
    buffer_store_dwordx2 v[10:11], v7, s[16:19], s31 offen offset:0 sc1
    s_nop 0
    v_cvt_pk_bf16_f32 v12, v244, v245
    v_cvt_pk_bf16_f32 v13, v246, v247
    buffer_store_dwordx2 v[12:13], v7, s[16:19], s31 offen offset:512 sc1
    s_nop 0
    v_cvt_pk_bf16_f32 v10, v248, v249
    v_cvt_pk_bf16_f32 v11, v250, v251
    buffer_store_dwordx2 v[10:11], v7, s[16:19], s31 offen offset:1024 sc1
    s_nop 0
    v_cvt_pk_bf16_f32 v12, v252, v253
    v_cvt_pk_bf16_f32 v13, v254, v255
    buffer_store_dwordx2 v[12:13], v7, s[16:19], s31 offen offset:1536 sc1
    s_nop 0
    s_add_u32 s7, s7, 28672
    s_cmp_ge_u32 s7, 86016
    s_cselect_b32 s28, 86016, 0
    s_sub_u32 s7, s7, s28
    s_add_u32 s6, s6, 1
    s_add_u32 s26, s6, 1
    s_cmp_lt_u32 s26, 16
    s_cbranch_scc1 wx_w7
    s_waitcnt vmcnt(0)
    s_branch wx_w
    wx_w7:
    s_waitcnt vmcnt(11)
    wx_w:
    s_cmp_lt_u32 s6, 16
    s_cbranch_scc1 wx_loop
    s_branch wk_loop
wk_n1:
    s_cmp_lt_u32 s40, 480
    s_cbranch_scc0 wk_n2
    s_sub_u32 s40, s40, 256
    s_mul_i32 s41, s40, 74899
    s_lshr_b32 s41, s41, 20
    s_lshl_b32 s41, s41, 2
    s_add_u32 s41, s41, 128
    s_mov_b32 s53, 0x100
    s_mul_i32 s5, s40, 74899
    s_lshr_b32 s5, s5, 20
    s_mul_i32 s20, s5, 14
    s_sub_u32 s4, s40, s20
    s_lshl_b32 s5, s5, 2
    s_add_u32 s5, s5, s3
    s_load_dwordx2 s[8:9], s[0:1], 152
    s_waitcnt lgkmcnt(0)
    s_add_u32 s8, s8, 28442624
    s_addc_u32 s9, s9, 0
    s_and_b32 s9, s9, 0xffff
    s_mov_b32 s10, 1835008
    s_mov_b32 s11, 0x20000
    s_load_dwordx2 s[12:13], s[0:1], 24
    s_waitcnt lgkmcnt(0)
    s_and_b32 s13, s13, 0xffff
    s_mov_b32 s14, 401408
    s_mov_b32 s15, 0x20000
    s_load_dwordx2 s[16:17], s[0:1], 32
    s_waitcnt lgkmcnt(0)
    s_and_b32 s17, s17, 0xffff
    s_mov_b32 s18, 401408
    s_mov_b32 s19, 0x20000
    s_load_dwordx2 s[44:45], s[0:1], 8
    s_load_dwordx2 s[46:47], s[0:1], 16
    s_load_dwordx2 s[48:49], s[0:1], 56
    s_waitcnt lgkmcnt(0)
    s_lshl_b32 s21, s4, 5
    v_add_u32 v5, s21, v2
    v_lshlrev_b32 v6, 1, v5
    v_add_u32 v7, 32, v6
    global_load_ushort v160, v6, s[44:45]
    global_load_ushort v161, v6, s[46:47]
    global_load_ushort v162, v6, s[48:49]
    global_load_ushort v164, v7, s[44:45]
    global_load_ushort v165, v7, s[46:47]
    global_load_ushort v166, v7, s[48:49]
    s_mul_i32 s20, s5, 28672
    v_lshrrev_b32 v8, 2, v2
    v_lshlrev_b32 v8, 3, v8
    v_and_b32 v9, 3, v2
    v_add_u32 v8, v8, v9
    v_add_u32 v9, 0, v8
    v_lshrrev_b32 v10, 4, v9
    v_mul_u32_u24 v10, 14336, v10
    v_and_b32 v9, 15, v9
    v_lshl_add_u32 v10, v9, 4, v10
    v_lshl_add_u32 v10, v3, 8, v10
    v_add_u32 v11, s20, v10
    v_add_u32 v9, 4, v8
    v_lshrrev_b32 v10, 4, v9
    v_mul_u32_u24 v10, 14336, v10
    v_and_b32 v9, 15, v9
    v_lshl_add_u32 v10, v9, 4, v10
    v_lshl_add_u32 v10, v3, 8, v10
    v_add_u32 v12, s20, v10
    v_mul_u32_u24 v10, 896, v5
    v_lshl_add_u32 v10, v3, 4, v10
    v_add_u32 v13, 14336, v10
    s_mov_b32 s20, 0
    buffer_load_dwordx4 v[16:19], v11, s[8:11], s20 offen
    s_mov_b32 s20, 0
    buffer_load_dwordx4 v[72:75], v12, s[8:11], s20 offen
    buffer_load_dwordx4 a[0:3], v10, s[12:15], 0 offen offset:0
    buffer_load_dwordx4 a[4:7], v13, s[12:15], 0 offen offset:0
    buffer_load_dwordx4 a[8:11], v10, s[16:19], 0 offen offset:0
    buffer_load_dwordx4 a[12:15], v13, s[16:19], 0 offen offset:0
    s_mov_b32 s20, 1024
    buffer_load_dwordx4 v[20:23], v11, s[8:11], s20 offen
    s_mov_b32 s20, 1024
    buffer_load_dwordx4 v[76:79], v12, s[8:11], s20 offen
    buffer_load_dwordx4 a[16:19], v10, s[12:15], 0 offen offset:64
    buffer_load_dwordx4 a[20:23], v13, s[12:15], 0 offen offset:64
    buffer_load_dwordx4 a[24:27], v10, s[16:19], 0 offen offset:64
    buffer_load_dwordx4 a[28:31], v13, s[16:19], 0 offen offset:64
    s_mov_b32 s20, 2048
    buffer_load_dwordx4 v[24:27], v11, s[8:11], s20 offen
    s_mov_b32 s20, 2048
    buffer_load_dwordx4 v[80:83], v12, s[8:11], s20 offen
    buffer_load_dwordx4 a[32:35], v10, s[12:15], 0 offen offset:128
    buffer_load_dwordx4 a[36:39], v13, s[12:15], 0 offen offset:128
    buffer_load_dwordx4 a[40:43], v10, s[16:19], 0 offen offset:128
    buffer_load_dwordx4 a[44:47], v13, s[16:19], 0 offen offset:128
    s_mov_b32 s20, 3072
    buffer_load_dwordx4 v[28:31], v11, s[8:11], s20 offen
    s_mov_b32 s20, 3072
    buffer_load_dwordx4 v[84:87], v12, s[8:11], s20 offen
    buffer_load_dwordx4 a[48:51], v10, s[12:15], 0 offen offset:192
    buffer_load_dwordx4 a[52:55], v13, s[12:15], 0 offen offset:192
    buffer_load_dwordx4 a[56:59], v10, s[16:19], 0 offen offset:192
    buffer_load_dwordx4 a[60:63], v13, s[16:19], 0 offen offset:192
    s_mov_b32 s20, 4096
    buffer_load_dwordx4 v[32:35], v11, s[8:11], s20 offen
    s_mov_b32 s20, 4096
    buffer_load_dwordx4 v[88:91], v12, s[8:11], s20 offen
    buffer_load_dwordx4 a[64:67], v10, s[12:15], 0 offen offset:256
    buffer_load_dwordx4 a[68:71], v13, s[12:15], 0 offen offset:256
    buffer_load_dwordx4 a[72:75], v10, s[16:19], 0 offen offset:256
    buffer_load_dwordx4 a[76:79], v13, s[16:19], 0 offen offset:256
    s_mov_b32 s20, 5120
    buffer_load_dwordx4 v[36:39], v11, s[8:11], s20 offen
    s_mov_b32 s20, 5120
    buffer_load_dwordx4 v[92:95], v12, s[8:11], s20 offen
    buffer_load_dwordx4 a[80:83], v10, s[12:15], 0 offen offset:320
    buffer_load_dwordx4 a[84:87], v13, s[12:15], 0 offen offset:320
    buffer_load_dwordx4 a[88:91], v10, s[16:19], 0 offen offset:320
    buffer_load_dwordx4 a[92:95], v13, s[16:19], 0 offen offset:320
    s_mov_b32 s20, 6144
    buffer_load_dwordx4 v[40:43], v11, s[8:11], s20 offen
    s_mov_b32 s20, 6144
    buffer_load_dwordx4 v[96:99], v12, s[8:11], s20 offen
    buffer_load_dwordx4 a[96:99], v10, s[12:15], 0 offen offset:384
    buffer_load_dwordx4 a[100:103], v13, s[12:15], 0 offen offset:384
    buffer_load_dwordx4 a[104:107], v10, s[16:19], 0 offen offset:384
    buffer_load_dwordx4 a[108:111], v13, s[16:19], 0 offen offset:384
    s_mov_b32 s20, 7168
    buffer_load_dwordx4 v[44:47], v11, s[8:11], s20 offen
    s_mov_b32 s20, 7168
    buffer_load_dwordx4 v[100:103], v12, s[8:11], s20 offen
    buffer_load_dwordx4 a[112:115], v10, s[12:15], 0 offen offset:448
    buffer_load_dwordx4 a[116:119], v13, s[12:15], 0 offen offset:448
    buffer_load_dwordx4 a[120:123], v10, s[16:19], 0 offen offset:448
    buffer_load_dwordx4 a[124:127], v13, s[16:19], 0 offen offset:448
    s_mov_b32 s20, 8192
    buffer_load_dwordx4 v[48:51], v11, s[8:11], s20 offen
    s_mov_b32 s20, 8192
    buffer_load_dwordx4 v[104:107], v12, s[8:11], s20 offen
    buffer_load_dwordx4 a[128:131], v10, s[12:15], 0 offen offset:512
    buffer_load_dwordx4 a[132:135], v13, s[12:15], 0 offen offset:512
    buffer_load_dwordx4 a[136:139], v10, s[16:19], 0 offen offset:512
    buffer_load_dwordx4 a[140:143], v13, s[16:19], 0 offen offset:512
    s_mov_b32 s20, 9216
    buffer_load_dwordx4 v[52:55], v11, s[8:11], s20 offen
    s_mov_b32 s20, 9216
    buffer_load_dwordx4 v[108:111], v12, s[8:11], s20 offen
    buffer_load_dwordx4 a[144:147], v10, s[12:15], 0 offen offset:576
    buffer_load_dwordx4 a[148:151], v13, s[12:15], 0 offen offset:576
    buffer_load_dwordx4 a[152:155], v10, s[16:19], 0 offen offset:576
    buffer_load_dwordx4 a[156:159], v13, s[16:19], 0 offen offset:576
    s_mov_b32 s20, 10240
    buffer_load_dwordx4 v[56:59], v11, s[8:11], s20 offen
    s_mov_b32 s20, 10240
    buffer_load_dwordx4 v[112:115], v12, s[8:11], s20 offen
    buffer_load_dwordx4 a[160:163], v10, s[12:15], 0 offen offset:640
    buffer_load_dwordx4 a[164:167], v13, s[12:15], 0 offen offset:640
    buffer_load_dwordx4 a[168:171], v10, s[16:19], 0 offen offset:640
    buffer_load_dwordx4 a[172:175], v13, s[16:19], 0 offen offset:640
    s_mov_b32 s20, 11264
    buffer_load_dwordx4 v[60:63], v11, s[8:11], s20 offen
    s_mov_b32 s20, 11264
    buffer_load_dwordx4 v[116:119], v12, s[8:11], s20 offen
    buffer_load_dwordx4 a[176:179], v10, s[12:15], 0 offen offset:704
    buffer_load_dwordx4 a[180:183], v13, s[12:15], 0 offen offset:704
    buffer_load_dwordx4 a[184:187], v10, s[16:19], 0 offen offset:704
    buffer_load_dwordx4 a[188:191], v13, s[16:19], 0 offen offset:704
    s_mov_b32 s20, 12288
    buffer_load_dwordx4 v[64:67], v11, s[8:11], s20 offen
    s_mov_b32 s20, 12288
    buffer_load_dwordx4 v[120:123], v12, s[8:11], s20 offen
    buffer_load_dwordx4 a[192:195], v10, s[12:15], 0 offen offset:768
    buffer_load_dwordx4 a[196:199], v13, s[12:15], 0 offen offset:768
    buffer_load_dwordx4 a[200:203], v10, s[16:19], 0 offen offset:768
    buffer_load_dwordx4 a[204:207], v13, s[16:19], 0 offen offset:768
    s_mov_b32 s20, 13312
    buffer_load_dwordx4 v[68:71], v11, s[8:11], s20 offen
    s_mov_b32 s20, 13312
    buffer_load_dwordx4 v[124:127], v12, s[8:11], s20 offen
    buffer_load_dwordx4 a[208:211], v10, s[12:15], 0 offen offset:832
    buffer_load_dwordx4 a[212:215], v13, s[12:15], 0 offen offset:832
    buffer_load_dwordx4 a[216:219], v10, s[16:19], 0 offen offset:832
    buffer_load_dwordx4 a[220:223], v13, s[16:19], 0 offen offset:832
    s_waitcnt vmcnt(63)
    v_mfma_f32_16x16x32_bf16 v[128:131], v[16:19], a[0:3], 0
    v_mfma_f32_16x16x32_bf16 v[132:135], v[72:75], a[0:3], 0
    v_mfma_f32_16x16x32_bf16 v[136:139], v[16:19], a[4:7], 0
    v_mfma_f32_16x16x32_bf16 v[140:143], v[72:75], a[4:7], 0
    v_mfma_f32_16x16x32_bf16 v[144:147], v[16:19], a[8:11], 0
    v_mfma_f32_16x16x32_bf16 v[148:151], v[72:75], a[8:11], 0
    v_mfma_f32_16x16x32_bf16 v[152:155], v[16:19], a[12:15], 0
    v_mfma_f32_16x16x32_bf16 v[156:159], v[72:75], a[12:15], 0
    s_waitcnt vmcnt(63)
    v_mfma_f32_16x16x32_bf16 v[128:131], v[20:23], a[16:19], v[128:131]
    v_mfma_f32_16x16x32_bf16 v[132:135], v[76:79], a[16:19], v[132:135]
    v_mfma_f32_16x16x32_bf16 v[136:139], v[20:23], a[20:23], v[136:139]
    v_mfma_f32_16x16x32_bf16 v[140:143], v[76:79], a[20:23], v[140:143]
    v_mfma_f32_16x16x32_bf16 v[144:147], v[20:23], a[24:27], v[144:147]
    v_mfma_f32_16x16x32_bf16 v[148:151], v[76:79], a[24:27], v[148:151]
    v_mfma_f32_16x16x32_bf16 v[152:155], v[20:23], a[28:31], v[152:155]
    v_mfma_f32_16x16x32_bf16 v[156:159], v[76:79], a[28:31], v[156:159]
    s_waitcnt vmcnt(63)
    v_mfma_f32_16x16x32_bf16 v[128:131], v[24:27], a[32:35], v[128:131]
    v_mfma_f32_16x16x32_bf16 v[132:135], v[80:83], a[32:35], v[132:135]
    v_mfma_f32_16x16x32_bf16 v[136:139], v[24:27], a[36:39], v[136:139]
    v_mfma_f32_16x16x32_bf16 v[140:143], v[80:83], a[36:39], v[140:143]
    v_mfma_f32_16x16x32_bf16 v[144:147], v[24:27], a[40:43], v[144:147]
    v_mfma_f32_16x16x32_bf16 v[148:151], v[80:83], a[40:43], v[148:151]
    v_mfma_f32_16x16x32_bf16 v[152:155], v[24:27], a[44:47], v[152:155]
    v_mfma_f32_16x16x32_bf16 v[156:159], v[80:83], a[44:47], v[156:159]
    s_waitcnt vmcnt(60)
    v_mfma_f32_16x16x32_bf16 v[128:131], v[28:31], a[48:51], v[128:131]
    v_mfma_f32_16x16x32_bf16 v[132:135], v[84:87], a[48:51], v[132:135]
    v_mfma_f32_16x16x32_bf16 v[136:139], v[28:31], a[52:55], v[136:139]
    v_mfma_f32_16x16x32_bf16 v[140:143], v[84:87], a[52:55], v[140:143]
    v_mfma_f32_16x16x32_bf16 v[144:147], v[28:31], a[56:59], v[144:147]
    v_mfma_f32_16x16x32_bf16 v[148:151], v[84:87], a[56:59], v[148:151]
    v_mfma_f32_16x16x32_bf16 v[152:155], v[28:31], a[60:63], v[152:155]
    v_mfma_f32_16x16x32_bf16 v[156:159], v[84:87], a[60:63], v[156:159]
    s_waitcnt vmcnt(54)
    v_mfma_f32_16x16x32_bf16 v[128:131], v[32:35], a[64:67], v[128:131]
    v_mfma_f32_16x16x32_bf16 v[132:135], v[88:91], a[64:67], v[132:135]
    v_mfma_f32_16x16x32_bf16 v[136:139], v[32:35], a[68:71], v[136:139]
    v_mfma_f32_16x16x32_bf16 v[140:143], v[88:91], a[68:71], v[140:143]
    v_mfma_f32_16x16x32_bf16 v[144:147], v[32:35], a[72:75], v[144:147]
    v_mfma_f32_16x16x32_bf16 v[148:151], v[88:91], a[72:75], v[148:151]
    v_mfma_f32_16x16x32_bf16 v[152:155], v[32:35], a[76:79], v[152:155]
    v_mfma_f32_16x16x32_bf16 v[156:159], v[88:91], a[76:79], v[156:159]
    s_waitcnt vmcnt(48)
    v_mfma_f32_16x16x32_bf16 v[128:131], v[36:39], a[80:83], v[128:131]
    v_mfma_f32_16x16x32_bf16 v[132:135], v[92:95], a[80:83], v[132:135]
    v_mfma_f32_16x16x32_bf16 v[136:139], v[36:39], a[84:87], v[136:139]
    v_mfma_f32_16x16x32_bf16 v[140:143], v[92:95], a[84:87], v[140:143]
    v_mfma_f32_16x16x32_bf16 v[144:147], v[36:39], a[88:91], v[144:147]
    v_mfma_f32_16x16x32_bf16 v[148:151], v[92:95], a[88:91], v[148:151]
    v_mfma_f32_16x16x32_bf16 v[152:155], v[36:39], a[92:95], v[152:155]
    v_mfma_f32_16x16x32_bf16 v[156:159], v[92:95], a[92:95], v[156:159]
    s_waitcnt vmcnt(42)
    v_mfma_f32_16x16x32_bf16 v[128:131], v[40:43], a[96:99], v[128:131]
    v_mfma_f32_16x16x32_bf16 v[132:135], v[96:99], a[96:99], v[132:135]
    v_mfma_f32_16x16x32_bf16 v[136:139], v[40:43], a[100:103], v[136:139]
    v_mfma_f32_16x16x32_bf16 v[140:143], v[96:99], a[100:103], v[140:143]
    v_mfma_f32_16x16x32_bf16 v[144:147], v[40:43], a[104:107], v[144:147]
    v_mfma_f32_16x16x32_bf16 v[148:151], v[96:99], a[104:107], v[148:151]
    v_mfma_f32_16x16x32_bf16 v[152:155], v[40:43], a[108:111], v[152:155]
    v_mfma_f32_16x16x32_bf16 v[156:159], v[96:99], a[108:111], v[156:159]
    s_waitcnt vmcnt(36)
    v_mfma_f32_16x16x32_bf16 v[128:131], v[44:47], a[112:115], v[128:131]
    v_mfma_f32_16x16x32_bf16 v[132:135], v[100:103], a[112:115], v[132:135]
    v_mfma_f32_16x16x32_bf16 v[136:139], v[44:47], a[116:119], v[136:139]
    v_mfma_f32_16x16x32_bf16 v[140:143], v[100:103], a[116:119], v[140:143]
    v_mfma_f32_16x16x32_bf16 v[144:147], v[44:47], a[120:123], v[144:147]
    v_mfma_f32_16x16x32_bf16 v[148:151], v[100:103], a[120:123], v[148:151]
    v_mfma_f32_16x16x32_bf16 v[152:155], v[44:47], a[124:127], v[152:155]
    v_mfma_f32_16x16x32_bf16 v[156:159], v[100:103], a[124:127], v[156:159]
    s_waitcnt vmcnt(30)
    v_mfma_f32_16x16x32_bf16 v[128:131], v[48:51], a[128:131], v[128:131]
    v_mfma_f32_16x16x32_bf16 v[132:135], v[104:107], a[128:131], v[132:135]
    v_mfma_f32_16x16x32_bf16 v[136:139], v[48:51], a[132:135], v[136:139]
    v_mfma_f32_16x16x32_bf16 v[140:143], v[104:107], a[132:135], v[140:143]
    v_mfma_f32_16x16x32_bf16 v[144:147], v[48:51], a[136:139], v[144:147]
    v_mfma_f32_16x16x32_bf16 v[148:151], v[104:107], a[136:139], v[148:151]
    v_mfma_f32_16x16x32_bf16 v[152:155], v[48:51], a[140:143], v[152:155]
    v_mfma_f32_16x16x32_bf16 v[156:159], v[104:107], a[140:143], v[156:159]
    s_waitcnt vmcnt(24)
    v_mfma_f32_16x16x32_bf16 v[128:131], v[52:55], a[144:147], v[128:131]
    v_mfma_f32_16x16x32_bf16 v[132:135], v[108:111], a[144:147], v[132:135]
    v_mfma_f32_16x16x32_bf16 v[136:139], v[52:55], a[148:151], v[136:139]
    v_mfma_f32_16x16x32_bf16 v[140:143], v[108:111], a[148:151], v[140:143]
    v_mfma_f32_16x16x32_bf16 v[144:147], v[52:55], a[152:155], v[144:147]
    v_mfma_f32_16x16x32_bf16 v[148:151], v[108:111], a[152:155], v[148:151]
    v_mfma_f32_16x16x32_bf16 v[152:155], v[52:55], a[156:159], v[152:155]
    v_mfma_f32_16x16x32_bf16 v[156:159], v[108:111], a[156:159], v[156:159]
    s_waitcnt vmcnt(18)
    v_mfma_f32_16x16x32_bf16 v[128:131], v[56:59], a[160:163], v[128:131]
    v_mfma_f32_16x16x32_bf16 v[132:135], v[112:115], a[160:163], v[132:135]
    v_mfma_f32_16x16x32_bf16 v[136:139], v[56:59], a[164:167], v[136:139]
    v_mfma_f32_16x16x32_bf16 v[140:143], v[112:115], a[164:167], v[140:143]
    v_mfma_f32_16x16x32_bf16 v[144:147], v[56:59], a[168:171], v[144:147]
    v_mfma_f32_16x16x32_bf16 v[148:151], v[112:115], a[168:171], v[148:151]
    v_mfma_f32_16x16x32_bf16 v[152:155], v[56:59], a[172:175], v[152:155]
    v_mfma_f32_16x16x32_bf16 v[156:159], v[112:115], a[172:175], v[156:159]
    s_waitcnt vmcnt(12)
    v_mfma_f32_16x16x32_bf16 v[128:131], v[60:63], a[176:179], v[128:131]
    v_mfma_f32_16x16x32_bf16 v[132:135], v[116:119], a[176:179], v[132:135]
    v_mfma_f32_16x16x32_bf16 v[136:139], v[60:63], a[180:183], v[136:139]
    v_mfma_f32_16x16x32_bf16 v[140:143], v[116:119], a[180:183], v[140:143]
    v_mfma_f32_16x16x32_bf16 v[144:147], v[60:63], a[184:187], v[144:147]
    v_mfma_f32_16x16x32_bf16 v[148:151], v[116:119], a[184:187], v[148:151]
    v_mfma_f32_16x16x32_bf16 v[152:155], v[60:63], a[188:191], v[152:155]
    v_mfma_f32_16x16x32_bf16 v[156:159], v[116:119], a[188:191], v[156:159]
    s_waitcnt vmcnt(6)
    v_mfma_f32_16x16x32_bf16 v[128:131], v[64:67], a[192:195], v[128:131]
    v_mfma_f32_16x16x32_bf16 v[132:135], v[120:123], a[192:195], v[132:135]
    v_mfma_f32_16x16x32_bf16 v[136:139], v[64:67], a[196:199], v[136:139]
    v_mfma_f32_16x16x32_bf16 v[140:143], v[120:123], a[196:199], v[140:143]
    v_mfma_f32_16x16x32_bf16 v[144:147], v[64:67], a[200:203], v[144:147]
    v_mfma_f32_16x16x32_bf16 v[148:151], v[120:123], a[200:203], v[148:151]
    v_mfma_f32_16x16x32_bf16 v[152:155], v[64:67], a[204:207], v[152:155]
    v_mfma_f32_16x16x32_bf16 v[156:159], v[120:123], a[204:207], v[156:159]
    s_waitcnt vmcnt(0)
    v_mfma_f32_16x16x32_bf16 v[128:131], v[68:71], a[208:211], v[128:131]
    v_mfma_f32_16x16x32_bf16 v[132:135], v[124:127], a[208:211], v[132:135]
    v_mfma_f32_16x16x32_bf16 v[136:139], v[68:71], a[212:215], v[136:139]
    v_mfma_f32_16x16x32_bf16 v[140:143], v[124:127], a[212:215], v[140:143]
    v_mfma_f32_16x16x32_bf16 v[144:147], v[68:71], a[216:219], v[144:147]
    v_mfma_f32_16x16x32_bf16 v[148:151], v[124:127], a[216:219], v[148:151]
    v_mfma_f32_16x16x32_bf16 v[152:155], v[68:71], a[220:223], v[152:155]
    v_mfma_f32_16x16x32_bf16 v[156:159], v[124:127], a[220:223], v[156:159]
    s_load_dwordx2 s[8:9], s[0:1], 152
    s_waitcnt lgkmcnt(0)
    s_add_u32 s8, s8, 37379072
    s_addc_u32 s9, s9, 0
    s_and_b32 s9, s9, 0xffff
    s_mov_b32 s10, 7569408
    s_mov_b32 s11, 0x20000
    s_lshl_b32 s20, s5, 5
    v_lshl_add_u32 v8, v3, 3, s20
    v_mul_u32_u24 v8, 3584, v8
    v_lshl_add_u32 v8, v5, 2, v8
    v_add_u32 v8, 229376, v8
    s_mul_i32 s20, s5, 3584
    v_lshlrev_b32 v9, 2, v5
    v_add_u32 v9, s20, v9
    v_mov_b32 v14, 0x7ffffff0
    v_cmp_eq_u32 vcc, 3, v3
    s_nop 1
    v_cndmask_b32 v9, v14, v9, vcc
    v_subrev_u32 v14, 16, v1
    v_lshlrev_b32 v14, 2, v14
    v_subrev_u32 v15, 32, v1
    v_lshlrev_b32 v15, 2, v15
    v_cmp_le_u32 s[38:39], 1, v3
    v_cmp_le_u32 s[50:51], 2, v3
    s_nop 7
    v_lshlrev_b32 v160, 16, v160
    v_lshlrev_b32 v161, 16, v161
    v_lshlrev_b32 v162, 16, v162
    v_mul_f32 v162, 0x3fb8aa3b, v162
    v_exp_f32 v162, v162
    s_nop 0
    v_cvt_pk_bf16_f32 v162, v162, v162
    v_lshlrev_b32 v162, 16, v162
    v_mul_f32 v20, v162, v160
    v_mul_f32 v21, v162, v161
    v_mul_f32 v20, 0x3fb8aa3b, v20
    v_mul_f32 v21, 0.15915494, v21
    v_exp_f32 v20, v20
    v_fract_f32 v21, v21
    s_nop 0
    v_cos_f32 v16, v21
    v_sin_f32 v17, v21
    s_nop 0
    v_mul_f32 v16, v20, v16
    v_mul_f32 v17, v20, v17
    v_add_f32 v20, -1.0, v16
    v_mul_f32 v21, v160, v160
    v_fma_f32 v21, v161, v161, v21
    v_rcp_f32 v21, v21
    v_mul_f32 v18, v20, v160
    v_fma_f32 v18, v17, v161, v18
    v_mul_f32 v19, v17, v160
    v_fma_f32 v19, -v20, v161, v19
    v_mul_f32 v18, v18, v21
    v_mul_f32 v19, v19, v21
    v_mul_f32 v20, v17, v17
    v_mul_f32 v21, v17, v16
    v_fma_f32 v25, v16, v17, v21
    v_fma_f32 v24, v16, v16, -v20
    v_mul_f32 v20, v25, v25
    v_mul_f32 v21, v25, v24
    v_fma_f32 v25, v24, v25, v21
    v_fma_f32 v24, v24, v24, -v20
    v_mul_f32 v20, v25, v25
    v_mul_f32 v21, v25, v24
    v_fma_f32 v25, v24, v25, v21
    v_fma_f32 v24, v24, v24, -v20
    v_mul_f32 v20, v25, v25
    v_mul_f32 v21, v25, v24
    v_fma_f32 v27, v24, v25, v21
    v_fma_f32 v26, v24, v24, -v20
    v_mul_f32 v20, v144, v19
    v_mul_f32 v21, v144, v18
    v_fma_f32 v144, v128, v19, v21
    v_fma_f32 v128, v128, v18, -v20
    v_mul_f32 v20, v145, v19
    v_mul_f32 v21, v145, v18
    v_fma_f32 v145, v129, v19, v21
    v_fma_f32 v129, v129, v18, -v20
    v_mul_f32 v20, v146, v19
    v_mul_f32 v21, v146, v18
    v_fma_f32 v146, v130, v19, v21
    v_fma_f32 v130, v130, v18, -v20
    v_mul_f32 v20, v147, v19
    v_mul_f32 v21, v147, v18
    v_fma_f32 v147, v131, v19, v21
    v_fma_f32 v131, v131, v18, -v20
    v_mul_f32 v20, v148, v19
    v_mul_f32 v21, v148, v18
    v_fma_f32 v148, v132, v19, v21
    v_fma_f32 v132, v132, v18, -v20
    v_mul_f32 v20, v149, v19
    v_mul_f32 v21, v149, v18
    v_fma_f32 v149, v133, v19, v21
    v_fma_f32 v133, v133, v18, -v20
    v_mul_f32 v20, v150, v19
    v_mul_f32 v21, v150, v18
    v_fma_f32 v150, v134, v19, v21
    v_fma_f32 v134, v134, v18, -v20
    v_mul_f32 v20, v151, v19
    v_mul_f32 v21, v151, v18
    v_fma_f32 v151, v135, v19, v21
    v_fma_f32 v135, v135, v18, -v20
    v_fma_f32 v20, -v144, v17, v129
    v_fma_f32 v21, v144, v16, v145
    v_fma_f32 v145, v128, v17, v21
    v_fma_f32 v129, v128, v16, v20
    v_fma_f32 v20, -v145, v17, v130
    v_fma_f32 v21, v145, v16, v146
    v_fma_f32 v146, v129, v17, v21
    v_fma_f32 v130, v129, v16, v20
    v_fma_f32 v20, -v146, v17, v131
    v_fma_f32 v21, v146, v16, v147
    v_fma_f32 v147, v130, v17, v21
    v_fma_f32 v131, v130, v16, v20
    v_fma_f32 v20, -v147, v17, v132
    v_fma_f32 v21, v147, v16, v148
    v_fma_f32 v148, v131, v17, v21
    v_fma_f32 v132, v131, v16, v20
    v_fma_f32 v20, -v148, v17, v133
    v_fma_f32 v21, v148, v16, v149
    v_fma_f32 v149, v132, v17, v21
    v_fma_f32 v133, v132, v16, v20
    v_fma_f32 v20, -v149, v17, v134
    v_fma_f32 v21, v149, v16, v150
    v_fma_f32 v150, v133, v17, v21
    v_fma_f32 v134, v133, v16, v20
    v_fma_f32 v20, -v150, v17, v135
    v_fma_f32 v21, v150, v16, v151
    v_fma_f32 v151, v134, v17, v21
    v_fma_f32 v135, v134, v16, v20
    v_mov_b32 v28, v135
    v_mov_b32 v29, v151
    ds_bpermute_b32 v30, v14, v28
    ds_bpermute_b32 v31, v14, v29
    s_waitcnt lgkmcnt(0)
    v_cndmask_b32 v30, 0, v30, s[38:39]
    v_cndmask_b32 v31, 0, v31, s[38:39]
    v_fma_f32 v20, -v31, v25, v28
    v_fma_f32 v21, v31, v24, v29
    v_fma_f32 v29, v30, v25, v21
    v_fma_f32 v28, v30, v24, v20
    ds_bpermute_b32 v30, v15, v28
    ds_bpermute_b32 v31, v15, v29
    s_waitcnt lgkmcnt(0)
    v_cndmask_b32 v30, 0, v30, s[50:51]
    v_cndmask_b32 v31, 0, v31, s[50:51]
    v_fma_f32 v20, -v31, v27, v28
    v_fma_f32 v21, v31, v26, v29
    v_fma_f32 v29, v30, v27, v21
    v_fma_f32 v28, v30, v26, v20
    buffer_store_dword v28, v9, s[8:11], 0 offen offset:0 sc1
    buffer_store_dword v29, v9, s[8:11], 0 offen offset:1792 sc1
    ds_bpermute_b32 v30, v14, v28
    ds_bpermute_b32 v31, v14, v29
    s_waitcnt lgkmcnt(0)
    v_cndmask_b32 v30, 0, v30, s[38:39]
    v_cndmask_b32 v31, 0, v31, s[38:39]
    v_mul_f32 v20, v31, v17
    v_mul_f32 v21, v31, v16
    v_fma_f32 v31, v30, v17, v21
    v_fma_f32 v30, v30, v16, -v20
    v_add_f32 v128, v128, v30
    v_add_f32 v144, v144, v31
    s_mov_b32 s20, 0
    buffer_store_dword v128, v8, s[8:11], s20 offen offset:0 sc1
    buffer_store_dword v144, v8, s[8:11], s20 offen offset:1792 sc1
    v_mul_f32 v20, v31, v17
    v_mul_f32 v21, v31, v16
    v_fma_f32 v31, v30, v17, v21
    v_fma_f32 v30, v30, v16, -v20
    v_add_f32 v129, v129, v30
    v_add_f32 v145, v145, v31
    s_mov_b32 s20, 3584
    buffer_store_dword v129, v8, s[8:11], s20 offen offset:0 sc1
    buffer_store_dword v145, v8, s[8:11], s20 offen offset:1792 sc1
    v_mul_f32 v20, v31, v17
    v_mul_f32 v21, v31, v16
    v_fma_f32 v31, v30, v17, v21
    v_fma_f32 v30, v30, v16, -v20
    v_add_f32 v130, v130, v30
    v_add_f32 v146, v146, v31
    s_mov_b32 s20, 7168
    buffer_store_dword v130, v8, s[8:11], s20 offen offset:0 sc1
    buffer_store_dword v146, v8, s[8:11], s20 offen offset:1792 sc1
    v_mul_f32 v20, v31, v17
    v_mul_f32 v21, v31, v16
    v_fma_f32 v31, v30, v17, v21
    v_fma_f32 v30, v30, v16, -v20
    v_add_f32 v131, v131, v30
    v_add_f32 v147, v147, v31
    s_mov_b32 s20, 10752
    buffer_store_dword v131, v8, s[8:11], s20 offen offset:0 sc1
    buffer_store_dword v147, v8, s[8:11], s20 offen offset:1792 sc1
    v_mul_f32 v20, v31, v17
    v_mul_f32 v21, v31, v16
    v_fma_f32 v31, v30, v17, v21
    v_fma_f32 v30, v30, v16, -v20
    v_add_f32 v132, v132, v30
    v_add_f32 v148, v148, v31
    s_mov_b32 s20, 14336
    buffer_store_dword v132, v8, s[8:11], s20 offen offset:0 sc1
    buffer_store_dword v148, v8, s[8:11], s20 offen offset:1792 sc1
    v_mul_f32 v20, v31, v17
    v_mul_f32 v21, v31, v16
    v_fma_f32 v31, v30, v17, v21
    v_fma_f32 v30, v30, v16, -v20
    v_add_f32 v133, v133, v30
    v_add_f32 v149, v149, v31
    s_mov_b32 s20, 17920
    buffer_store_dword v133, v8, s[8:11], s20 offen offset:0 sc1
    buffer_store_dword v149, v8, s[8:11], s20 offen offset:1792 sc1
    v_mul_f32 v20, v31, v17
    v_mul_f32 v21, v31, v16
    v_fma_f32 v31, v30, v17, v21
    v_fma_f32 v30, v30, v16, -v20
    v_add_f32 v134, v134, v30
    v_add_f32 v150, v150, v31
    s_mov_b32 s20, 21504
    buffer_store_dword v134, v8, s[8:11], s20 offen offset:0 sc1
    buffer_store_dword v150, v8, s[8:11], s20 offen offset:1792 sc1
    v_mul_f32 v20, v31, v17
    v_mul_f32 v21, v31, v16
    v_fma_f32 v31, v30, v17, v21
    v_fma_f32 v30, v30, v16, -v20
    v_add_f32 v135, v135, v30
    v_add_f32 v151, v151, v31
    s_mov_b32 s20, 25088
    buffer_store_dword v135, v8, s[8:11], s20 offen offset:0 sc1
    buffer_store_dword v151, v8, s[8:11], s20 offen offset:1792 sc1
    v_lshlrev_b32 v164, 16, v164
    v_lshlrev_b32 v165, 16, v165
    v_lshlrev_b32 v166, 16, v166
    v_mul_f32 v166, 0x3fb8aa3b, v166
    v_exp_f32 v166, v166
    s_nop 0
    v_cvt_pk_bf16_f32 v166, v166, v166
    v_lshlrev_b32 v166, 16, v166
    v_mul_f32 v20, v166, v164
    v_mul_f32 v21, v166, v165
    v_mul_f32 v20, 0x3fb8aa3b, v20
    v_mul_f32 v21, 0.15915494, v21
    v_exp_f32 v20, v20
    v_fract_f32 v21, v21
    s_nop 0
    v_cos_f32 v16, v21
    v_sin_f32 v17, v21
    s_nop 0
    v_mul_f32 v16, v20, v16
    v_mul_f32 v17, v20, v17
    v_add_f32 v20, -1.0, v16
    v_mul_f32 v21, v164, v164
    v_fma_f32 v21, v165, v165, v21
    v_rcp_f32 v21, v21
    v_mul_f32 v18, v20, v164
    v_fma_f32 v18, v17, v165, v18
    v_mul_f32 v19, v17, v164
    v_fma_f32 v19, -v20, v165, v19
    v_mul_f32 v18, v18, v21
    v_mul_f32 v19, v19, v21
    v_mul_f32 v20, v17, v17
    v_mul_f32 v21, v17, v16
    v_fma_f32 v25, v16, v17, v21
    v_fma_f32 v24, v16, v16, -v20
    v_mul_f32 v20, v25, v25
    v_mul_f32 v21, v25, v24
    v_fma_f32 v25, v24, v25, v21
    v_fma_f32 v24, v24, v24, -v20
    v_mul_f32 v20, v25, v25
    v_mul_f32 v21, v25, v24
    v_fma_f32 v25, v24, v25, v21
    v_fma_f32 v24, v24, v24, -v20
    v_mul_f32 v20, v25, v25
    v_mul_f32 v21, v25, v24
    v_fma_f32 v27, v24, v25, v21
    v_fma_f32 v26, v24, v24, -v20
    v_mul_f32 v20, v152, v19
    v_mul_f32 v21, v152, v18
    v_fma_f32 v152, v136, v19, v21
    v_fma_f32 v136, v136, v18, -v20
    v_mul_f32 v20, v153, v19
    v_mul_f32 v21, v153, v18
    v_fma_f32 v153, v137, v19, v21
    v_fma_f32 v137, v137, v18, -v20
    v_mul_f32 v20, v154, v19
    v_mul_f32 v21, v154, v18
    v_fma_f32 v154, v138, v19, v21
    v_fma_f32 v138, v138, v18, -v20
    v_mul_f32 v20, v155, v19
    v_mul_f32 v21, v155, v18
    v_fma_f32 v155, v139, v19, v21
    v_fma_f32 v139, v139, v18, -v20
    v_mul_f32 v20, v156, v19
    v_mul_f32 v21, v156, v18
    v_fma_f32 v156, v140, v19, v21
    v_fma_f32 v140, v140, v18, -v20
    v_mul_f32 v20, v157, v19
    v_mul_f32 v21, v157, v18
    v_fma_f32 v157, v141, v19, v21
    v_fma_f32 v141, v141, v18, -v20
    v_mul_f32 v20, v158, v19
    v_mul_f32 v21, v158, v18
    v_fma_f32 v158, v142, v19, v21
    v_fma_f32 v142, v142, v18, -v20
    v_mul_f32 v20, v159, v19
    v_mul_f32 v21, v159, v18
    v_fma_f32 v159, v143, v19, v21
    v_fma_f32 v143, v143, v18, -v20
    v_fma_f32 v20, -v152, v17, v137
    v_fma_f32 v21, v152, v16, v153
    v_fma_f32 v153, v136, v17, v21
    v_fma_f32 v137, v136, v16, v20
    v_fma_f32 v20, -v153, v17, v138
    v_fma_f32 v21, v153, v16, v154
    v_fma_f32 v154, v137, v17, v21
    v_fma_f32 v138, v137, v16, v20
    v_fma_f32 v20, -v154, v17, v139
    v_fma_f32 v21, v154, v16, v155
    v_fma_f32 v155, v138, v17, v21
    v_fma_f32 v139, v138, v16, v20
    v_fma_f32 v20, -v155, v17, v140
    v_fma_f32 v21, v155, v16, v156
    v_fma_f32 v156, v139, v17, v21
    v_fma_f32 v140, v139, v16, v20
    v_fma_f32 v20, -v156, v17, v141
    v_fma_f32 v21, v156, v16, v157
    v_fma_f32 v157, v140, v17, v21
    v_fma_f32 v141, v140, v16, v20
    v_fma_f32 v20, -v157, v17, v142
    v_fma_f32 v21, v157, v16, v158
    v_fma_f32 v158, v141, v17, v21
    v_fma_f32 v142, v141, v16, v20
    v_fma_f32 v20, -v158, v17, v143
    v_fma_f32 v21, v158, v16, v159
    v_fma_f32 v159, v142, v17, v21
    v_fma_f32 v143, v142, v16, v20
    v_mov_b32 v28, v143
    v_mov_b32 v29, v159
    ds_bpermute_b32 v30, v14, v28
    ds_bpermute_b32 v31, v14, v29
    s_waitcnt lgkmcnt(0)
    v_cndmask_b32 v30, 0, v30, s[38:39]
    v_cndmask_b32 v31, 0, v31, s[38:39]
    v_fma_f32 v20, -v31, v25, v28
    v_fma_f32 v21, v31, v24, v29
    v_fma_f32 v29, v30, v25, v21
    v_fma_f32 v28, v30, v24, v20
    ds_bpermute_b32 v30, v15, v28
    ds_bpermute_b32 v31, v15, v29
    s_waitcnt lgkmcnt(0)
    v_cndmask_b32 v30, 0, v30, s[50:51]
    v_cndmask_b32 v31, 0, v31, s[50:51]
    v_fma_f32 v20, -v31, v27, v28
    v_fma_f32 v21, v31, v26, v29
    v_fma_f32 v29, v30, v27, v21
    v_fma_f32 v28, v30, v26, v20
    buffer_store_dword v28, v9, s[8:11], 0 offen offset:64 sc1
    buffer_store_dword v29, v9, s[8:11], 0 offen offset:1856 sc1
    ds_bpermute_b32 v30, v14, v28
    ds_bpermute_b32 v31, v14, v29
    s_waitcnt lgkmcnt(0)
    v_cndmask_b32 v30, 0, v30, s[38:39]
    v_cndmask_b32 v31, 0, v31, s[38:39]
    v_mul_f32 v20, v31, v17
    v_mul_f32 v21, v31, v16
    v_fma_f32 v31, v30, v17, v21
    v_fma_f32 v30, v30, v16, -v20
    v_add_f32 v136, v136, v30
    v_add_f32 v152, v152, v31
    s_mov_b32 s20, 0
    buffer_store_dword v136, v8, s[8:11], s20 offen offset:64 sc1
    buffer_store_dword v152, v8, s[8:11], s20 offen offset:1856 sc1
    v_mul_f32 v20, v31, v17
    v_mul_f32 v21, v31, v16
    v_fma_f32 v31, v30, v17, v21
    v_fma_f32 v30, v30, v16, -v20
    v_add_f32 v137, v137, v30
    v_add_f32 v153, v153, v31
    s_mov_b32 s20, 3584
    buffer_store_dword v137, v8, s[8:11], s20 offen offset:64 sc1
    buffer_store_dword v153, v8, s[8:11], s20 offen offset:1856 sc1
    v_mul_f32 v20, v31, v17
    v_mul_f32 v21, v31, v16
    v_fma_f32 v31, v30, v17, v21
    v_fma_f32 v30, v30, v16, -v20
    v_add_f32 v138, v138, v30
    v_add_f32 v154, v154, v31
    s_mov_b32 s20, 7168
    buffer_store_dword v138, v8, s[8:11], s20 offen offset:64 sc1
    buffer_store_dword v154, v8, s[8:11], s20 offen offset:1856 sc1
    v_mul_f32 v20, v31, v17
    v_mul_f32 v21, v31, v16
    v_fma_f32 v31, v30, v17, v21
    v_fma_f32 v30, v30, v16, -v20
    v_add_f32 v139, v139, v30
    v_add_f32 v155, v155, v31
    s_mov_b32 s20, 10752
    buffer_store_dword v139, v8, s[8:11], s20 offen offset:64 sc1
    buffer_store_dword v155, v8, s[8:11], s20 offen offset:1856 sc1
    v_mul_f32 v20, v31, v17
    v_mul_f32 v21, v31, v16
    v_fma_f32 v31, v30, v17, v21
    v_fma_f32 v30, v30, v16, -v20
    v_add_f32 v140, v140, v30
    v_add_f32 v156, v156, v31
    s_mov_b32 s20, 14336
    buffer_store_dword v140, v8, s[8:11], s20 offen offset:64 sc1
    buffer_store_dword v156, v8, s[8:11], s20 offen offset:1856 sc1
    v_mul_f32 v20, v31, v17
    v_mul_f32 v21, v31, v16
    v_fma_f32 v31, v30, v17, v21
    v_fma_f32 v30, v30, v16, -v20
    v_add_f32 v141, v141, v30
    v_add_f32 v157, v157, v31
    s_mov_b32 s20, 17920
    buffer_store_dword v141, v8, s[8:11], s20 offen offset:64 sc1
    buffer_store_dword v157, v8, s[8:11], s20 offen offset:1856 sc1
    v_mul_f32 v20, v31, v17
    v_mul_f32 v21, v31, v16
    v_fma_f32 v31, v30, v17, v21
    v_fma_f32 v30, v30, v16, -v20
    v_add_f32 v142, v142, v30
    v_add_f32 v158, v158, v31
    s_mov_b32 s20, 21504
    buffer_store_dword v142, v8, s[8:11], s20 offen offset:64 sc1
    buffer_store_dword v158, v8, s[8:11], s20 offen offset:1856 sc1
    v_mul_f32 v20, v31, v17
    v_mul_f32 v21, v31, v16
    v_fma_f32 v31, v30, v17, v21
    v_fma_f32 v30, v30, v16, -v20
    v_add_f32 v143, v143, v30
    v_add_f32 v159, v159, v31
    s_mov_b32 s20, 25088
    buffer_store_dword v143, v8, s[8:11], s20 offen offset:64 sc1
    buffer_store_dword v159, v8, s[8:11], s20 offen offset:1856 sc1
    s_branch wk_loop
wk_n2:
    s_cmp_lt_u32 s40, 736
    s_cbranch_scc0 wk_n3
    s_sub_u32 s40, s40, 480
    s_lshr_b32 s41, s40, 4
    s_lshl_b32 s41, s41, 2
    s_add_u32 s41, s41, 128
    s_mov_b32 s53, 65536
    s_lshr_b32 s20, s40, 4
    v_lshlrev_b32 v32, 2, v2
    v_add_u32 v32, 128, v32
    v_cmp_ge_u32 s[22:23], s20, v2
    s_mov_b32 s35, 2000000
wk_wa:
    global_load_dword v33, v32, s[42:43] sc1
    s_waitcnt vmcnt(0)
    v_bfe_u32 v33, v33, 8, 8
    v_cmp_gt_u32 vcc, 14, v33
    s_and_b64 vcc, vcc, s[22:23]
    s_cbranch_vccz wk_ga
    s_sleep 2
    s_cmp_eq_u32 s20, 15
    s_cbranch_scc1 wk_sa
    s_sleep 40
    wk_sa:
    s_sub_u32 s35, s35, 1
    s_cmp_lg_u32 s35, 0
    s_cbranch_scc1 wk_wa
    s_branch chain_end
wk_ga:
    s_lshr_b32 s5, s40, 2
    s_and_b32 s4, s40, 3
    s_load_dwordx2 s[8:9], s[0:1], 152
    s_waitcnt lgkmcnt(0)
    s_add_u32 s8, s8, 37379072
    s_addc_u32 s9, s9, 0
    s_and_b32 s9, s9, 0xffff
    s_mov_b32 s10, 7569408
    s_mov_b32 s11, 0x20000
    s_cmp_lt_u32 s3, 2
    s_cselect_b32 s20, 40, 48
    s_load_dwordx2 s[12:13], s[0:1], s20
    s_waitcnt lgkmcnt(0)
    s_and_b32 s13, s13, 0xffff
    s_mov_b32 s14, 401408
    s_mov_b32 s15, 0x20000
    s_load_dwordx2 s[44:45], s[0:1], 8
    s_load_dwordx2 s[46:47], s[0:1], 16
    s_load_dwordx2 s[48:49], s[0:1], 56
    s_waitcnt lgkmcnt(0)
    s_mul_i32 s20, s4, 112
    v_add_u32 v4, s20, v2
    v_mul_u32_u24 v4, 896, v4
    v_lshl_add_u32 v4, v3, 4, v4
    s_and_b32 s21, s3, 1
    s_mul_i32 s21, s21, 448
    v_add_u32 v4, s21, v4
    v_min_u32 v5, 223, v0
    v_lshlrev_b32 v6, 2, v5
    v_add_u32 v7, 2, v6
    global_load_ushort v16, v6, s[44:45]
    global_load_ushort v17, v6, s[46:47]
    global_load_ushort v18, v6, s[48:49]
    global_load_ushort v20, v7, s[44:45]
    global_load_ushort v21, v7, s[46:47]
    global_load_ushort v22, v7, s[48:49]
    v_lshlrev_b32 v8, 3, v5
    s_mul_i32 s20, s5, 114688
    v_add_u32 v9, s20, v8
    v_add_u32 v9, 229376, v9
    s_mov_b32 s20, 0
    buffer_load_dwordx2 v[64:65], v9, s[8:11], s20 offen sc1
    buffer_load_dwordx2 v[66:67], v9, s[8:11], s20 offen offset:1792 sc1
    s_mov_b32 s20, 3584
    buffer_load_dwordx2 v[68:69], v9, s[8:11], s20 offen sc1
    buffer_load_dwordx2 v[70:71], v9, s[8:11], s20 offen offset:1792 sc1
    s_mov_b32 s20, 7168
    buffer_load_dwordx2 v[72:73], v9, s[8:11], s20 offen sc1
    buffer_load_dwordx2 v[74:75], v9, s[8:11], s20 offen offset:1792 sc1
    s_mov_b32 s20, 10752
    buffer_load_dwordx2 v[76:77], v9, s[8:11], s20 offen sc1
    buffer_load_dwordx2 v[78:79], v9, s[8:11], s20 offen offset:1792 sc1
    s_mov_b32 s20, 14336
    buffer_load_dwordx2 v[80:81], v9, s[8:11], s20 offen sc1
    buffer_load_dwordx2 v[82:83], v9, s[8:11], s20 offen offset:1792 sc1
    s_mov_b32 s20, 17920
    buffer_load_dwordx2 v[84:85], v9, s[8:11], s20 offen sc1
    buffer_load_dwordx2 v[86:87], v9, s[8:11], s20 offen offset:1792 sc1
    s_mov_b32 s20, 21504
    buffer_load_dwordx2 v[88:89], v9, s[8:11], s20 offen sc1
    buffer_load_dwordx2 v[90:91], v9, s[8:11], s20 offen offset:1792 sc1
    s_mov_b32 s20, 25088
    buffer_load_dwordx2 v[92:93], v9, s[8:11], s20 offen sc1
    buffer_load_dwordx2 v[94:95], v9, s[8:11], s20 offen offset:1792 sc1
    s_mov_b32 s20, 28672
    buffer_load_dwordx2 v[96:97], v9, s[8:11], s20 offen sc1
    buffer_load_dwordx2 v[98:99], v9, s[8:11], s20 offen offset:1792 sc1
    s_mov_b32 s20, 32256
    buffer_load_dwordx2 v[100:101], v9, s[8:11], s20 offen sc1
    buffer_load_dwordx2 v[102:103], v9, s[8:11], s20 offen offset:1792 sc1
    s_mov_b32 s20, 35840
    buffer_load_dwordx2 v[104:105], v9, s[8:11], s20 offen sc1
    buffer_load_dwordx2 v[106:107], v9, s[8:11], s20 offen offset:1792 sc1
    s_mov_b32 s20, 39424
    buffer_load_dwordx2 v[108:109], v9, s[8:11], s20 offen sc1
    buffer_load_dwordx2 v[110:111], v9, s[8:11], s20 offen offset:1792 sc1
    s_mov_b32 s20, 43008
    buffer_load_dwordx2 v[112:113], v9, s[8:11], s20 offen sc1
    buffer_load_dwordx2 v[114:115], v9, s[8:11], s20 offen offset:1792 sc1
    s_mov_b32 s20, 46592
    buffer_load_dwordx2 v[116:117], v9, s[8:11], s20 offen sc1
    buffer_load_dwordx2 v[118:119], v9, s[8:11], s20 offen offset:1792 sc1
    s_mov_b32 s20, 50176
    buffer_load_dwordx2 v[120:121], v9, s[8:11], s20 offen sc1
    buffer_load_dwordx2 v[122:123], v9, s[8:11], s20 offen offset:1792 sc1
    s_mov_b32 s20, 53760
    buffer_load_dwordx2 v[124:125], v9, s[8:11], s20 offen sc1
    buffer_load_dwordx2 v[126:127], v9, s[8:11], s20 offen offset:1792 sc1
    s_mov_b32 s20, 57344
    buffer_load_dwordx2 v[128:129], v9, s[8:11], s20 offen sc1
    buffer_load_dwordx2 v[130:131], v9, s[8:11], s20 offen offset:1792 sc1
    s_mov_b32 s20, 60928
    buffer_load_dwordx2 v[132:133], v9, s[8:11], s20 offen sc1
    buffer_load_dwordx2 v[134:135], v9, s[8:11], s20 offen offset:1792 sc1
    s_mov_b32 s20, 64512
    buffer_load_dwordx2 v[136:137], v9, s[8:11], s20 offen sc1
    buffer_load_dwordx2 v[138:139], v9, s[8:11], s20 offen offset:1792 sc1
    s_mov_b32 s20, 68096
    buffer_load_dwordx2 v[140:141], v9, s[8:11], s20 offen sc1
    buffer_load_dwordx2 v[142:143], v9, s[8:11], s20 offen offset:1792 sc1
    s_mov_b32 s20, 71680
    buffer_load_dwordx2 v[144:145], v9, s[8:11], s20 offen sc1
    buffer_load_dwordx2 v[146:147], v9, s[8:11], s20 offen offset:1792 sc1
    s_mov_b32 s20, 75264
    buffer_load_dwordx2 v[148:149], v9, s[8:11], s20 offen sc1
    buffer_load_dwordx2 v[150:151], v9, s[8:11], s20 offen offset:1792 sc1
    s_mov_b32 s20, 78848
    buffer_load_dwordx2 v[152:153], v9, s[8:11], s20 offen sc1
    buffer_load_dwordx2 v[154:155], v9, s[8:11], s20 offen offset:1792 sc1
    s_mov_b32 s20, 82432
    buffer_load_dwordx2 v[156:157], v9, s[8:11], s20 offen sc1
    buffer_load_dwordx2 v[158:159], v9, s[8:11], s20 offen offset:1792 sc1
    s_mov_b32 s20, 86016
    buffer_load_dwordx2 v[160:161], v9, s[8:11], s20 offen sc1
    buffer_load_dwordx2 v[162:163], v9, s[8:11], s20 offen offset:1792 sc1
    s_mov_b32 s20, 89600
    buffer_load_dwordx2 v[164:165], v9, s[8:11], s20 offen sc1
    buffer_load_dwordx2 v[166:167], v9, s[8:11], s20 offen offset:1792 sc1
    s_mov_b32 s20, 93184
    buffer_load_dwordx2 v[168:169], v9, s[8:11], s20 offen sc1
    buffer_load_dwordx2 v[170:171], v9, s[8:11], s20 offen offset:1792 sc1
    s_mov_b32 s20, 96768
    buffer_load_dwordx2 v[172:173], v9, s[8:11], s20 offen sc1
    buffer_load_dwordx2 v[174:175], v9, s[8:11], s20 offen offset:1792 sc1
    s_mov_b32 s20, 100352
    buffer_load_dwordx2 v[176:177], v9, s[8:11], s20 offen sc1
    buffer_load_dwordx2 v[178:179], v9, s[8:11], s20 offen offset:1792 sc1
    s_mov_b32 s20, 103936
    buffer_load_dwordx2 v[180:181], v9, s[8:11], s20 offen sc1
    buffer_load_dwordx2 v[182:183], v9, s[8:11], s20 offen offset:1792 sc1
    s_mov_b32 s20, 107520
    buffer_load_dwordx2 v[184:185], v9, s[8:11], s20 offen sc1
    buffer_load_dwordx2 v[186:187], v9, s[8:11], s20 offen offset:1792 sc1
    s_mov_b32 s20, 111104
    buffer_load_dwordx2 v[188:189], v9, s[8:11], s20 offen sc1
    buffer_load_dwordx2 v[190:191], v9, s[8:11], s20 offen offset:1792 sc1
    s_mov_b32 s20, 0
    buffer_load_dwordx4 a[0:3], v4, s[12:15], s20 offen offset:0
    s_mov_b32 s20, 0
    buffer_load_dwordx4 a[4:7], v4, s[12:15], s20 offen offset:64
    s_mov_b32 s20, 0
    buffer_load_dwordx4 a[8:11], v4, s[12:15], s20 offen offset:128
    s_mov_b32 s20, 0
    buffer_load_dwordx4 a[12:15], v4, s[12:15], s20 offen offset:192
    s_mov_b32 s20, 0
    buffer_load_dwordx4 a[16:19], v4, s[12:15], s20 offen offset:256
    s_mov_b32 s20, 0
    buffer_load_dwordx4 a[20:23], v4, s[12:15], s20 offen offset:320
    s_mov_b32 s20, 0
    buffer_load_dwordx4 a[24:27], v4, s[12:15], s20 offen offset:384
    s_mov_b32 s20, 14336
    buffer_load_dwordx4 a[28:31], v4, s[12:15], s20 offen offset:0
    s_mov_b32 s20, 14336
    buffer_load_dwordx4 a[32:35], v4, s[12:15], s20 offen offset:64
    s_mov_b32 s20, 14336
    buffer_load_dwordx4 a[36:39], v4, s[12:15], s20 offen offset:128
    s_mov_b32 s20, 14336
    buffer_load_dwordx4 a[40:43], v4, s[12:15], s20 offen offset:192
    s_mov_b32 s20, 14336
    buffer_load_dwordx4 a[44:47], v4, s[12:15], s20 offen offset:256
    s_mov_b32 s20, 14336
    buffer_load_dwordx4 a[48:51], v4, s[12:15], s20 offen offset:320
    s_mov_b32 s20, 14336
    buffer_load_dwordx4 a[52:55], v4, s[12:15], s20 offen offset:384
    s_mov_b32 s20, 28672
    buffer_load_dwordx4 a[56:59], v4, s[12:15], s20 offen offset:0
    s_mov_b32 s20, 28672
    buffer_load_dwordx4 a[60:63], v4, s[12:15], s20 offen offset:64
    s_mov_b32 s20, 28672
    buffer_load_dwordx4 a[64:67], v4, s[12:15], s20 offen offset:128
    s_mov_b32 s20, 28672
    buffer_load_dwordx4 a[68:71], v4, s[12:15], s20 offen offset:192
    s_mov_b32 s20, 28672
    buffer_load_dwordx4 a[72:75], v4, s[12:15], s20 offen offset:256
    s_mov_b32 s20, 28672
    buffer_load_dwordx4 a[76:79], v4, s[12:15], s20 offen offset:320
    s_mov_b32 s20, 28672
    buffer_load_dwordx4 a[80:83], v4, s[12:15], s20 offen offset:384
    s_mov_b32 s20, 43008
    buffer_load_dwordx4 a[84:87], v4, s[12:15], s20 offen offset:0
    s_mov_b32 s20, 43008
    buffer_load_dwordx4 a[88:91], v4, s[12:15], s20 offen offset:64
    s_mov_b32 s20, 43008
    buffer_load_dwordx4 a[92:95], v4, s[12:15], s20 offen offset:128
    s_mov_b32 s20, 43008
    buffer_load_dwordx4 a[96:99], v4, s[12:15], s20 offen offset:192
    s_mov_b32 s20, 43008
    buffer_load_dwordx4 a[100:103], v4, s[12:15], s20 offen offset:256
    s_mov_b32 s20, 43008
    buffer_load_dwordx4 a[104:107], v4, s[12:15], s20 offen offset:320
    s_mov_b32 s20, 43008
    buffer_load_dwordx4 a[108:111], v4, s[12:15], s20 offen offset:384
    s_mov_b32 s20, 57344
    buffer_load_dwordx4 a[112:115], v4, s[12:15], s20 offen offset:0
    s_mov_b32 s20, 57344
    buffer_load_dwordx4 a[116:119], v4, s[12:15], s20 offen offset:64
    s_mov_b32 s20, 57344
    buffer_load_dwordx4 a[120:123], v4, s[12:15], s20 offen offset:128
    s_mov_b32 s20, 57344
    buffer_load_dwordx4 a[124:127], v4, s[12:15], s20 offen offset:192
    s_mov_b32 s20, 57344
    buffer_load_dwordx4 a[128:131], v4, s[12:15], s20 offen offset:256
    s_mov_b32 s20, 57344
    buffer_load_dwordx4 a[132:135], v4, s[12:15], s20 offen offset:320
    s_mov_b32 s20, 57344
    buffer_load_dwordx4 a[136:139], v4, s[12:15], s20 offen offset:384
    s_mov_b32 s20, 71680
    buffer_load_dwordx4 a[140:143], v4, s[12:15], s20 offen offset:0
    s_mov_b32 s20, 71680
    buffer_load_dwordx4 a[144:147], v4, s[12:15], s20 offen offset:64
    s_mov_b32 s20, 71680
    buffer_load_dwordx4 a[148:151], v4, s[12:15], s20 offen offset:128
    s_mov_b32 s20, 71680
    buffer_load_dwordx4 a[152:155], v4, s[12:15], s20 offen offset:192
    s_mov_b32 s20, 71680
    buffer_load_dwordx4 a[156:159], v4, s[12:15], s20 offen offset:256
    s_mov_b32 s20, 71680
    buffer_load_dwordx4 a[160:163], v4, s[12:15], s20 offen offset:320
    s_mov_b32 s20, 71680
    buffer_load_dwordx4 a[164:167], v4, s[12:15], s20 offen offset:384
    s_mov_b32 s20, 86016
    buffer_load_dwordx4 a[168:171], v4, s[12:15], s20 offen offset:0
    s_mov_b32 s20, 86016
    buffer_load_dwordx4 a[172:175], v4, s[12:15], s20 offen offset:64
    s_mov_b32 s20, 86016
    buffer_load_dwordx4 a[176:179], v4, s[12:15], s20 offen offset:128
    s_mov_b32 s20, 86016
    buffer_load_dwordx4 a[180:183], v4, s[12:15], s20 offen offset:192
    s_mov_b32 s20, 86016
    buffer_load_dwordx4 a[184:187], v4, s[12:15], s20 offen offset:256
    s_mov_b32 s20, 86016
    buffer_load_dwordx4 a[188:191], v4, s[12:15], s20 offen offset:320
    s_mov_b32 s20, 86016
    buffer_load_dwordx4 a[192:195], v4, s[12:15], s20 offen offset:384
    s_waitcnt vmcnt(63)
    v_lshlrev_b32 v16, 16, v16
    v_lshlrev_b32 v17, 16, v17
    v_lshlrev_b32 v18, 16, v18
    v_mul_f32 v18, 0x3fb8aa3b, v18
    v_exp_f32 v18, v18
    s_nop 0
    v_cvt_pk_bf16_f32 v18, v18, v18
    v_lshlrev_b32 v18, 16, v18
    v_mul_f32 v24, v18, v16
    v_mul_f32 v25, v18, v17
    v_mul_f32 v24, 0x3fb8aa3b, v24
    v_mul_f32 v25, 0.15915494, v25
    v_exp_f32 v24, v24
    v_fract_f32 v25, v25
    s_nop 0
    v_cos_f32 v28, v25
    v_sin_f32 v29, v25
    s_nop 0
    v_mul_f32 v28, v24, v28
    v_mul_f32 v29, v24, v29
    v_lshlrev_b32 v20, 16, v20
    v_lshlrev_b32 v21, 16, v21
    v_lshlrev_b32 v22, 16, v22
    v_mul_f32 v22, 0x3fb8aa3b, v22
    v_exp_f32 v22, v22
    s_nop 0
    v_cvt_pk_bf16_f32 v22, v22, v22
    v_lshlrev_b32 v22, 16, v22
    v_mul_f32 v24, v22, v20
    v_mul_f32 v25, v22, v21
    v_mul_f32 v24, 0x3fb8aa3b, v24
    v_mul_f32 v25, 0.15915494, v25
    v_exp_f32 v24, v24
    v_fract_f32 v25, v25
    s_nop 0
    v_cos_f32 v30, v25
    v_sin_f32 v31, v25
    s_nop 0
    v_mul_f32 v30, v24, v30
    v_mul_f32 v31, v24, v31
    v_mul_f32 v24, v29, v29
    v_mul_f32 v25, v29, v28
    v_fma_f32 v33, v28, v29, v25
    v_fma_f32 v32, v28, v28, -v24
    v_mul_f32 v24, v33, v33
    v_mul_f32 v25, v33, v32
    v_fma_f32 v33, v32, v33, v25
    v_fma_f32 v32, v32, v32, -v24
    v_mul_f32 v24, v33, v33
    v_mul_f32 v25, v33, v32
    v_fma_f32 v33, v32, v33, v25
    v_fma_f32 v32, v32, v32, -v24
    v_mul_f32 v24, v33, v33
    v_mul_f32 v25, v33, v32
    v_fma_f32 v33, v32, v33, v25
    v_fma_f32 v32, v32, v32, -v24
    v_mul_f32 v24, v33, v33
    v_mul_f32 v25, v33, v32
    v_fma_f32 v33, v32, v33, v25
    v_fma_f32 v32, v32, v32, -v24
    v_mul_f32 v24, v31, v31
    v_mul_f32 v25, v31, v30
    v_fma_f32 v35, v30, v31, v25
    v_fma_f32 v34, v30, v30, -v24
    v_mul_f32 v24, v35, v35
    v_mul_f32 v25, v35, v34
    v_fma_f32 v35, v34, v35, v25
    v_fma_f32 v34, v34, v34, -v24
    v_mul_f32 v24, v35, v35
    v_mul_f32 v25, v35, v34
    v_fma_f32 v35, v34, v35, v25
    v_fma_f32 v34, v34, v34, -v24
    v_mul_f32 v24, v35, v35
    v_mul_f32 v25, v35, v34
    v_fma_f32 v35, v34, v35, v25
    v_fma_f32 v34, v34, v34, -v24
    v_mul_f32 v24, v35, v35
    v_mul_f32 v25, v35, v34
    v_fma_f32 v35, v34, v35, v25
    v_fma_f32 v34, v34, v34, -v24
    v_mov_b32 v36, 0
    v_mov_b32 v37, 0
    v_mov_b32 v38, 0
    v_mov_b32 v39, 0
    s_cmp_le_u32 s5, 48
    s_cbranch_scc1 wb_h3
    s_sub_u32 s20, s5, 64
    s_max_i32 s20, s20, 0
    s_mul_i32 s20, s20, 3584
    buffer_load_dwordx2 v[252:253], v8, s[8:11], s20 offen sc1
    buffer_load_dwordx2 v[254:255], v8, s[8:11], s20 offen offset:1792 sc1
    s_sub_u32 s20, s5, 63
    s_max_i32 s20, s20, 0
    s_mul_i32 s20, s20, 3584
    buffer_load_dwordx2 v[248:249], v8, s[8:11], s20 offen sc1
    buffer_load_dwordx2 v[250:251], v8, s[8:11], s20 offen offset:1792 sc1
    s_sub_u32 s20, s5, 62
    s_max_i32 s20, s20, 0
    s_mul_i32 s20, s20, 3584
    buffer_load_dwordx2 v[244:245], v8, s[8:11], s20 offen sc1
    buffer_load_dwordx2 v[246:247], v8, s[8:11], s20 offen offset:1792 sc1
    s_sub_u32 s20, s5, 61
    s_max_i32 s20, s20, 0
    s_mul_i32 s20, s20, 3584
    buffer_load_dwordx2 v[240:241], v8, s[8:11], s20 offen sc1
    buffer_load_dwordx2 v[242:243], v8, s[8:11], s20 offen offset:1792 sc1
    s_sub_u32 s20, s5, 60
    s_max_i32 s20, s20, 0
    s_mul_i32 s20, s20, 3584
    buffer_load_dwordx2 v[236:237], v8, s[8:11], s20 offen sc1
    buffer_load_dwordx2 v[238:239], v8, s[8:11], s20 offen offset:1792 sc1
    s_sub_u32 s20, s5, 59
    s_max_i32 s20, s20, 0
    s_mul_i32 s20, s20, 3584
    buffer_load_dwordx2 v[232:233], v8, s[8:11], s20 offen sc1
    buffer_load_dwordx2 v[234:235], v8, s[8:11], s20 offen offset:1792 sc1
    s_sub_u32 s20, s5, 58
    s_max_i32 s20, s20, 0
    s_mul_i32 s20, s20, 3584
    buffer_load_dwordx2 v[228:229], v8, s[8:11], s20 offen sc1
    buffer_load_dwordx2 v[230:231], v8, s[8:11], s20 offen offset:1792 sc1
    s_sub_u32 s20, s5, 57
    s_max_i32 s20, s20, 0
    s_mul_i32 s20, s20, 3584
    buffer_load_dwordx2 v[224:225], v8, s[8:11], s20 offen sc1
    buffer_load_dwordx2 v[226:227], v8, s[8:11], s20 offen offset:1792 sc1
    s_sub_u32 s20, s5, 56
    s_max_i32 s20, s20, 0
    s_mul_i32 s20, s20, 3584
    buffer_load_dwordx2 v[220:221], v8, s[8:11], s20 offen sc1
    buffer_load_dwordx2 v[222:223], v8, s[8:11], s20 offen offset:1792 sc1
    s_sub_u32 s20, s5, 55
    s_max_i32 s20, s20, 0
    s_mul_i32 s20, s20, 3584
    buffer_load_dwordx2 v[216:217], v8, s[8:11], s20 offen sc1
    buffer_load_dwordx2 v[218:219], v8, s[8:11], s20 offen offset:1792 sc1
    s_sub_u32 s20, s5, 54
    s_max_i32 s20, s20, 0
    s_mul_i32 s20, s20, 3584
    buffer_load_dwordx2 v[212:213], v8, s[8:11], s20 offen sc1
    buffer_load_dwordx2 v[214:215], v8, s[8:11], s20 offen offset:1792 sc1
    s_sub_u32 s20, s5, 53
    s_max_i32 s20, s20, 0
    s_mul_i32 s20, s20, 3584
    buffer_load_dwordx2 v[208:209], v8, s[8:11], s20 offen sc1
    buffer_load_dwordx2 v[210:211], v8, s[8:11], s20 offen offset:1792 sc1
    s_sub_u32 s20, s5, 52
    s_max_i32 s20, s20, 0
    s_mul_i32 s20, s20, 3584
    buffer_load_dwordx2 v[204:205], v8, s[8:11], s20 offen sc1
    buffer_load_dwordx2 v[206:207], v8, s[8:11], s20 offen offset:1792 sc1
    s_sub_u32 s20, s5, 51
    s_max_i32 s20, s20, 0
    s_mul_i32 s20, s20, 3584
    buffer_load_dwordx2 v[200:201], v8, s[8:11], s20 offen sc1
    buffer_load_dwordx2 v[202:203], v8, s[8:11], s20 offen offset:1792 sc1
    s_sub_u32 s20, s5, 50
    s_max_i32 s20, s20, 0
    s_mul_i32 s20, s20, 3584
    buffer_load_dwordx2 v[196:197], v8, s[8:11], s20 offen sc1
    buffer_load_dwordx2 v[198:199], v8, s[8:11], s20 offen offset:1792 sc1
    s_sub_u32 s20, s5, 49
    s_max_i32 s20, s20, 0
    s_mul_i32 s20, s20, 3584
    buffer_load_dwordx2 v[192:193], v8, s[8:11], s20 offen sc1
    buffer_load_dwordx2 v[194:195], v8, s[8:11], s20 offen offset:1792 sc1
    s_waitcnt vmcnt(0)
    s_cmp_gt_u32 s5, 63
    s_cselect_b32 s20, 1.0, 0
    v_mul_f32 v252, s20, v252
    v_mul_f32 v254, s20, v254
    v_fma_f32 v24, -v37, v33, v252
    v_fma_f32 v25, v37, v32, v254
    v_fma_f32 v37, v36, v33, v25
    v_fma_f32 v36, v36, v32, v24
    v_mul_f32 v253, s20, v253
    v_mul_f32 v255, s20, v255
    v_fma_f32 v24, -v39, v35, v253
    v_fma_f32 v25, v39, v34, v255
    v_fma_f32 v39, v38, v35, v25
    v_fma_f32 v38, v38, v34, v24
    s_cmp_gt_u32 s5, 62
    s_cselect_b32 s20, 1.0, 0
    v_mul_f32 v248, s20, v248
    v_mul_f32 v250, s20, v250
    v_fma_f32 v24, -v37, v33, v248
    v_fma_f32 v25, v37, v32, v250
    v_fma_f32 v37, v36, v33, v25
    v_fma_f32 v36, v36, v32, v24
    v_mul_f32 v249, s20, v249
    v_mul_f32 v251, s20, v251
    v_fma_f32 v24, -v39, v35, v249
    v_fma_f32 v25, v39, v34, v251
    v_fma_f32 v39, v38, v35, v25
    v_fma_f32 v38, v38, v34, v24
    s_cmp_gt_u32 s5, 61
    s_cselect_b32 s20, 1.0, 0
    v_mul_f32 v244, s20, v244
    v_mul_f32 v246, s20, v246
    v_fma_f32 v24, -v37, v33, v244
    v_fma_f32 v25, v37, v32, v246
    v_fma_f32 v37, v36, v33, v25
    v_fma_f32 v36, v36, v32, v24
    v_mul_f32 v245, s20, v245
    v_mul_f32 v247, s20, v247
    v_fma_f32 v24, -v39, v35, v245
    v_fma_f32 v25, v39, v34, v247
    v_fma_f32 v39, v38, v35, v25
    v_fma_f32 v38, v38, v34, v24
    s_cmp_gt_u32 s5, 60
    s_cselect_b32 s20, 1.0, 0
    v_mul_f32 v240, s20, v240
    v_mul_f32 v242, s20, v242
    v_fma_f32 v24, -v37, v33, v240
    v_fma_f32 v25, v37, v32, v242
    v_fma_f32 v37, v36, v33, v25
    v_fma_f32 v36, v36, v32, v24
    v_mul_f32 v241, s20, v241
    v_mul_f32 v243, s20, v243
    v_fma_f32 v24, -v39, v35, v241
    v_fma_f32 v25, v39, v34, v243
    v_fma_f32 v39, v38, v35, v25
    v_fma_f32 v38, v38, v34, v24
    s_cmp_gt_u32 s5, 59
    s_cselect_b32 s20, 1.0, 0
    v_mul_f32 v236, s20, v236
    v_mul_f32 v238, s20, v238
    v_fma_f32 v24, -v37, v33, v236
    v_fma_f32 v25, v37, v32, v238
    v_fma_f32 v37, v36, v33, v25
    v_fma_f32 v36, v36, v32, v24
    v_mul_f32 v237, s20, v237
    v_mul_f32 v239, s20, v239
    v_fma_f32 v24, -v39, v35, v237
    v_fma_f32 v25, v39, v34, v239
    v_fma_f32 v39, v38, v35, v25
    v_fma_f32 v38, v38, v34, v24
    s_cmp_gt_u32 s5, 58
    s_cselect_b32 s20, 1.0, 0
    v_mul_f32 v232, s20, v232
    v_mul_f32 v234, s20, v234
    v_fma_f32 v24, -v37, v33, v232
    v_fma_f32 v25, v37, v32, v234
    v_fma_f32 v37, v36, v33, v25
    v_fma_f32 v36, v36, v32, v24
    v_mul_f32 v233, s20, v233
    v_mul_f32 v235, s20, v235
    v_fma_f32 v24, -v39, v35, v233
    v_fma_f32 v25, v39, v34, v235
    v_fma_f32 v39, v38, v35, v25
    v_fma_f32 v38, v38, v34, v24
    s_cmp_gt_u32 s5, 57
    s_cselect_b32 s20, 1.0, 0
    v_mul_f32 v228, s20, v228
    v_mul_f32 v230, s20, v230
    v_fma_f32 v24, -v37, v33, v228
    v_fma_f32 v25, v37, v32, v230
    v_fma_f32 v37, v36, v33, v25
    v_fma_f32 v36, v36, v32, v24
    v_mul_f32 v229, s20, v229
    v_mul_f32 v231, s20, v231
    v_fma_f32 v24, -v39, v35, v229
    v_fma_f32 v25, v39, v34, v231
    v_fma_f32 v39, v38, v35, v25
    v_fma_f32 v38, v38, v34, v24
    s_cmp_gt_u32 s5, 56
    s_cselect_b32 s20, 1.0, 0
    v_mul_f32 v224, s20, v224
    v_mul_f32 v226, s20, v226
    v_fma_f32 v24, -v37, v33, v224
    v_fma_f32 v25, v37, v32, v226
    v_fma_f32 v37, v36, v33, v25
    v_fma_f32 v36, v36, v32, v24
    v_mul_f32 v225, s20, v225
    v_mul_f32 v227, s20, v227
    v_fma_f32 v24, -v39, v35, v225
    v_fma_f32 v25, v39, v34, v227
    v_fma_f32 v39, v38, v35, v25
    v_fma_f32 v38, v38, v34, v24
    s_cmp_gt_u32 s5, 55
    s_cselect_b32 s20, 1.0, 0
    v_mul_f32 v220, s20, v220
    v_mul_f32 v222, s20, v222
    v_fma_f32 v24, -v37, v33, v220
    v_fma_f32 v25, v37, v32, v222
    v_fma_f32 v37, v36, v33, v25
    v_fma_f32 v36, v36, v32, v24
    v_mul_f32 v221, s20, v221
    v_mul_f32 v223, s20, v223
    v_fma_f32 v24, -v39, v35, v221
    v_fma_f32 v25, v39, v34, v223
    v_fma_f32 v39, v38, v35, v25
    v_fma_f32 v38, v38, v34, v24
    s_cmp_gt_u32 s5, 54
    s_cselect_b32 s20, 1.0, 0
    v_mul_f32 v216, s20, v216
    v_mul_f32 v218, s20, v218
    v_fma_f32 v24, -v37, v33, v216
    v_fma_f32 v25, v37, v32, v218
    v_fma_f32 v37, v36, v33, v25
    v_fma_f32 v36, v36, v32, v24
    v_mul_f32 v217, s20, v217
    v_mul_f32 v219, s20, v219
    v_fma_f32 v24, -v39, v35, v217
    v_fma_f32 v25, v39, v34, v219
    v_fma_f32 v39, v38, v35, v25
    v_fma_f32 v38, v38, v34, v24
    s_cmp_gt_u32 s5, 53
    s_cselect_b32 s20, 1.0, 0
    v_mul_f32 v212, s20, v212
    v_mul_f32 v214, s20, v214
    v_fma_f32 v24, -v37, v33, v212
    v_fma_f32 v25, v37, v32, v214
    v_fma_f32 v37, v36, v33, v25
    v_fma_f32 v36, v36, v32, v24
    v_mul_f32 v213, s20, v213
    v_mul_f32 v215, s20, v215
    v_fma_f32 v24, -v39, v35, v213
    v_fma_f32 v25, v39, v34, v215
    v_fma_f32 v39, v38, v35, v25
    v_fma_f32 v38, v38, v34, v24
    s_cmp_gt_u32 s5, 52
    s_cselect_b32 s20, 1.0, 0
    v_mul_f32 v208, s20, v208
    v_mul_f32 v210, s20, v210
    v_fma_f32 v24, -v37, v33, v208
    v_fma_f32 v25, v37, v32, v210
    v_fma_f32 v37, v36, v33, v25
    v_fma_f32 v36, v36, v32, v24
    v_mul_f32 v209, s20, v209
    v_mul_f32 v211, s20, v211
    v_fma_f32 v24, -v39, v35, v209
    v_fma_f32 v25, v39, v34, v211
    v_fma_f32 v39, v38, v35, v25
    v_fma_f32 v38, v38, v34, v24
    s_cmp_gt_u32 s5, 51
    s_cselect_b32 s20, 1.0, 0
    v_mul_f32 v204, s20, v204
    v_mul_f32 v206, s20, v206
    v_fma_f32 v24, -v37, v33, v204
    v_fma_f32 v25, v37, v32, v206
    v_fma_f32 v37, v36, v33, v25
    v_fma_f32 v36, v36, v32, v24
    v_mul_f32 v205, s20, v205
    v_mul_f32 v207, s20, v207
    v_fma_f32 v24, -v39, v35, v205
    v_fma_f32 v25, v39, v34, v207
    v_fma_f32 v39, v38, v35, v25
    v_fma_f32 v38, v38, v34, v24
    s_cmp_gt_u32 s5, 50
    s_cselect_b32 s20, 1.0, 0
    v_mul_f32 v200, s20, v200
    v_mul_f32 v202, s20, v202
    v_fma_f32 v24, -v37, v33, v200
    v_fma_f32 v25, v37, v32, v202
    v_fma_f32 v37, v36, v33, v25
    v_fma_f32 v36, v36, v32, v24
    v_mul_f32 v201, s20, v201
    v_mul_f32 v203, s20, v203
    v_fma_f32 v24, -v39, v35, v201
    v_fma_f32 v25, v39, v34, v203
    v_fma_f32 v39, v38, v35, v25
    v_fma_f32 v38, v38, v34, v24
    s_cmp_gt_u32 s5, 49
    s_cselect_b32 s20, 1.0, 0
    v_mul_f32 v196, s20, v196
    v_mul_f32 v198, s20, v198
    v_fma_f32 v24, -v37, v33, v196
    v_fma_f32 v25, v37, v32, v198
    v_fma_f32 v37, v36, v33, v25
    v_fma_f32 v36, v36, v32, v24
    v_mul_f32 v197, s20, v197
    v_mul_f32 v199, s20, v199
    v_fma_f32 v24, -v39, v35, v197
    v_fma_f32 v25, v39, v34, v199
    v_fma_f32 v39, v38, v35, v25
    v_fma_f32 v38, v38, v34, v24
    s_cmp_gt_u32 s5, 48
    s_cselect_b32 s20, 1.0, 0
    v_mul_f32 v192, s20, v192
    v_mul_f32 v194, s20, v194
    v_fma_f32 v24, -v37, v33, v192
    v_fma_f32 v25, v37, v32, v194
    v_fma_f32 v37, v36, v33, v25
    v_fma_f32 v36, v36, v32, v24
    v_mul_f32 v193, s20, v193
    v_mul_f32 v195, s20, v195
    v_fma_f32 v24, -v39, v35, v193
    v_fma_f32 v25, v39, v34, v195
    v_fma_f32 v39, v38, v35, v25
    v_fma_f32 v38, v38, v34, v24
wb_h3:
    s_cmp_le_u32 s5, 32
    s_cbranch_scc1 wb_h2
    s_sub_u32 s20, s5, 48
    s_max_i32 s20, s20, 0
    s_mul_i32 s20, s20, 3584
    buffer_load_dwordx2 v[252:253], v8, s[8:11], s20 offen sc1
    buffer_load_dwordx2 v[254:255], v8, s[8:11], s20 offen offset:1792 sc1
    s_sub_u32 s20, s5, 47
    s_max_i32 s20, s20, 0
    s_mul_i32 s20, s20, 3584
    buffer_load_dwordx2 v[248:249], v8, s[8:11], s20 offen sc1
    buffer_load_dwordx2 v[250:251], v8, s[8:11], s20 offen offset:1792 sc1
    s_sub_u32 s20, s5, 46
    s_max_i32 s20, s20, 0
    s_mul_i32 s20, s20, 3584
    buffer_load_dwordx2 v[244:245], v8, s[8:11], s20 offen sc1
    buffer_load_dwordx2 v[246:247], v8, s[8:11], s20 offen offset:1792 sc1
    s_sub_u32 s20, s5, 45
    s_max_i32 s20, s20, 0
    s_mul_i32 s20, s20, 3584
    buffer_load_dwordx2 v[240:241], v8, s[8:11], s20 offen sc1
    buffer_load_dwordx2 v[242:243], v8, s[8:11], s20 offen offset:1792 sc1
    s_sub_u32 s20, s5, 44
    s_max_i32 s20, s20, 0
    s_mul_i32 s20, s20, 3584
    buffer_load_dwordx2 v[236:237], v8, s[8:11], s20 offen sc1
    buffer_load_dwordx2 v[238:239], v8, s[8:11], s20 offen offset:1792 sc1
    s_sub_u32 s20, s5, 43
    s_max_i32 s20, s20, 0
    s_mul_i32 s20, s20, 3584
    buffer_load_dwordx2 v[232:233], v8, s[8:11], s20 offen sc1
    buffer_load_dwordx2 v[234:235], v8, s[8:11], s20 offen offset:1792 sc1
    s_sub_u32 s20, s5, 42
    s_max_i32 s20, s20, 0
    s_mul_i32 s20, s20, 3584
    buffer_load_dwordx2 v[228:229], v8, s[8:11], s20 offen sc1
    buffer_load_dwordx2 v[230:231], v8, s[8:11], s20 offen offset:1792 sc1
    s_sub_u32 s20, s5, 41
    s_max_i32 s20, s20, 0
    s_mul_i32 s20, s20, 3584
    buffer_load_dwordx2 v[224:225], v8, s[8:11], s20 offen sc1
    buffer_load_dwordx2 v[226:227], v8, s[8:11], s20 offen offset:1792 sc1
    s_sub_u32 s20, s5, 40
    s_max_i32 s20, s20, 0
    s_mul_i32 s20, s20, 3584
    buffer_load_dwordx2 v[220:221], v8, s[8:11], s20 offen sc1
    buffer_load_dwordx2 v[222:223], v8, s[8:11], s20 offen offset:1792 sc1
    s_sub_u32 s20, s5, 39
    s_max_i32 s20, s20, 0
    s_mul_i32 s20, s20, 3584
    buffer_load_dwordx2 v[216:217], v8, s[8:11], s20 offen sc1
    buffer_load_dwordx2 v[218:219], v8, s[8:11], s20 offen offset:1792 sc1
    s_sub_u32 s20, s5, 38
    s_max_i32 s20, s20, 0
    s_mul_i32 s20, s20, 3584
    buffer_load_dwordx2 v[212:213], v8, s[8:11], s20 offen sc1
    buffer_load_dwordx2 v[214:215], v8, s[8:11], s20 offen offset:1792 sc1
    s_sub_u32 s20, s5, 37
    s_max_i32 s20, s20, 0
    s_mul_i32 s20, s20, 3584
    buffer_load_dwordx2 v[208:209], v8, s[8:11], s20 offen sc1
    buffer_load_dwordx2 v[210:211], v8, s[8:11], s20 offen offset:1792 sc1
    s_sub_u32 s20, s5, 36
    s_max_i32 s20, s20, 0
    s_mul_i32 s20, s20, 3584
    buffer_load_dwordx2 v[204:205], v8, s[8:11], s20 offen sc1
    buffer_load_dwordx2 v[206:207], v8, s[8:11], s20 offen offset:1792 sc1
    s_sub_u32 s20, s5, 35
    s_max_i32 s20, s20, 0
    s_mul_i32 s20, s20, 3584
    buffer_load_dwordx2 v[200:201], v8, s[8:11], s20 offen sc1
    buffer_load_dwordx2 v[202:203], v8, s[8:11], s20 offen offset:1792 sc1
    s_sub_u32 s20, s5, 34
    s_max_i32 s20, s20, 0
    s_mul_i32 s20, s20, 3584
    buffer_load_dwordx2 v[196:197], v8, s[8:11], s20 offen sc1
    buffer_load_dwordx2 v[198:199], v8, s[8:11], s20 offen offset:1792 sc1
    s_sub_u32 s20, s5, 33
    s_max_i32 s20, s20, 0
    s_mul_i32 s20, s20, 3584
    buffer_load_dwordx2 v[192:193], v8, s[8:11], s20 offen sc1
    buffer_load_dwordx2 v[194:195], v8, s[8:11], s20 offen offset:1792 sc1
    s_waitcnt vmcnt(0)
    s_cmp_gt_u32 s5, 47
    s_cselect_b32 s20, 1.0, 0
    v_mul_f32 v252, s20, v252
    v_mul_f32 v254, s20, v254
    v_fma_f32 v24, -v37, v33, v252
    v_fma_f32 v25, v37, v32, v254
    v_fma_f32 v37, v36, v33, v25
    v_fma_f32 v36, v36, v32, v24
    v_mul_f32 v253, s20, v253
    v_mul_f32 v255, s20, v255
    v_fma_f32 v24, -v39, v35, v253
    v_fma_f32 v25, v39, v34, v255
    v_fma_f32 v39, v38, v35, v25
    v_fma_f32 v38, v38, v34, v24
    s_cmp_gt_u32 s5, 46
    s_cselect_b32 s20, 1.0, 0
    v_mul_f32 v248, s20, v248
    v_mul_f32 v250, s20, v250
    v_fma_f32 v24, -v37, v33, v248
    v_fma_f32 v25, v37, v32, v250
    v_fma_f32 v37, v36, v33, v25
    v_fma_f32 v36, v36, v32, v24
    v_mul_f32 v249, s20, v249
    v_mul_f32 v251, s20, v251
    v_fma_f32 v24, -v39, v35, v249
    v_fma_f32 v25, v39, v34, v251
    v_fma_f32 v39, v38, v35, v25
    v_fma_f32 v38, v38, v34, v24
    s_cmp_gt_u32 s5, 45
    s_cselect_b32 s20, 1.0, 0
    v_mul_f32 v244, s20, v244
    v_mul_f32 v246, s20, v246
    v_fma_f32 v24, -v37, v33, v244
    v_fma_f32 v25, v37, v32, v246
    v_fma_f32 v37, v36, v33, v25
    v_fma_f32 v36, v36, v32, v24
    v_mul_f32 v245, s20, v245
    v_mul_f32 v247, s20, v247
    v_fma_f32 v24, -v39, v35, v245
    v_fma_f32 v25, v39, v34, v247
    v_fma_f32 v39, v38, v35, v25
    v_fma_f32 v38, v38, v34, v24
    s_cmp_gt_u32 s5, 44
    s_cselect_b32 s20, 1.0, 0
    v_mul_f32 v240, s20, v240
    v_mul_f32 v242, s20, v242
    v_fma_f32 v24, -v37, v33, v240
    v_fma_f32 v25, v37, v32, v242
    v_fma_f32 v37, v36, v33, v25
    v_fma_f32 v36, v36, v32, v24
    v_mul_f32 v241, s20, v241
    v_mul_f32 v243, s20, v243
    v_fma_f32 v24, -v39, v35, v241
    v_fma_f32 v25, v39, v34, v243
    v_fma_f32 v39, v38, v35, v25
    v_fma_f32 v38, v38, v34, v24
    s_cmp_gt_u32 s5, 43
    s_cselect_b32 s20, 1.0, 0
    v_mul_f32 v236, s20, v236
    v_mul_f32 v238, s20, v238
    v_fma_f32 v24, -v37, v33, v236
    v_fma_f32 v25, v37, v32, v238
    v_fma_f32 v37, v36, v33, v25
    v_fma_f32 v36, v36, v32, v24
    v_mul_f32 v237, s20, v237
    v_mul_f32 v239, s20, v239
    v_fma_f32 v24, -v39, v35, v237
    v_fma_f32 v25, v39, v34, v239
    v_fma_f32 v39, v38, v35, v25
    v_fma_f32 v38, v38, v34, v24
    s_cmp_gt_u32 s5, 42
    s_cselect_b32 s20, 1.0, 0
    v_mul_f32 v232, s20, v232
    v_mul_f32 v234, s20, v234
    v_fma_f32 v24, -v37, v33, v232
    v_fma_f32 v25, v37, v32, v234
    v_fma_f32 v37, v36, v33, v25
    v_fma_f32 v36, v36, v32, v24
    v_mul_f32 v233, s20, v233
    v_mul_f32 v235, s20, v235
    v_fma_f32 v24, -v39, v35, v233
    v_fma_f32 v25, v39, v34, v235
    v_fma_f32 v39, v38, v35, v25
    v_fma_f32 v38, v38, v34, v24
    s_cmp_gt_u32 s5, 41
    s_cselect_b32 s20, 1.0, 0
    v_mul_f32 v228, s20, v228
    v_mul_f32 v230, s20, v230
    v_fma_f32 v24, -v37, v33, v228
    v_fma_f32 v25, v37, v32, v230
    v_fma_f32 v37, v36, v33, v25
    v_fma_f32 v36, v36, v32, v24
    v_mul_f32 v229, s20, v229
    v_mul_f32 v231, s20, v231
    v_fma_f32 v24, -v39, v35, v229
    v_fma_f32 v25, v39, v34, v231
    v_fma_f32 v39, v38, v35, v25
    v_fma_f32 v38, v38, v34, v24
    s_cmp_gt_u32 s5, 40
    s_cselect_b32 s20, 1.0, 0
    v_mul_f32 v224, s20, v224
    v_mul_f32 v226, s20, v226
    v_fma_f32 v24, -v37, v33, v224
    v_fma_f32 v25, v37, v32, v226
    v_fma_f32 v37, v36, v33, v25
    v_fma_f32 v36, v36, v32, v24
    v_mul_f32 v225, s20, v225
    v_mul_f32 v227, s20, v227
    v_fma_f32 v24, -v39, v35, v225
    v_fma_f32 v25, v39, v34, v227
    v_fma_f32 v39, v38, v35, v25
    v_fma_f32 v38, v38, v34, v24
    s_cmp_gt_u32 s5, 39
    s_cselect_b32 s20, 1.0, 0
    v_mul_f32 v220, s20, v220
    v_mul_f32 v222, s20, v222
    v_fma_f32 v24, -v37, v33, v220
    v_fma_f32 v25, v37, v32, v222
    v_fma_f32 v37, v36, v33, v25
    v_fma_f32 v36, v36, v32, v24
    v_mul_f32 v221, s20, v221
    v_mul_f32 v223, s20, v223
    v_fma_f32 v24, -v39, v35, v221
    v_fma_f32 v25, v39, v34, v223
    v_fma_f32 v39, v38, v35, v25
    v_fma_f32 v38, v38, v34, v24
    s_cmp_gt_u32 s5, 38
    s_cselect_b32 s20, 1.0, 0
    v_mul_f32 v216, s20, v216
    v_mul_f32 v218, s20, v218
    v_fma_f32 v24, -v37, v33, v216
    v_fma_f32 v25, v37, v32, v218
    v_fma_f32 v37, v36, v33, v25
    v_fma_f32 v36, v36, v32, v24
    v_mul_f32 v217, s20, v217
    v_mul_f32 v219, s20, v219
    v_fma_f32 v24, -v39, v35, v217
    v_fma_f32 v25, v39, v34, v219
    v_fma_f32 v39, v38, v35, v25
    v_fma_f32 v38, v38, v34, v24
    s_cmp_gt_u32 s5, 37
    s_cselect_b32 s20, 1.0, 0
    v_mul_f32 v212, s20, v212
    v_mul_f32 v214, s20, v214
    v_fma_f32 v24, -v37, v33, v212
    v_fma_f32 v25, v37, v32, v214
    v_fma_f32 v37, v36, v33, v25
    v_fma_f32 v36, v36, v32, v24
    v_mul_f32 v213, s20, v213
    v_mul_f32 v215, s20, v215
    v_fma_f32 v24, -v39, v35, v213
    v_fma_f32 v25, v39, v34, v215
    v_fma_f32 v39, v38, v35, v25
    v_fma_f32 v38, v38, v34, v24
    s_cmp_gt_u32 s5, 36
    s_cselect_b32 s20, 1.0, 0
    v_mul_f32 v208, s20, v208
    v_mul_f32 v210, s20, v210
    v_fma_f32 v24, -v37, v33, v208
    v_fma_f32 v25, v37, v32, v210
    v_fma_f32 v37, v36, v33, v25
    v_fma_f32 v36, v36, v32, v24
    v_mul_f32 v209, s20, v209
    v_mul_f32 v211, s20, v211
    v_fma_f32 v24, -v39, v35, v209
    v_fma_f32 v25, v39, v34, v211
    v_fma_f32 v39, v38, v35, v25
    v_fma_f32 v38, v38, v34, v24
    s_cmp_gt_u32 s5, 35
    s_cselect_b32 s20, 1.0, 0
    v_mul_f32 v204, s20, v204
    v_mul_f32 v206, s20, v206
    v_fma_f32 v24, -v37, v33, v204
    v_fma_f32 v25, v37, v32, v206
    v_fma_f32 v37, v36, v33, v25
    v_fma_f32 v36, v36, v32, v24
    v_mul_f32 v205, s20, v205
    v_mul_f32 v207, s20, v207
    v_fma_f32 v24, -v39, v35, v205
    v_fma_f32 v25, v39, v34, v207
    v_fma_f32 v39, v38, v35, v25
    v_fma_f32 v38, v38, v34, v24
    s_cmp_gt_u32 s5, 34
    s_cselect_b32 s20, 1.0, 0
    v_mul_f32 v200, s20, v200
    v_mul_f32 v202, s20, v202
    v_fma_f32 v24, -v37, v33, v200
    v_fma_f32 v25, v37, v32, v202
    v_fma_f32 v37, v36, v33, v25
    v_fma_f32 v36, v36, v32, v24
    v_mul_f32 v201, s20, v201
    v_mul_f32 v203, s20, v203
    v_fma_f32 v24, -v39, v35, v201
    v_fma_f32 v25, v39, v34, v203
    v_fma_f32 v39, v38, v35, v25
    v_fma_f32 v38, v38, v34, v24
    s_cmp_gt_u32 s5, 33
    s_cselect_b32 s20, 1.0, 0
    v_mul_f32 v196, s20, v196
    v_mul_f32 v198, s20, v198
    v_fma_f32 v24, -v37, v33, v196
    v_fma_f32 v25, v37, v32, v198
    v_fma_f32 v37, v36, v33, v25
    v_fma_f32 v36, v36, v32, v24
    v_mul_f32 v197, s20, v197
    v_mul_f32 v199, s20, v199
    v_fma_f32 v24, -v39, v35, v197
    v_fma_f32 v25, v39, v34, v199
    v_fma_f32 v39, v38, v35, v25
    v_fma_f32 v38, v38, v34, v24
    s_cmp_gt_u32 s5, 32
    s_cselect_b32 s20, 1.0, 0
    v_mul_f32 v192, s20, v192
    v_mul_f32 v194, s20, v194
    v_fma_f32 v24, -v37, v33, v192
    v_fma_f32 v25, v37, v32, v194
    v_fma_f32 v37, v36, v33, v25
    v_fma_f32 v36, v36, v32, v24
    v_mul_f32 v193, s20, v193
    v_mul_f32 v195, s20, v195
    v_fma_f32 v24, -v39, v35, v193
    v_fma_f32 v25, v39, v34, v195
    v_fma_f32 v39, v38, v35, v25
    v_fma_f32 v38, v38, v34, v24
wb_h2:
    s_cmp_le_u32 s5, 16
    s_cbranch_scc1 wb_h1
    s_sub_u32 s20, s5, 32
    s_max_i32 s20, s20, 0
    s_mul_i32 s20, s20, 3584
    buffer_load_dwordx2 v[252:253], v8, s[8:11], s20 offen sc1
    buffer_load_dwordx2 v[254:255], v8, s[8:11], s20 offen offset:1792 sc1
    s_sub_u32 s20, s5, 31
    s_max_i32 s20, s20, 0
    s_mul_i32 s20, s20, 3584
    buffer_load_dwordx2 v[248:249], v8, s[8:11], s20 offen sc1
    buffer_load_dwordx2 v[250:251], v8, s[8:11], s20 offen offset:1792 sc1
    s_sub_u32 s20, s5, 30
    s_max_i32 s20, s20, 0
    s_mul_i32 s20, s20, 3584
    buffer_load_dwordx2 v[244:245], v8, s[8:11], s20 offen sc1
    buffer_load_dwordx2 v[246:247], v8, s[8:11], s20 offen offset:1792 sc1
    s_sub_u32 s20, s5, 29
    s_max_i32 s20, s20, 0
    s_mul_i32 s20, s20, 3584
    buffer_load_dwordx2 v[240:241], v8, s[8:11], s20 offen sc1
    buffer_load_dwordx2 v[242:243], v8, s[8:11], s20 offen offset:1792 sc1
    s_sub_u32 s20, s5, 28
    s_max_i32 s20, s20, 0
    s_mul_i32 s20, s20, 3584
    buffer_load_dwordx2 v[236:237], v8, s[8:11], s20 offen sc1
    buffer_load_dwordx2 v[238:239], v8, s[8:11], s20 offen offset:1792 sc1
    s_sub_u32 s20, s5, 27
    s_max_i32 s20, s20, 0
    s_mul_i32 s20, s20, 3584
    buffer_load_dwordx2 v[232:233], v8, s[8:11], s20 offen sc1
    buffer_load_dwordx2 v[234:235], v8, s[8:11], s20 offen offset:1792 sc1
    s_sub_u32 s20, s5, 26
    s_max_i32 s20, s20, 0
    s_mul_i32 s20, s20, 3584
    buffer_load_dwordx2 v[228:229], v8, s[8:11], s20 offen sc1
    buffer_load_dwordx2 v[230:231], v8, s[8:11], s20 offen offset:1792 sc1
    s_sub_u32 s20, s5, 25
    s_max_i32 s20, s20, 0
    s_mul_i32 s20, s20, 3584
    buffer_load_dwordx2 v[224:225], v8, s[8:11], s20 offen sc1
    buffer_load_dwordx2 v[226:227], v8, s[8:11], s20 offen offset:1792 sc1
    s_sub_u32 s20, s5, 24
    s_max_i32 s20, s20, 0
    s_mul_i32 s20, s20, 3584
    buffer_load_dwordx2 v[220:221], v8, s[8:11], s20 offen sc1
    buffer_load_dwordx2 v[222:223], v8, s[8:11], s20 offen offset:1792 sc1
    s_sub_u32 s20, s5, 23
    s_max_i32 s20, s20, 0
    s_mul_i32 s20, s20, 3584
    buffer_load_dwordx2 v[216:217], v8, s[8:11], s20 offen sc1
    buffer_load_dwordx2 v[218:219], v8, s[8:11], s20 offen offset:1792 sc1
    s_sub_u32 s20, s5, 22
    s_max_i32 s20, s20, 0
    s_mul_i32 s20, s20, 3584
    buffer_load_dwordx2 v[212:213], v8, s[8:11], s20 offen sc1
    buffer_load_dwordx2 v[214:215], v8, s[8:11], s20 offen offset:1792 sc1
    s_sub_u32 s20, s5, 21
    s_max_i32 s20, s20, 0
    s_mul_i32 s20, s20, 3584
    buffer_load_dwordx2 v[208:209], v8, s[8:11], s20 offen sc1
    buffer_load_dwordx2 v[210:211], v8, s[8:11], s20 offen offset:1792 sc1
    s_sub_u32 s20, s5, 20
    s_max_i32 s20, s20, 0
    s_mul_i32 s20, s20, 3584
    buffer_load_dwordx2 v[204:205], v8, s[8:11], s20 offen sc1
    buffer_load_dwordx2 v[206:207], v8, s[8:11], s20 offen offset:1792 sc1
    s_sub_u32 s20, s5, 19
    s_max_i32 s20, s20, 0
    s_mul_i32 s20, s20, 3584
    buffer_load_dwordx2 v[200:201], v8, s[8:11], s20 offen sc1
    buffer_load_dwordx2 v[202:203], v8, s[8:11], s20 offen offset:1792 sc1
    s_sub_u32 s20, s5, 18
    s_max_i32 s20, s20, 0
    s_mul_i32 s20, s20, 3584
    buffer_load_dwordx2 v[196:197], v8, s[8:11], s20 offen sc1
    buffer_load_dwordx2 v[198:199], v8, s[8:11], s20 offen offset:1792 sc1
    s_sub_u32 s20, s5, 17
    s_max_i32 s20, s20, 0
    s_mul_i32 s20, s20, 3584
    buffer_load_dwordx2 v[192:193], v8, s[8:11], s20 offen sc1
    buffer_load_dwordx2 v[194:195], v8, s[8:11], s20 offen offset:1792 sc1
    s_waitcnt vmcnt(0)
    s_cmp_gt_u32 s5, 31
    s_cselect_b32 s20, 1.0, 0
    v_mul_f32 v252, s20, v252
    v_mul_f32 v254, s20, v254
    v_fma_f32 v24, -v37, v33, v252
    v_fma_f32 v25, v37, v32, v254
    v_fma_f32 v37, v36, v33, v25
    v_fma_f32 v36, v36, v32, v24
    v_mul_f32 v253, s20, v253
    v_mul_f32 v255, s20, v255
    v_fma_f32 v24, -v39, v35, v253
    v_fma_f32 v25, v39, v34, v255
    v_fma_f32 v39, v38, v35, v25
    v_fma_f32 v38, v38, v34, v24
    s_cmp_gt_u32 s5, 30
    s_cselect_b32 s20, 1.0, 0
    v_mul_f32 v248, s20, v248
    v_mul_f32 v250, s20, v250
    v_fma_f32 v24, -v37, v33, v248
    v_fma_f32 v25, v37, v32, v250
    v_fma_f32 v37, v36, v33, v25
    v_fma_f32 v36, v36, v32, v24
    v_mul_f32 v249, s20, v249
    v_mul_f32 v251, s20, v251
    v_fma_f32 v24, -v39, v35, v249
    v_fma_f32 v25, v39, v34, v251
    v_fma_f32 v39, v38, v35, v25
    v_fma_f32 v38, v38, v34, v24
    s_cmp_gt_u32 s5, 29
    s_cselect_b32 s20, 1.0, 0
    v_mul_f32 v244, s20, v244
    v_mul_f32 v246, s20, v246
    v_fma_f32 v24, -v37, v33, v244
    v_fma_f32 v25, v37, v32, v246
    v_fma_f32 v37, v36, v33, v25
    v_fma_f32 v36, v36, v32, v24
    v_mul_f32 v245, s20, v245
    v_mul_f32 v247, s20, v247
    v_fma_f32 v24, -v39, v35, v245
    v_fma_f32 v25, v39, v34, v247
    v_fma_f32 v39, v38, v35, v25
    v_fma_f32 v38, v38, v34, v24
    s_cmp_gt_u32 s5, 28
    s_cselect_b32 s20, 1.0, 0
    v_mul_f32 v240, s20, v240
    v_mul_f32 v242, s20, v242
    v_fma_f32 v24, -v37, v33, v240
    v_fma_f32 v25, v37, v32, v242
    v_fma_f32 v37, v36, v33, v25
    v_fma_f32 v36, v36, v32, v24
    v_mul_f32 v241, s20, v241
    v_mul_f32 v243, s20, v243
    v_fma_f32 v24, -v39, v35, v241
    v_fma_f32 v25, v39, v34, v243
    v_fma_f32 v39, v38, v35, v25
    v_fma_f32 v38, v38, v34, v24
    s_cmp_gt_u32 s5, 27
    s_cselect_b32 s20, 1.0, 0
    v_mul_f32 v236, s20, v236
    v_mul_f32 v238, s20, v238
    v_fma_f32 v24, -v37, v33, v236
    v_fma_f32 v25, v37, v32, v238
    v_fma_f32 v37, v36, v33, v25
    v_fma_f32 v36, v36, v32, v24
    v_mul_f32 v237, s20, v237
    v_mul_f32 v239, s20, v239
    v_fma_f32 v24, -v39, v35, v237
    v_fma_f32 v25, v39, v34, v239
    v_fma_f32 v39, v38, v35, v25
    v_fma_f32 v38, v38, v34, v24
    s_cmp_gt_u32 s5, 26
    s_cselect_b32 s20, 1.0, 0
    v_mul_f32 v232, s20, v232
    v_mul_f32 v234, s20, v234
    v_fma_f32 v24, -v37, v33, v232
    v_fma_f32 v25, v37, v32, v234
    v_fma_f32 v37, v36, v33, v25
    v_fma_f32 v36, v36, v32, v24
    v_mul_f32 v233, s20, v233
    v_mul_f32 v235, s20, v235
    v_fma_f32 v24, -v39, v35, v233
    v_fma_f32 v25, v39, v34, v235
    v_fma_f32 v39, v38, v35, v25
    v_fma_f32 v38, v38, v34, v24
    s_cmp_gt_u32 s5, 25
    s_cselect_b32 s20, 1.0, 0
    v_mul_f32 v228, s20, v228
    v_mul_f32 v230, s20, v230
    v_fma_f32 v24, -v37, v33, v228
    v_fma_f32 v25, v37, v32, v230
    v_fma_f32 v37, v36, v33, v25
    v_fma_f32 v36, v36, v32, v24
    v_mul_f32 v229, s20, v229
    v_mul_f32 v231, s20, v231
    v_fma_f32 v24, -v39, v35, v229
    v_fma_f32 v25, v39, v34, v231
    v_fma_f32 v39, v38, v35, v25
    v_fma_f32 v38, v38, v34, v24
    s_cmp_gt_u32 s5, 24
    s_cselect_b32 s20, 1.0, 0
    v_mul_f32 v224, s20, v224
    v_mul_f32 v226, s20, v226
    v_fma_f32 v24, -v37, v33, v224
    v_fma_f32 v25, v37, v32, v226
    v_fma_f32 v37, v36, v33, v25
    v_fma_f32 v36, v36, v32, v24
    v_mul_f32 v225, s20, v225
    v_mul_f32 v227, s20, v227
    v_fma_f32 v24, -v39, v35, v225
    v_fma_f32 v25, v39, v34, v227
    v_fma_f32 v39, v38, v35, v25
    v_fma_f32 v38, v38, v34, v24
    s_cmp_gt_u32 s5, 23
    s_cselect_b32 s20, 1.0, 0
    v_mul_f32 v220, s20, v220
    v_mul_f32 v222, s20, v222
    v_fma_f32 v24, -v37, v33, v220
    v_fma_f32 v25, v37, v32, v222
    v_fma_f32 v37, v36, v33, v25
    v_fma_f32 v36, v36, v32, v24
    v_mul_f32 v221, s20, v221
    v_mul_f32 v223, s20, v223
    v_fma_f32 v24, -v39, v35, v221
    v_fma_f32 v25, v39, v34, v223
    v_fma_f32 v39, v38, v35, v25
    v_fma_f32 v38, v38, v34, v24
    s_cmp_gt_u32 s5, 22
    s_cselect_b32 s20, 1.0, 0
    v_mul_f32 v216, s20, v216
    v_mul_f32 v218, s20, v218
    v_fma_f32 v24, -v37, v33, v216
    v_fma_f32 v25, v37, v32, v218
    v_fma_f32 v37, v36, v33, v25
    v_fma_f32 v36, v36, v32, v24
    v_mul_f32 v217, s20, v217
    v_mul_f32 v219, s20, v219
    v_fma_f32 v24, -v39, v35, v217
    v_fma_f32 v25, v39, v34, v219
    v_fma_f32 v39, v38, v35, v25
    v_fma_f32 v38, v38, v34, v24
    s_cmp_gt_u32 s5, 21
    s_cselect_b32 s20, 1.0, 0
    v_mul_f32 v212, s20, v212
    v_mul_f32 v214, s20, v214
    v_fma_f32 v24, -v37, v33, v212
    v_fma_f32 v25, v37, v32, v214
    v_fma_f32 v37, v36, v33, v25
    v_fma_f32 v36, v36, v32, v24
    v_mul_f32 v213, s20, v213
    v_mul_f32 v215, s20, v215
    v_fma_f32 v24, -v39, v35, v213
    v_fma_f32 v25, v39, v34, v215
    v_fma_f32 v39, v38, v35, v25
    v_fma_f32 v38, v38, v34, v24
    s_cmp_gt_u32 s5, 20
    s_cselect_b32 s20, 1.0, 0
    v_mul_f32 v208, s20, v208
    v_mul_f32 v210, s20, v210
    v_fma_f32 v24, -v37, v33, v208
    v_fma_f32 v25, v37, v32, v210
    v_fma_f32 v37, v36, v33, v25
    v_fma_f32 v36, v36, v32, v24
    v_mul_f32 v209, s20, v209
    v_mul_f32 v211, s20, v211
    v_fma_f32 v24, -v39, v35, v209
    v_fma_f32 v25, v39, v34, v211
    v_fma_f32 v39, v38, v35, v25
    v_fma_f32 v38, v38, v34, v24
    s_cmp_gt_u32 s5, 19
    s_cselect_b32 s20, 1.0, 0
    v_mul_f32 v204, s20, v204
    v_mul_f32 v206, s20, v206
    v_fma_f32 v24, -v37, v33, v204
    v_fma_f32 v25, v37, v32, v206
    v_fma_f32 v37, v36, v33, v25
    v_fma_f32 v36, v36, v32, v24
    v_mul_f32 v205, s20, v205
    v_mul_f32 v207, s20, v207
    v_fma_f32 v24, -v39, v35, v205
    v_fma_f32 v25, v39, v34, v207
    v_fma_f32 v39, v38, v35, v25
    v_fma_f32 v38, v38, v34, v24
    s_cmp_gt_u32 s5, 18
    s_cselect_b32 s20, 1.0, 0
    v_mul_f32 v200, s20, v200
    v_mul_f32 v202, s20, v202
    v_fma_f32 v24, -v37, v33, v200
    v_fma_f32 v25, v37, v32, v202
    v_fma_f32 v37, v36, v33, v25
    v_fma_f32 v36, v36, v32, v24
    v_mul_f32 v201, s20, v201
    v_mul_f32 v203, s20, v203
    v_fma_f32 v24, -v39, v35, v201
    v_fma_f32 v25, v39, v34, v203
    v_fma_f32 v39, v38, v35, v25
    v_fma_f32 v38, v38, v34, v24
    s_cmp_gt_u32 s5, 17
    s_cselect_b32 s20, 1.0, 0
    v_mul_f32 v196, s20, v196
    v_mul_f32 v198, s20, v198
    v_fma_f32 v24, -v37, v33, v196
    v_fma_f32 v25, v37, v32, v198
    v_fma_f32 v37, v36, v33, v25
    v_fma_f32 v36, v36, v32, v24
    v_mul_f32 v197, s20, v197
    v_mul_f32 v199, s20, v199
    v_fma_f32 v24, -v39, v35, v197
    v_fma_f32 v25, v39, v34, v199
    v_fma_f32 v39, v38, v35, v25
    v_fma_f32 v38, v38, v34, v24
    s_cmp_gt_u32 s5, 16
    s_cselect_b32 s20, 1.0, 0
    v_mul_f32 v192, s20, v192
    v_mul_f32 v194, s20, v194
    v_fma_f32 v24, -v37, v33, v192
    v_fma_f32 v25, v37, v32, v194
    v_fma_f32 v37, v36, v33, v25
    v_fma_f32 v36, v36, v32, v24
    v_mul_f32 v193, s20, v193
    v_mul_f32 v195, s20, v195
    v_fma_f32 v24, -v39, v35, v193
    v_fma_f32 v25, v39, v34, v195
    v_fma_f32 v39, v38, v35, v25
    v_fma_f32 v38, v38, v34, v24
wb_h1:
    s_cmp_le_u32 s5, 0
    s_cbranch_scc1 wb_h0
    s_sub_u32 s20, s5, 16
    s_max_i32 s20, s20, 0
    s_mul_i32 s20, s20, 3584
    buffer_load_dwordx2 v[252:253], v8, s[8:11], s20 offen sc1
    buffer_load_dwordx2 v[254:255], v8, s[8:11], s20 offen offset:1792 sc1
    s_sub_u32 s20, s5, 15
    s_max_i32 s20, s20, 0
    s_mul_i32 s20, s20, 3584
    buffer_load_dwordx2 v[248:249], v8, s[8:11], s20 offen sc1
    buffer_load_dwordx2 v[250:251], v8, s[8:11], s20 offen offset:1792 sc1
    s_sub_u32 s20, s5, 14
    s_max_i32 s20, s20, 0
    s_mul_i32 s20, s20, 3584
    buffer_load_dwordx2 v[244:245], v8, s[8:11], s20 offen sc1
    buffer_load_dwordx2 v[246:247], v8, s[8:11], s20 offen offset:1792 sc1
    s_sub_u32 s20, s5, 13
    s_max_i32 s20, s20, 0
    s_mul_i32 s20, s20, 3584
    buffer_load_dwordx2 v[240:241], v8, s[8:11], s20 offen sc1
    buffer_load_dwordx2 v[242:243], v8, s[8:11], s20 offen offset:1792 sc1
    s_sub_u32 s20, s5, 12
    s_max_i32 s20, s20, 0
    s_mul_i32 s20, s20, 3584
    buffer_load_dwordx2 v[236:237], v8, s[8:11], s20 offen sc1
    buffer_load_dwordx2 v[238:239], v8, s[8:11], s20 offen offset:1792 sc1
    s_sub_u32 s20, s5, 11
    s_max_i32 s20, s20, 0
    s_mul_i32 s20, s20, 3584
    buffer_load_dwordx2 v[232:233], v8, s[8:11], s20 offen sc1
    buffer_load_dwordx2 v[234:235], v8, s[8:11], s20 offen offset:1792 sc1
    s_sub_u32 s20, s5, 10
    s_max_i32 s20, s20, 0
    s_mul_i32 s20, s20, 3584
    buffer_load_dwordx2 v[228:229], v8, s[8:11], s20 offen sc1
    buffer_load_dwordx2 v[230:231], v8, s[8:11], s20 offen offset:1792 sc1
    s_sub_u32 s20, s5, 9
    s_max_i32 s20, s20, 0
    s_mul_i32 s20, s20, 3584
    buffer_load_dwordx2 v[224:225], v8, s[8:11], s20 offen sc1
    buffer_load_dwordx2 v[226:227], v8, s[8:11], s20 offen offset:1792 sc1
    s_sub_u32 s20, s5, 8
    s_max_i32 s20, s20, 0
    s_mul_i32 s20, s20, 3584
    buffer_load_dwordx2 v[220:221], v8, s[8:11], s20 offen sc1
    buffer_load_dwordx2 v[222:223], v8, s[8:11], s20 offen offset:1792 sc1
    s_sub_u32 s20, s5, 7
    s_max_i32 s20, s20, 0
    s_mul_i32 s20, s20, 3584
    buffer_load_dwordx2 v[216:217], v8, s[8:11], s20 offen sc1
    buffer_load_dwordx2 v[218:219], v8, s[8:11], s20 offen offset:1792 sc1
    s_sub_u32 s20, s5, 6
    s_max_i32 s20, s20, 0
    s_mul_i32 s20, s20, 3584
    buffer_load_dwordx2 v[212:213], v8, s[8:11], s20 offen sc1
    buffer_load_dwordx2 v[214:215], v8, s[8:11], s20 offen offset:1792 sc1
    s_sub_u32 s20, s5, 5
    s_max_i32 s20, s20, 0
    s_mul_i32 s20, s20, 3584
    buffer_load_dwordx2 v[208:209], v8, s[8:11], s20 offen sc1
    buffer_load_dwordx2 v[210:211], v8, s[8:11], s20 offen offset:1792 sc1
    s_sub_u32 s20, s5, 4
    s_max_i32 s20, s20, 0
    s_mul_i32 s20, s20, 3584
    buffer_load_dwordx2 v[204:205], v8, s[8:11], s20 offen sc1
    buffer_load_dwordx2 v[206:207], v8, s[8:11], s20 offen offset:1792 sc1
    s_sub_u32 s20, s5, 3
    s_max_i32 s20, s20, 0
    s_mul_i32 s20, s20, 3584
    buffer_load_dwordx2 v[200:201], v8, s[8:11], s20 offen sc1
    buffer_load_dwordx2 v[202:203], v8, s[8:11], s20 offen offset:1792 sc1
    s_sub_u32 s20, s5, 2
    s_max_i32 s20, s20, 0
    s_mul_i32 s20, s20, 3584
    buffer_load_dwordx2 v[196:197], v8, s[8:11], s20 offen sc1
    buffer_load_dwordx2 v[198:199], v8, s[8:11], s20 offen offset:1792 sc1
    s_sub_u32 s20, s5, 1
    s_max_i32 s20, s20, 0
    s_mul_i32 s20, s20, 3584
    buffer_load_dwordx2 v[192:193], v8, s[8:11], s20 offen sc1
    buffer_load_dwordx2 v[194:195], v8, s[8:11], s20 offen offset:1792 sc1
    s_waitcnt vmcnt(0)
    s_cmp_gt_u32 s5, 15
    s_cselect_b32 s20, 1.0, 0
    v_mul_f32 v252, s20, v252
    v_mul_f32 v254, s20, v254
    v_fma_f32 v24, -v37, v33, v252
    v_fma_f32 v25, v37, v32, v254
    v_fma_f32 v37, v36, v33, v25
    v_fma_f32 v36, v36, v32, v24
    v_mul_f32 v253, s20, v253
    v_mul_f32 v255, s20, v255
    v_fma_f32 v24, -v39, v35, v253
    v_fma_f32 v25, v39, v34, v255
    v_fma_f32 v39, v38, v35, v25
    v_fma_f32 v38, v38, v34, v24
    s_cmp_gt_u32 s5, 14
    s_cselect_b32 s20, 1.0, 0
    v_mul_f32 v248, s20, v248
    v_mul_f32 v250, s20, v250
    v_fma_f32 v24, -v37, v33, v248
    v_fma_f32 v25, v37, v32, v250
    v_fma_f32 v37, v36, v33, v25
    v_fma_f32 v36, v36, v32, v24
    v_mul_f32 v249, s20, v249
    v_mul_f32 v251, s20, v251
    v_fma_f32 v24, -v39, v35, v249
    v_fma_f32 v25, v39, v34, v251
    v_fma_f32 v39, v38, v35, v25
    v_fma_f32 v38, v38, v34, v24
    s_cmp_gt_u32 s5, 13
    s_cselect_b32 s20, 1.0, 0
    v_mul_f32 v244, s20, v244
    v_mul_f32 v246, s20, v246
    v_fma_f32 v24, -v37, v33, v244
    v_fma_f32 v25, v37, v32, v246
    v_fma_f32 v37, v36, v33, v25
    v_fma_f32 v36, v36, v32, v24
    v_mul_f32 v245, s20, v245
    v_mul_f32 v247, s20, v247
    v_fma_f32 v24, -v39, v35, v245
    v_fma_f32 v25, v39, v34, v247
    v_fma_f32 v39, v38, v35, v25
    v_fma_f32 v38, v38, v34, v24
    s_cmp_gt_u32 s5, 12
    s_cselect_b32 s20, 1.0, 0
    v_mul_f32 v240, s20, v240
    v_mul_f32 v242, s20, v242
    v_fma_f32 v24, -v37, v33, v240
    v_fma_f32 v25, v37, v32, v242
    v_fma_f32 v37, v36, v33, v25
    v_fma_f32 v36, v36, v32, v24
    v_mul_f32 v241, s20, v241
    v_mul_f32 v243, s20, v243
    v_fma_f32 v24, -v39, v35, v241
    v_fma_f32 v25, v39, v34, v243
    v_fma_f32 v39, v38, v35, v25
    v_fma_f32 v38, v38, v34, v24
    s_cmp_gt_u32 s5, 11
    s_cselect_b32 s20, 1.0, 0
    v_mul_f32 v236, s20, v236
    v_mul_f32 v238, s20, v238
    v_fma_f32 v24, -v37, v33, v236
    v_fma_f32 v25, v37, v32, v238
    v_fma_f32 v37, v36, v33, v25
    v_fma_f32 v36, v36, v32, v24
    v_mul_f32 v237, s20, v237
    v_mul_f32 v239, s20, v239
    v_fma_f32 v24, -v39, v35, v237
    v_fma_f32 v25, v39, v34, v239
    v_fma_f32 v39, v38, v35, v25
    v_fma_f32 v38, v38, v34, v24
    s_cmp_gt_u32 s5, 10
    s_cselect_b32 s20, 1.0, 0
    v_mul_f32 v232, s20, v232
    v_mul_f32 v234, s20, v234
    v_fma_f32 v24, -v37, v33, v232
    v_fma_f32 v25, v37, v32, v234
    v_fma_f32 v37, v36, v33, v25
    v_fma_f32 v36, v36, v32, v24
    v_mul_f32 v233, s20, v233
    v_mul_f32 v235, s20, v235
    v_fma_f32 v24, -v39, v35, v233
    v_fma_f32 v25, v39, v34, v235
    v_fma_f32 v39, v38, v35, v25
    v_fma_f32 v38, v38, v34, v24
    s_cmp_gt_u32 s5, 9
    s_cselect_b32 s20, 1.0, 0
    v_mul_f32 v228, s20, v228
    v_mul_f32 v230, s20, v230
    v_fma_f32 v24, -v37, v33, v228
    v_fma_f32 v25, v37, v32, v230
    v_fma_f32 v37, v36, v33, v25
    v_fma_f32 v36, v36, v32, v24
    v_mul_f32 v229, s20, v229
    v_mul_f32 v231, s20, v231
    v_fma_f32 v24, -v39, v35, v229
    v_fma_f32 v25, v39, v34, v231
    v_fma_f32 v39, v38, v35, v25
    v_fma_f32 v38, v38, v34, v24
    s_cmp_gt_u32 s5, 8
    s_cselect_b32 s20, 1.0, 0
    v_mul_f32 v224, s20, v224
    v_mul_f32 v226, s20, v226
    v_fma_f32 v24, -v37, v33, v224
    v_fma_f32 v25, v37, v32, v226
    v_fma_f32 v37, v36, v33, v25
    v_fma_f32 v36, v36, v32, v24
    v_mul_f32 v225, s20, v225
    v_mul_f32 v227, s20, v227
    v_fma_f32 v24, -v39, v35, v225
    v_fma_f32 v25, v39, v34, v227
    v_fma_f32 v39, v38, v35, v25
    v_fma_f32 v38, v38, v34, v24
    s_cmp_gt_u32 s5, 7
    s_cselect_b32 s20, 1.0, 0
    v_mul_f32 v220, s20, v220
    v_mul_f32 v222, s20, v222
    v_fma_f32 v24, -v37, v33, v220
    v_fma_f32 v25, v37, v32, v222
    v_fma_f32 v37, v36, v33, v25
    v_fma_f32 v36, v36, v32, v24
    v_mul_f32 v221, s20, v221
    v_mul_f32 v223, s20, v223
    v_fma_f32 v24, -v39, v35, v221
    v_fma_f32 v25, v39, v34, v223
    v_fma_f32 v39, v38, v35, v25
    v_fma_f32 v38, v38, v34, v24
    s_cmp_gt_u32 s5, 6
    s_cselect_b32 s20, 1.0, 0
    v_mul_f32 v216, s20, v216
    v_mul_f32 v218, s20, v218
    v_fma_f32 v24, -v37, v33, v216
    v_fma_f32 v25, v37, v32, v218
    v_fma_f32 v37, v36, v33, v25
    v_fma_f32 v36, v36, v32, v24
    v_mul_f32 v217, s20, v217
    v_mul_f32 v219, s20, v219
    v_fma_f32 v24, -v39, v35, v217
    v_fma_f32 v25, v39, v34, v219
    v_fma_f32 v39, v38, v35, v25
    v_fma_f32 v38, v38, v34, v24
    s_cmp_gt_u32 s5, 5
    s_cselect_b32 s20, 1.0, 0
    v_mul_f32 v212, s20, v212
    v_mul_f32 v214, s20, v214
    v_fma_f32 v24, -v37, v33, v212
    v_fma_f32 v25, v37, v32, v214
    v_fma_f32 v37, v36, v33, v25
    v_fma_f32 v36, v36, v32, v24
    v_mul_f32 v213, s20, v213
    v_mul_f32 v215, s20, v215
    v_fma_f32 v24, -v39, v35, v213
    v_fma_f32 v25, v39, v34, v215
    v_fma_f32 v39, v38, v35, v25
    v_fma_f32 v38, v38, v34, v24
    s_cmp_gt_u32 s5, 4
    s_cselect_b32 s20, 1.0, 0
    v_mul_f32 v208, s20, v208
    v_mul_f32 v210, s20, v210
    v_fma_f32 v24, -v37, v33, v208
    v_fma_f32 v25, v37, v32, v210
    v_fma_f32 v37, v36, v33, v25
    v_fma_f32 v36, v36, v32, v24
    v_mul_f32 v209, s20, v209
    v_mul_f32 v211, s20, v211
    v_fma_f32 v24, -v39, v35, v209
    v_fma_f32 v25, v39, v34, v211
    v_fma_f32 v39, v38, v35, v25
    v_fma_f32 v38, v38, v34, v24
    s_cmp_gt_u32 s5, 3
    s_cselect_b32 s20, 1.0, 0
    v_mul_f32 v204, s20, v204
    v_mul_f32 v206, s20, v206
    v_fma_f32 v24, -v37, v33, v204
    v_fma_f32 v25, v37, v32, v206
    v_fma_f32 v37, v36, v33, v25
    v_fma_f32 v36, v36, v32, v24
    v_mul_f32 v205, s20, v205
    v_mul_f32 v207, s20, v207
    v_fma_f32 v24, -v39, v35, v205
    v_fma_f32 v25, v39, v34, v207
    v_fma_f32 v39, v38, v35, v25
    v_fma_f32 v38, v38, v34, v24
    s_cmp_gt_u32 s5, 2
    s_cselect_b32 s20, 1.0, 0
    v_mul_f32 v200, s20, v200
    v_mul_f32 v202, s20, v202
    v_fma_f32 v24, -v37, v33, v200
    v_fma_f32 v25, v37, v32, v202
    v_fma_f32 v37, v36, v33, v25
    v_fma_f32 v36, v36, v32, v24
    v_mul_f32 v201, s20, v201
    v_mul_f32 v203, s20, v203
    v_fma_f32 v24, -v39, v35, v201
    v_fma_f32 v25, v39, v34, v203
    v_fma_f32 v39, v38, v35, v25
    v_fma_f32 v38, v38, v34, v24
    s_cmp_gt_u32 s5, 1
    s_cselect_b32 s20, 1.0, 0
    v_mul_f32 v196, s20, v196
    v_mul_f32 v198, s20, v198
    v_fma_f32 v24, -v37, v33, v196
    v_fma_f32 v25, v37, v32, v198
    v_fma_f32 v37, v36, v33, v25
    v_fma_f32 v36, v36, v32, v24
    v_mul_f32 v197, s20, v197
    v_mul_f32 v199, s20, v199
    v_fma_f32 v24, -v39, v35, v197
    v_fma_f32 v25, v39, v34, v199
    v_fma_f32 v39, v38, v35, v25
    v_fma_f32 v38, v38, v34, v24
    s_cmp_gt_u32 s5, 0
    s_cselect_b32 s20, 1.0, 0
    v_mul_f32 v192, s20, v192
    v_mul_f32 v194, s20, v194
    v_fma_f32 v24, -v37, v33, v192
    v_fma_f32 v25, v37, v32, v194
    v_fma_f32 v37, v36, v33, v25
    v_fma_f32 v36, v36, v32, v24
    v_mul_f32 v193, s20, v193
    v_mul_f32 v195, s20, v195
    v_fma_f32 v24, -v39, v35, v193
    v_fma_f32 v25, v39, v34, v195
    v_fma_f32 v39, v38, v35, v25
    v_fma_f32 v38, v38, v34, v24
wb_h0:
    s_waitcnt vmcnt(0)
    v_lshrrev_b32 v10, 4, v5
    v_mul_u32_u24 v10, 1088, v10
    v_bfe_u32 v11, v5, 2, 2
    v_mul_u32_u24 v11, 272, v11
    v_add_u32 v10, v10, v11
    v_and_b32 v11, 3, v5
    v_lshl_add_u32 v10, v11, 2, v10
    s_movk_i32 s20, 224
    v_cmp_gt_u32 vcc, s20, v0
    s_and_saveexec_b64 s[38:39], vcc
    v_mul_f32 v24, v37, v29
    v_mul_f32 v25, v37, v28
    v_fma_f32 v37, v36, v29, v25
    v_fma_f32 v36, v36, v28, -v24
    v_add_f32 v64, v64, v36
    v_add_f32 v66, v66, v37
    v_mul_f32 v24, v39, v31
    v_mul_f32 v25, v39, v30
    v_fma_f32 v39, v38, v31, v25
    v_fma_f32 v38, v38, v30, -v24
    v_add_f32 v65, v65, v38
    v_add_f32 v67, v67, v39
    v_cvt_pk_bf16_f32 v64, v64, v65
    v_cvt_pk_bf16_f32 v66, -v66, -v67
    ds_write_b32 v10, v64 offset:0
    ds_write_b32 v10, v66 offset:15232
    v_mul_f32 v24, v37, v29
    v_mul_f32 v25, v37, v28
    v_fma_f32 v37, v36, v29, v25
    v_fma_f32 v36, v36, v28, -v24
    v_add_f32 v68, v68, v36
    v_add_f32 v70, v70, v37
    v_mul_f32 v24, v39, v31
    v_mul_f32 v25, v39, v30
    v_fma_f32 v39, v38, v31, v25
    v_fma_f32 v38, v38, v30, -v24
    v_add_f32 v69, v69, v38
    v_add_f32 v71, v71, v39
    v_cvt_pk_bf16_f32 v68, v68, v69
    v_cvt_pk_bf16_f32 v70, -v70, -v71
    ds_write_b32 v10, v68 offset:16
    ds_write_b32 v10, v70 offset:15248
    v_mul_f32 v24, v37, v29
    v_mul_f32 v25, v37, v28
    v_fma_f32 v37, v36, v29, v25
    v_fma_f32 v36, v36, v28, -v24
    v_add_f32 v72, v72, v36
    v_add_f32 v74, v74, v37
    v_mul_f32 v24, v39, v31
    v_mul_f32 v25, v39, v30
    v_fma_f32 v39, v38, v31, v25
    v_fma_f32 v38, v38, v30, -v24
    v_add_f32 v73, v73, v38
    v_add_f32 v75, v75, v39
    v_cvt_pk_bf16_f32 v72, v72, v73
    v_cvt_pk_bf16_f32 v74, -v74, -v75
    ds_write_b32 v10, v72 offset:32
    ds_write_b32 v10, v74 offset:15264
    v_mul_f32 v24, v37, v29
    v_mul_f32 v25, v37, v28
    v_fma_f32 v37, v36, v29, v25
    v_fma_f32 v36, v36, v28, -v24
    v_add_f32 v76, v76, v36
    v_add_f32 v78, v78, v37
    v_mul_f32 v24, v39, v31
    v_mul_f32 v25, v39, v30
    v_fma_f32 v39, v38, v31, v25
    v_fma_f32 v38, v38, v30, -v24
    v_add_f32 v77, v77, v38
    v_add_f32 v79, v79, v39
    v_cvt_pk_bf16_f32 v76, v76, v77
    v_cvt_pk_bf16_f32 v78, -v78, -v79
    ds_write_b32 v10, v76 offset:48
    ds_write_b32 v10, v78 offset:15280
    v_mul_f32 v24, v37, v29
    v_mul_f32 v25, v37, v28
    v_fma_f32 v37, v36, v29, v25
    v_fma_f32 v36, v36, v28, -v24
    v_add_f32 v80, v80, v36
    v_add_f32 v82, v82, v37
    v_mul_f32 v24, v39, v31
    v_mul_f32 v25, v39, v30
    v_fma_f32 v39, v38, v31, v25
    v_fma_f32 v38, v38, v30, -v24
    v_add_f32 v81, v81, v38
    v_add_f32 v83, v83, v39
    v_cvt_pk_bf16_f32 v80, v80, v81
    v_cvt_pk_bf16_f32 v82, -v82, -v83
    ds_write_b32 v10, v80 offset:64
    ds_write_b32 v10, v82 offset:15296
    v_mul_f32 v24, v37, v29
    v_mul_f32 v25, v37, v28
    v_fma_f32 v37, v36, v29, v25
    v_fma_f32 v36, v36, v28, -v24
    v_add_f32 v84, v84, v36
    v_add_f32 v86, v86, v37
    v_mul_f32 v24, v39, v31
    v_mul_f32 v25, v39, v30
    v_fma_f32 v39, v38, v31, v25
    v_fma_f32 v38, v38, v30, -v24
    v_add_f32 v85, v85, v38
    v_add_f32 v87, v87, v39
    v_cvt_pk_bf16_f32 v84, v84, v85
    v_cvt_pk_bf16_f32 v86, -v86, -v87
    ds_write_b32 v10, v84 offset:80
    ds_write_b32 v10, v86 offset:15312
    v_mul_f32 v24, v37, v29
    v_mul_f32 v25, v37, v28
    v_fma_f32 v37, v36, v29, v25
    v_fma_f32 v36, v36, v28, -v24
    v_add_f32 v88, v88, v36
    v_add_f32 v90, v90, v37
    v_mul_f32 v24, v39, v31
    v_mul_f32 v25, v39, v30
    v_fma_f32 v39, v38, v31, v25
    v_fma_f32 v38, v38, v30, -v24
    v_add_f32 v89, v89, v38
    v_add_f32 v91, v91, v39
    v_cvt_pk_bf16_f32 v88, v88, v89
    v_cvt_pk_bf16_f32 v90, -v90, -v91
    ds_write_b32 v10, v88 offset:96
    ds_write_b32 v10, v90 offset:15328
    v_mul_f32 v24, v37, v29
    v_mul_f32 v25, v37, v28
    v_fma_f32 v37, v36, v29, v25
    v_fma_f32 v36, v36, v28, -v24
    v_add_f32 v92, v92, v36
    v_add_f32 v94, v94, v37
    v_mul_f32 v24, v39, v31
    v_mul_f32 v25, v39, v30
    v_fma_f32 v39, v38, v31, v25
    v_fma_f32 v38, v38, v30, -v24
    v_add_f32 v93, v93, v38
    v_add_f32 v95, v95, v39
    v_cvt_pk_bf16_f32 v92, v92, v93
    v_cvt_pk_bf16_f32 v94, -v94, -v95
    ds_write_b32 v10, v92 offset:112
    ds_write_b32 v10, v94 offset:15344
    v_mul_f32 v24, v37, v29
    v_mul_f32 v25, v37, v28
    v_fma_f32 v37, v36, v29, v25
    v_fma_f32 v36, v36, v28, -v24
    v_add_f32 v96, v96, v36
    v_add_f32 v98, v98, v37
    v_mul_f32 v24, v39, v31
    v_mul_f32 v25, v39, v30
    v_fma_f32 v39, v38, v31, v25
    v_fma_f32 v38, v38, v30, -v24
    v_add_f32 v97, v97, v38
    v_add_f32 v99, v99, v39
    v_cvt_pk_bf16_f32 v96, v96, v97
    v_cvt_pk_bf16_f32 v98, -v98, -v99
    ds_write_b32 v10, v96 offset:128
    ds_write_b32 v10, v98 offset:15360
    v_mul_f32 v24, v37, v29
    v_mul_f32 v25, v37, v28
    v_fma_f32 v37, v36, v29, v25
    v_fma_f32 v36, v36, v28, -v24
    v_add_f32 v100, v100, v36
    v_add_f32 v102, v102, v37
    v_mul_f32 v24, v39, v31
    v_mul_f32 v25, v39, v30
    v_fma_f32 v39, v38, v31, v25
    v_fma_f32 v38, v38, v30, -v24
    v_add_f32 v101, v101, v38
    v_add_f32 v103, v103, v39
    v_cvt_pk_bf16_f32 v100, v100, v101
    v_cvt_pk_bf16_f32 v102, -v102, -v103
    ds_write_b32 v10, v100 offset:144
    ds_write_b32 v10, v102 offset:15376
    v_mul_f32 v24, v37, v29
    v_mul_f32 v25, v37, v28
    v_fma_f32 v37, v36, v29, v25
    v_fma_f32 v36, v36, v28, -v24
    v_add_f32 v104, v104, v36
    v_add_f32 v106, v106, v37
    v_mul_f32 v24, v39, v31
    v_mul_f32 v25, v39, v30
    v_fma_f32 v39, v38, v31, v25
    v_fma_f32 v38, v38, v30, -v24
    v_add_f32 v105, v105, v38
    v_add_f32 v107, v107, v39
    v_cvt_pk_bf16_f32 v104, v104, v105
    v_cvt_pk_bf16_f32 v106, -v106, -v107
    ds_write_b32 v10, v104 offset:160
    ds_write_b32 v10, v106 offset:15392
    v_mul_f32 v24, v37, v29
    v_mul_f32 v25, v37, v28
    v_fma_f32 v37, v36, v29, v25
    v_fma_f32 v36, v36, v28, -v24
    v_add_f32 v108, v108, v36
    v_add_f32 v110, v110, v37
    v_mul_f32 v24, v39, v31
    v_mul_f32 v25, v39, v30
    v_fma_f32 v39, v38, v31, v25
    v_fma_f32 v38, v38, v30, -v24
    v_add_f32 v109, v109, v38
    v_add_f32 v111, v111, v39
    v_cvt_pk_bf16_f32 v108, v108, v109
    v_cvt_pk_bf16_f32 v110, -v110, -v111
    ds_write_b32 v10, v108 offset:176
    ds_write_b32 v10, v110 offset:15408
    v_mul_f32 v24, v37, v29
    v_mul_f32 v25, v37, v28
    v_fma_f32 v37, v36, v29, v25
    v_fma_f32 v36, v36, v28, -v24
    v_add_f32 v112, v112, v36
    v_add_f32 v114, v114, v37
    v_mul_f32 v24, v39, v31
    v_mul_f32 v25, v39, v30
    v_fma_f32 v39, v38, v31, v25
    v_fma_f32 v38, v38, v30, -v24
    v_add_f32 v113, v113, v38
    v_add_f32 v115, v115, v39
    v_cvt_pk_bf16_f32 v112, v112, v113
    v_cvt_pk_bf16_f32 v114, -v114, -v115
    ds_write_b32 v10, v112 offset:192
    ds_write_b32 v10, v114 offset:15424
    v_mul_f32 v24, v37, v29
    v_mul_f32 v25, v37, v28
    v_fma_f32 v37, v36, v29, v25
    v_fma_f32 v36, v36, v28, -v24
    v_add_f32 v116, v116, v36
    v_add_f32 v118, v118, v37
    v_mul_f32 v24, v39, v31
    v_mul_f32 v25, v39, v30
    v_fma_f32 v39, v38, v31, v25
    v_fma_f32 v38, v38, v30, -v24
    v_add_f32 v117, v117, v38
    v_add_f32 v119, v119, v39
    v_cvt_pk_bf16_f32 v116, v116, v117
    v_cvt_pk_bf16_f32 v118, -v118, -v119
    ds_write_b32 v10, v116 offset:208
    ds_write_b32 v10, v118 offset:15440
    v_mul_f32 v24, v37, v29
    v_mul_f32 v25, v37, v28
    v_fma_f32 v37, v36, v29, v25
    v_fma_f32 v36, v36, v28, -v24
    v_add_f32 v120, v120, v36
    v_add_f32 v122, v122, v37
    v_mul_f32 v24, v39, v31
    v_mul_f32 v25, v39, v30
    v_fma_f32 v39, v38, v31, v25
    v_fma_f32 v38, v38, v30, -v24
    v_add_f32 v121, v121, v38
    v_add_f32 v123, v123, v39
    v_cvt_pk_bf16_f32 v120, v120, v121
    v_cvt_pk_bf16_f32 v122, -v122, -v123
    ds_write_b32 v10, v120 offset:224
    ds_write_b32 v10, v122 offset:15456
    v_mul_f32 v24, v37, v29
    v_mul_f32 v25, v37, v28
    v_fma_f32 v37, v36, v29, v25
    v_fma_f32 v36, v36, v28, -v24
    v_add_f32 v124, v124, v36
    v_add_f32 v126, v126, v37
    v_mul_f32 v24, v39, v31
    v_mul_f32 v25, v39, v30
    v_fma_f32 v39, v38, v31, v25
    v_fma_f32 v38, v38, v30, -v24
    v_add_f32 v125, v125, v38
    v_add_f32 v127, v127, v39
    v_cvt_pk_bf16_f32 v124, v124, v125
    v_cvt_pk_bf16_f32 v126, -v126, -v127
    ds_write_b32 v10, v124 offset:240
    ds_write_b32 v10, v126 offset:15472
    v_mul_f32 v24, v37, v29
    v_mul_f32 v25, v37, v28
    v_fma_f32 v37, v36, v29, v25
    v_fma_f32 v36, v36, v28, -v24
    v_add_f32 v128, v128, v36
    v_add_f32 v130, v130, v37
    v_mul_f32 v24, v39, v31
    v_mul_f32 v25, v39, v30
    v_fma_f32 v39, v38, v31, v25
    v_fma_f32 v38, v38, v30, -v24
    v_add_f32 v129, v129, v38
    v_add_f32 v131, v131, v39
    v_cvt_pk_bf16_f32 v128, v128, v129
    v_cvt_pk_bf16_f32 v130, -v130, -v131
    ds_write_b32 v10, v128 offset:30464
    ds_write_b32 v10, v130 offset:45696
    v_mul_f32 v24, v37, v29
    v_mul_f32 v25, v37, v28
    v_fma_f32 v37, v36, v29, v25
    v_fma_f32 v36, v36, v28, -v24
    v_add_f32 v132, v132, v36
    v_add_f32 v134, v134, v37
    v_mul_f32 v24, v39, v31
    v_mul_f32 v25, v39, v30
    v_fma_f32 v39, v38, v31, v25
    v_fma_f32 v38, v38, v30, -v24
    v_add_f32 v133, v133, v38
    v_add_f32 v135, v135, v39
    v_cvt_pk_bf16_f32 v132, v132, v133
    v_cvt_pk_bf16_f32 v134, -v134, -v135
    ds_write_b32 v10, v132 offset:30480
    ds_write_b32 v10, v134 offset:45712
    v_mul_f32 v24, v37, v29
    v_mul_f32 v25, v37, v28
    v_fma_f32 v37, v36, v29, v25
    v_fma_f32 v36, v36, v28, -v24
    v_add_f32 v136, v136, v36
    v_add_f32 v138, v138, v37
    v_mul_f32 v24, v39, v31
    v_mul_f32 v25, v39, v30
    v_fma_f32 v39, v38, v31, v25
    v_fma_f32 v38, v38, v30, -v24
    v_add_f32 v137, v137, v38
    v_add_f32 v139, v139, v39
    v_cvt_pk_bf16_f32 v136, v136, v137
    v_cvt_pk_bf16_f32 v138, -v138, -v139
    ds_write_b32 v10, v136 offset:30496
    ds_write_b32 v10, v138 offset:45728
    v_mul_f32 v24, v37, v29
    v_mul_f32 v25, v37, v28
    v_fma_f32 v37, v36, v29, v25
    v_fma_f32 v36, v36, v28, -v24
    v_add_f32 v140, v140, v36
    v_add_f32 v142, v142, v37
    v_mul_f32 v24, v39, v31
    v_mul_f32 v25, v39, v30
    v_fma_f32 v39, v38, v31, v25
    v_fma_f32 v38, v38, v30, -v24
    v_add_f32 v141, v141, v38
    v_add_f32 v143, v143, v39
    v_cvt_pk_bf16_f32 v140, v140, v141
    v_cvt_pk_bf16_f32 v142, -v142, -v143
    ds_write_b32 v10, v140 offset:30512
    ds_write_b32 v10, v142 offset:45744
    v_mul_f32 v24, v37, v29
    v_mul_f32 v25, v37, v28
    v_fma_f32 v37, v36, v29, v25
    v_fma_f32 v36, v36, v28, -v24
    v_add_f32 v144, v144, v36
    v_add_f32 v146, v146, v37
    v_mul_f32 v24, v39, v31
    v_mul_f32 v25, v39, v30
    v_fma_f32 v39, v38, v31, v25
    v_fma_f32 v38, v38, v30, -v24
    v_add_f32 v145, v145, v38
    v_add_f32 v147, v147, v39
    v_cvt_pk_bf16_f32 v144, v144, v145
    v_cvt_pk_bf16_f32 v146, -v146, -v147
    ds_write_b32 v10, v144 offset:30528
    ds_write_b32 v10, v146 offset:45760
    v_mul_f32 v24, v37, v29
    v_mul_f32 v25, v37, v28
    v_fma_f32 v37, v36, v29, v25
    v_fma_f32 v36, v36, v28, -v24
    v_add_f32 v148, v148, v36
    v_add_f32 v150, v150, v37
    v_mul_f32 v24, v39, v31
    v_mul_f32 v25, v39, v30
    v_fma_f32 v39, v38, v31, v25
    v_fma_f32 v38, v38, v30, -v24
    v_add_f32 v149, v149, v38
    v_add_f32 v151, v151, v39
    v_cvt_pk_bf16_f32 v148, v148, v149
    v_cvt_pk_bf16_f32 v150, -v150, -v151
    ds_write_b32 v10, v148 offset:30544
    ds_write_b32 v10, v150 offset:45776
    v_mul_f32 v24, v37, v29
    v_mul_f32 v25, v37, v28
    v_fma_f32 v37, v36, v29, v25
    v_fma_f32 v36, v36, v28, -v24
    v_add_f32 v152, v152, v36
    v_add_f32 v154, v154, v37
    v_mul_f32 v24, v39, v31
    v_mul_f32 v25, v39, v30
    v_fma_f32 v39, v38, v31, v25
    v_fma_f32 v38, v38, v30, -v24
    v_add_f32 v153, v153, v38
    v_add_f32 v155, v155, v39
    v_cvt_pk_bf16_f32 v152, v152, v153
    v_cvt_pk_bf16_f32 v154, -v154, -v155
    ds_write_b32 v10, v152 offset:30560
    ds_write_b32 v10, v154 offset:45792
    v_mul_f32 v24, v37, v29
    v_mul_f32 v25, v37, v28
    v_fma_f32 v37, v36, v29, v25
    v_fma_f32 v36, v36, v28, -v24
    v_add_f32 v156, v156, v36
    v_add_f32 v158, v158, v37
    v_mul_f32 v24, v39, v31
    v_mul_f32 v25, v39, v30
    v_fma_f32 v39, v38, v31, v25
    v_fma_f32 v38, v38, v30, -v24
    v_add_f32 v157, v157, v38
    v_add_f32 v159, v159, v39
    v_cvt_pk_bf16_f32 v156, v156, v157
    v_cvt_pk_bf16_f32 v158, -v158, -v159
    ds_write_b32 v10, v156 offset:30576
    ds_write_b32 v10, v158 offset:45808
    v_mul_f32 v24, v37, v29
    v_mul_f32 v25, v37, v28
    v_fma_f32 v37, v36, v29, v25
    v_fma_f32 v36, v36, v28, -v24
    v_add_f32 v160, v160, v36
    v_add_f32 v162, v162, v37
    v_mul_f32 v24, v39, v31
    v_mul_f32 v25, v39, v30
    v_fma_f32 v39, v38, v31, v25
    v_fma_f32 v38, v38, v30, -v24
    v_add_f32 v161, v161, v38
    v_add_f32 v163, v163, v39
    v_cvt_pk_bf16_f32 v160, v160, v161
    v_cvt_pk_bf16_f32 v162, -v162, -v163
    ds_write_b32 v10, v160 offset:30592
    ds_write_b32 v10, v162 offset:45824
    v_mul_f32 v24, v37, v29
    v_mul_f32 v25, v37, v28
    v_fma_f32 v37, v36, v29, v25
    v_fma_f32 v36, v36, v28, -v24
    v_add_f32 v164, v164, v36
    v_add_f32 v166, v166, v37
    v_mul_f32 v24, v39, v31
    v_mul_f32 v25, v39, v30
    v_fma_f32 v39, v38, v31, v25
    v_fma_f32 v38, v38, v30, -v24
    v_add_f32 v165, v165, v38
    v_add_f32 v167, v167, v39
    v_cvt_pk_bf16_f32 v164, v164, v165
    v_cvt_pk_bf16_f32 v166, -v166, -v167
    ds_write_b32 v10, v164 offset:30608
    ds_write_b32 v10, v166 offset:45840
    v_mul_f32 v24, v37, v29
    v_mul_f32 v25, v37, v28
    v_fma_f32 v37, v36, v29, v25
    v_fma_f32 v36, v36, v28, -v24
    v_add_f32 v168, v168, v36
    v_add_f32 v170, v170, v37
    v_mul_f32 v24, v39, v31
    v_mul_f32 v25, v39, v30
    v_fma_f32 v39, v38, v31, v25
    v_fma_f32 v38, v38, v30, -v24
    v_add_f32 v169, v169, v38
    v_add_f32 v171, v171, v39
    v_cvt_pk_bf16_f32 v168, v168, v169
    v_cvt_pk_bf16_f32 v170, -v170, -v171
    ds_write_b32 v10, v168 offset:30624
    ds_write_b32 v10, v170 offset:45856
    v_mul_f32 v24, v37, v29
    v_mul_f32 v25, v37, v28
    v_fma_f32 v37, v36, v29, v25
    v_fma_f32 v36, v36, v28, -v24
    v_add_f32 v172, v172, v36
    v_add_f32 v174, v174, v37
    v_mul_f32 v24, v39, v31
    v_mul_f32 v25, v39, v30
    v_fma_f32 v39, v38, v31, v25
    v_fma_f32 v38, v38, v30, -v24
    v_add_f32 v173, v173, v38
    v_add_f32 v175, v175, v39
    v_cvt_pk_bf16_f32 v172, v172, v173
    v_cvt_pk_bf16_f32 v174, -v174, -v175
    ds_write_b32 v10, v172 offset:30640
    ds_write_b32 v10, v174 offset:45872
    v_mul_f32 v24, v37, v29
    v_mul_f32 v25, v37, v28
    v_fma_f32 v37, v36, v29, v25
    v_fma_f32 v36, v36, v28, -v24
    v_add_f32 v176, v176, v36
    v_add_f32 v178, v178, v37
    v_mul_f32 v24, v39, v31
    v_mul_f32 v25, v39, v30
    v_fma_f32 v39, v38, v31, v25
    v_fma_f32 v38, v38, v30, -v24
    v_add_f32 v177, v177, v38
    v_add_f32 v179, v179, v39
    v_cvt_pk_bf16_f32 v176, v176, v177
    v_cvt_pk_bf16_f32 v178, -v178, -v179
    ds_write_b32 v10, v176 offset:30656
    ds_write_b32 v10, v178 offset:45888
    v_mul_f32 v24, v37, v29
    v_mul_f32 v25, v37, v28
    v_fma_f32 v37, v36, v29, v25
    v_fma_f32 v36, v36, v28, -v24
    v_add_f32 v180, v180, v36
    v_add_f32 v182, v182, v37
    v_mul_f32 v24, v39, v31
    v_mul_f32 v25, v39, v30
    v_fma_f32 v39, v38, v31, v25
    v_fma_f32 v38, v38, v30, -v24
    v_add_f32 v181, v181, v38
    v_add_f32 v183, v183, v39
    v_cvt_pk_bf16_f32 v180, v180, v181
    v_cvt_pk_bf16_f32 v182, -v182, -v183
    ds_write_b32 v10, v180 offset:30672
    ds_write_b32 v10, v182 offset:45904
    v_mul_f32 v24, v37, v29
    v_mul_f32 v25, v37, v28
    v_fma_f32 v37, v36, v29, v25
    v_fma_f32 v36, v36, v28, -v24
    v_add_f32 v184, v184, v36
    v_add_f32 v186, v186, v37
    v_mul_f32 v24, v39, v31
    v_mul_f32 v25, v39, v30
    v_fma_f32 v39, v38, v31, v25
    v_fma_f32 v38, v38, v30, -v24
    v_add_f32 v185, v185, v38
    v_add_f32 v187, v187, v39
    v_cvt_pk_bf16_f32 v184, v184, v185
    v_cvt_pk_bf16_f32 v186, -v186, -v187
    ds_write_b32 v10, v184 offset:30688
    ds_write_b32 v10, v186 offset:45920
    v_mul_f32 v24, v37, v29
    v_mul_f32 v25, v37, v28
    v_fma_f32 v37, v36, v29, v25
    v_fma_f32 v36, v36, v28, -v24
    v_add_f32 v188, v188, v36
    v_add_f32 v190, v190, v37
    v_mul_f32 v24, v39, v31
    v_mul_f32 v25, v39, v30
    v_fma_f32 v39, v38, v31, v25
    v_fma_f32 v38, v38, v30, -v24
    v_add_f32 v189, v189, v38
    v_add_f32 v191, v191, v39
    v_cvt_pk_bf16_f32 v188, v188, v189
    v_cvt_pk_bf16_f32 v190, -v190, -v191
    ds_write_b32 v10, v188 offset:30704
    ds_write_b32 v10, v190 offset:45936
    s_mov_b64 exec, s[38:39]
    s_waitcnt lgkmcnt(0)
    s_barrier
    s_mul_i32 s20, s3, 7616
    v_mul_u32_u24 v10, 272, v3
    v_lshl_add_u32 v10, v2, 4, v10
    v_add_u32 v10, s20, v10
    ds_read_b128 v[64:67], v10 offset:0
    ds_read_b128 v[68:71], v10 offset:1088
    ds_read_b128 v[72:75], v10 offset:2176
    ds_read_b128 v[76:79], v10 offset:3264
    ds_read_b128 v[80:83], v10 offset:4352
    ds_read_b128 v[84:87], v10 offset:5440
    ds_read_b128 v[88:91], v10 offset:6528
    ds_read_b128 v[92:95], v10 offset:30464
    ds_read_b128 v[96:99], v10 offset:31552
    ds_read_b128 v[100:103], v10 offset:32640
    ds_read_b128 v[104:107], v10 offset:33728
    ds_read_b128 v[108:111], v10 offset:34816
    ds_read_b128 v[112:115], v10 offset:35904
    ds_read_b128 v[116:119], v10 offset:36992
    s_waitcnt lgkmcnt(0)
    s_barrier
    v_mfma_f32_16x16x32_bf16 v[128:131], a[0:3], v[64:67], 0
    v_mfma_f32_16x16x32_bf16 v[156:159], a[0:3], v[92:95], 0
    v_mfma_f32_16x16x32_bf16 v[132:135], a[28:31], v[64:67], 0
    v_mfma_f32_16x16x32_bf16 v[160:163], a[28:31], v[92:95], 0
    v_mfma_f32_16x16x32_bf16 v[136:139], a[56:59], v[64:67], 0
    v_mfma_f32_16x16x32_bf16 v[164:167], a[56:59], v[92:95], 0
    v_mfma_f32_16x16x32_bf16 v[140:143], a[84:87], v[64:67], 0
    v_mfma_f32_16x16x32_bf16 v[168:171], a[84:87], v[92:95], 0
    v_mfma_f32_16x16x32_bf16 v[144:147], a[112:115], v[64:67], 0
    v_mfma_f32_16x16x32_bf16 v[172:175], a[112:115], v[92:95], 0
    v_mfma_f32_16x16x32_bf16 v[148:151], a[140:143], v[64:67], 0
    v_mfma_f32_16x16x32_bf16 v[176:179], a[140:143], v[92:95], 0
    v_mfma_f32_16x16x32_bf16 v[152:155], a[168:171], v[64:67], 0
    v_mfma_f32_16x16x32_bf16 v[180:183], a[168:171], v[92:95], 0
    v_mfma_f32_16x16x32_bf16 v[128:131], a[4:7], v[68:71], v[128:131]
    v_mfma_f32_16x16x32_bf16 v[156:159], a[4:7], v[96:99], v[156:159]
    v_mfma_f32_16x16x32_bf16 v[132:135], a[32:35], v[68:71], v[132:135]
    v_mfma_f32_16x16x32_bf16 v[160:163], a[32:35], v[96:99], v[160:163]
    v_mfma_f32_16x16x32_bf16 v[136:139], a[60:63], v[68:71], v[136:139]
    v_mfma_f32_16x16x32_bf16 v[164:167], a[60:63], v[96:99], v[164:167]
    v_mfma_f32_16x16x32_bf16 v[140:143], a[88:91], v[68:71], v[140:143]
    v_mfma_f32_16x16x32_bf16 v[168:171], a[88:91], v[96:99], v[168:171]
    v_mfma_f32_16x16x32_bf16 v[144:147], a[116:119], v[68:71], v[144:147]
    v_mfma_f32_16x16x32_bf16 v[172:175], a[116:119], v[96:99], v[172:175]
    v_mfma_f32_16x16x32_bf16 v[148:151], a[144:147], v[68:71], v[148:151]
    v_mfma_f32_16x16x32_bf16 v[176:179], a[144:147], v[96:99], v[176:179]
    v_mfma_f32_16x16x32_bf16 v[152:155], a[172:175], v[68:71], v[152:155]
    v_mfma_f32_16x16x32_bf16 v[180:183], a[172:175], v[96:99], v[180:183]
    v_mfma_f32_16x16x32_bf16 v[128:131], a[8:11], v[72:75], v[128:131]
    v_mfma_f32_16x16x32_bf16 v[156:159], a[8:11], v[100:103], v[156:159]
    v_mfma_f32_16x16x32_bf16 v[132:135], a[36:39], v[72:75], v[132:135]
    v_mfma_f32_16x16x32_bf16 v[160:163], a[36:39], v[100:103], v[160:163]
    v_mfma_f32_16x16x32_bf16 v[136:139], a[64:67], v[72:75], v[136:139]
    v_mfma_f32_16x16x32_bf16 v[164:167], a[64:67], v[100:103], v[164:167]
    v_mfma_f32_16x16x32_bf16 v[140:143], a[92:95], v[72:75], v[140:143]
    v_mfma_f32_16x16x32_bf16 v[168:171], a[92:95], v[100:103], v[168:171]
    v_mfma_f32_16x16x32_bf16 v[144:147], a[120:123], v[72:75], v[144:147]
    v_mfma_f32_16x16x32_bf16 v[172:175], a[120:123], v[100:103], v[172:175]
    v_mfma_f32_16x16x32_bf16 v[148:151], a[148:151], v[72:75], v[148:151]
    v_mfma_f32_16x16x32_bf16 v[176:179], a[148:151], v[100:103], v[176:179]
    v_mfma_f32_16x16x32_bf16 v[152:155], a[176:179], v[72:75], v[152:155]
    v_mfma_f32_16x16x32_bf16 v[180:183], a[176:179], v[100:103], v[180:183]
    v_mfma_f32_16x16x32_bf16 v[128:131], a[12:15], v[76:79], v[128:131]
    v_mfma_f32_16x16x32_bf16 v[156:159], a[12:15], v[104:107], v[156:159]
    v_mfma_f32_16x16x32_bf16 v[132:135], a[40:43], v[76:79], v[132:135]
    v_mfma_f32_16x16x32_bf16 v[160:163], a[40:43], v[104:107], v[160:163]
    v_mfma_f32_16x16x32_bf16 v[136:139], a[68:71], v[76:79], v[136:139]
    v_mfma_f32_16x16x32_bf16 v[164:167], a[68:71], v[104:107], v[164:167]
    v_mfma_f32_16x16x32_bf16 v[140:143], a[96:99], v[76:79], v[140:143]
    v_mfma_f32_16x16x32_bf16 v[168:171], a[96:99], v[104:107], v[168:171]
    v_mfma_f32_16x16x32_bf16 v[144:147], a[124:127], v[76:79], v[144:147]
    v_mfma_f32_16x16x32_bf16 v[172:175], a[124:127], v[104:107], v[172:175]
    v_mfma_f32_16x16x32_bf16 v[148:151], a[152:155], v[76:79], v[148:151]
    v_mfma_f32_16x16x32_bf16 v[176:179], a[152:155], v[104:107], v[176:179]
    v_mfma_f32_16x16x32_bf16 v[152:155], a[180:183], v[76:79], v[152:155]
    v_mfma_f32_16x16x32_bf16 v[180:183], a[180:183], v[104:107], v[180:183]
    v_mfma_f32_16x16x32_bf16 v[128:131], a[16:19], v[80:83], v[128:131]
    v_mfma_f32_16x16x32_bf16 v[156:159], a[16:19], v[108:111], v[156:159]
    v_mfma_f32_16x16x32_bf16 v[132:135], a[44:47], v[80:83], v[132:135]
    v_mfma_f32_16x16x32_bf16 v[160:163], a[44:47], v[108:111], v[160:163]
    v_mfma_f32_16x16x32_bf16 v[136:139], a[72:75], v[80:83], v[136:139]
    v_mfma_f32_16x16x32_bf16 v[164:167], a[72:75], v[108:111], v[164:167]
    v_mfma_f32_16x16x32_bf16 v[140:143], a[100:103], v[80:83], v[140:143]
    v_mfma_f32_16x16x32_bf16 v[168:171], a[100:103], v[108:111], v[168:171]
    v_mfma_f32_16x16x32_bf16 v[144:147], a[128:131], v[80:83], v[144:147]
    v_mfma_f32_16x16x32_bf16 v[172:175], a[128:131], v[108:111], v[172:175]
    v_mfma_f32_16x16x32_bf16 v[148:151], a[156:159], v[80:83], v[148:151]
    v_mfma_f32_16x16x32_bf16 v[176:179], a[156:159], v[108:111], v[176:179]
    v_mfma_f32_16x16x32_bf16 v[152:155], a[184:187], v[80:83], v[152:155]
    v_mfma_f32_16x16x32_bf16 v[180:183], a[184:187], v[108:111], v[180:183]
    v_mfma_f32_16x16x32_bf16 v[128:131], a[20:23], v[84:87], v[128:131]
    v_mfma_f32_16x16x32_bf16 v[156:159], a[20:23], v[112:115], v[156:159]
    v_mfma_f32_16x16x32_bf16 v[132:135], a[48:51], v[84:87], v[132:135]
    v_mfma_f32_16x16x32_bf16 v[160:163], a[48:51], v[112:115], v[160:163]
    v_mfma_f32_16x16x32_bf16 v[136:139], a[76:79], v[84:87], v[136:139]
    v_mfma_f32_16x16x32_bf16 v[164:167], a[76:79], v[112:115], v[164:167]
    v_mfma_f32_16x16x32_bf16 v[140:143], a[104:107], v[84:87], v[140:143]
    v_mfma_f32_16x16x32_bf16 v[168:171], a[104:107], v[112:115], v[168:171]
    v_mfma_f32_16x16x32_bf16 v[144:147], a[132:135], v[84:87], v[144:147]
    v_mfma_f32_16x16x32_bf16 v[172:175], a[132:135], v[112:115], v[172:175]
    v_mfma_f32_16x16x32_bf16 v[148:151], a[160:163], v[84:87], v[148:151]
    v_mfma_f32_16x16x32_bf16 v[176:179], a[160:163], v[112:115], v[176:179]
    v_mfma_f32_16x16x32_bf16 v[152:155], a[188:191], v[84:87], v[152:155]
    v_mfma_f32_16x16x32_bf16 v[180:183], a[188:191], v[112:115], v[180:183]
    v_mfma_f32_16x16x32_bf16 v[128:131], a[24:27], v[88:91], v[128:131]
    v_mfma_f32_16x16x32_bf16 v[156:159], a[24:27], v[116:119], v[156:159]
    v_mfma_f32_16x16x32_bf16 v[132:135], a[52:55], v[88:91], v[132:135]
    v_mfma_f32_16x16x32_bf16 v[160:163], a[52:55], v[116:119], v[160:163]
    v_mfma_f32_16x16x32_bf16 v[136:139], a[80:83], v[88:91], v[136:139]
    v_mfma_f32_16x16x32_bf16 v[164:167], a[80:83], v[116:119], v[164:167]
    v_mfma_f32_16x16x32_bf16 v[140:143], a[108:111], v[88:91], v[140:143]
    v_mfma_f32_16x16x32_bf16 v[168:171], a[108:111], v[116:119], v[168:171]
    v_mfma_f32_16x16x32_bf16 v[144:147], a[136:139], v[88:91], v[144:147]
    v_mfma_f32_16x16x32_bf16 v[172:175], a[136:139], v[116:119], v[172:175]
    v_mfma_f32_16x16x32_bf16 v[148:151], a[164:167], v[88:91], v[148:151]
    v_mfma_f32_16x16x32_bf16 v[176:179], a[164:167], v[116:119], v[176:179]
    v_mfma_f32_16x16x32_bf16 v[152:155], a[192:195], v[88:91], v[152:155]
    v_mfma_f32_16x16x32_bf16 v[180:183], a[192:195], v[116:119], v[180:183]
    s_mul_i32 s20, s3, 14336
    v_lshlrev_b32 v10, 4, v1
    v_add_u32 v11, s20, v10
    s_nop 7
    ds_write_b128 v11, v[128:131] offset:0
    ds_write_b128 v11, v[132:135] offset:1024
    ds_write_b128 v11, v[136:139] offset:2048
    ds_write_b128 v11, v[140:143] offset:3072
    ds_write_b128 v11, v[144:147] offset:4096
    ds_write_b128 v11, v[148:151] offset:5120
    ds_write_b128 v11, v[152:155] offset:6144
    ds_write_b128 v11, v[156:159] offset:7168
    ds_write_b128 v11, v[160:163] offset:8192
    ds_write_b128 v11, v[164:167] offset:9216
    ds_write_b128 v11, v[168:171] offset:10240
    ds_write_b128 v11, v[172:175] offset:11264
    ds_write_b128 v11, v[176:179] offset:12288
    ds_write_b128 v11, v[180:183] offset:13312
    s_load_dwordx2 s[8:9], s[0:1], 0
    s_waitcnt lgkmcnt(0)
    s_and_b32 s9, s9, 0xffff
    s_mov_b32 s10, 1835008
    s_mov_b32 s11, 0x20000
    s_load_dwordx2 s[12:13], s[0:1], 64
    s_waitcnt lgkmcnt(0)
    s_and_b32 s13, s13, 0xffff
    s_mov_b32 s14, 896
    s_mov_b32 s15, 0x20000
    s_load_dwordx2 s[16:17], s[0:1], 152
    s_waitcnt lgkmcnt(0)
    s_add_u32 s16, s16, 32112640
    s_addc_u32 s17, s17, 0
    s_and_b32 s17, s17, 0xffff
    s_mov_b32 s18, 3670016
    s_mov_b32 s19, 0x20000
    s_load_dwordx2 s[20:21], s[0:1], 152
    s_waitcnt lgkmcnt(0)
    s_add_u32 s20, s20, 37370880
    s_addc_u32 s21, s21, 0
    s_and_b32 s21, s21, 0xffff
    s_mov_b32 s22, 8192
    s_mov_b32 s23, 0x20000
    s_waitcnt lgkmcnt(0)
    s_barrier
    s_add_u32 s24, s3, 0
    s_cmp_ge_u32 s24, 14
    s_cbranch_scc1 wb_done
    s_cmp_ge_u32 s24, 7
    s_cselect_b32 s25, 1, 0
    s_mul_i32 s26, s25, 7
    s_sub_u32 s26, s24, s26
    s_lshl_b32 s27, s5, 5
    s_lshl_b32 s25, s25, 4
    s_add_u32 s27, s27, s25
    v_add_u32 v12, s27, v2
    s_mul_i32 s27, s4, 112
    s_lshl_b32 s26, s26, 4
    s_add_u32 s27, s27, s26
    v_lshl_add_u32 v13, v3, 2, s27
    v_mul_u32_u24 v14, 448, v12
    v_add_u32 v14, v14, v13
    v_lshlrev_b32 v15, 1, v14
    v_lshlrev_b32 v14, 2, v14
    v_lshlrev_b32 v13, 1, v13
    v_lshlrev_b32 v12, 2, v12
    buffer_load_dwordx2 v[16:17], v15, s[8:11], 0 offen
    buffer_load_dwordx2 v[18:19], v13, s[12:15], 0 offen
    buffer_load_dword v20, v12, s[20:23], 0 offen sc1
    s_lshl_b32 s24, s24, 10
    v_add_u32 v21, s24, v10
    ds_read_b128 v[32:35], v21 offset:0
    ds_read_b128 v[36:39], v21 offset:14336
    ds_read_b128 v[40:43], v21 offset:28672
    ds_read_b128 v[44:47], v21 offset:43008
    s_waitcnt lgkmcnt(0)
    v_add_f32 v32, v32, v36
    v_add_f32 v40, v40, v44
    v_add_f32 v32, v32, v40
    v_add_f32 v33, v33, v37
    v_add_f32 v41, v41, v45
    v_add_f32 v33, v33, v41
    v_add_f32 v34, v34, v38
    v_add_f32 v42, v42, v46
    v_add_f32 v34, v34, v42
    v_add_f32 v35, v35, v39
    v_add_f32 v43, v43, v47
    v_add_f32 v35, v35, v43
    s_waitcnt vmcnt(0)
    v_lshlrev_b32 v22, 16, v16
    v_lshlrev_b32 v23, 16, v18
    v_mul_f32 v22, v22, v23
    v_cvt_pk_bf16_f32 v22, v22, v22
    v_lshlrev_b32 v22, 16, v22
    v_fma_f32 v22, v32, 2.0, v22
    v_mul_f32 v24, v20, v22
    v_and_b32 v22, 0xffff0000, v16
    v_and_b32 v23, 0xffff0000, v18
    v_mul_f32 v22, v22, v23
    v_cvt_pk_bf16_f32 v22, v22, v22
    v_lshlrev_b32 v22, 16, v22
    v_fma_f32 v22, v33, 2.0, v22
    v_mul_f32 v25, v20, v22
    v_lshlrev_b32 v22, 16, v17
    v_lshlrev_b32 v23, 16, v19
    v_mul_f32 v22, v22, v23
    v_cvt_pk_bf16_f32 v22, v22, v22
    v_lshlrev_b32 v22, 16, v22
    v_fma_f32 v22, v34, 2.0, v22
    v_mul_f32 v26, v20, v22
    v_and_b32 v22, 0xffff0000, v17
    v_and_b32 v23, 0xffff0000, v19
    v_mul_f32 v22, v22, v23
    v_cvt_pk_bf16_f32 v22, v22, v22
    v_lshlrev_b32 v22, 16, v22
    v_fma_f32 v22, v35, 2.0, v22
    v_mul_f32 v27, v20, v22
    buffer_store_dwordx4 v[24:27], v14, s[16:19], 0 offen sc1
    s_nop 1
    s_add_u32 s24, s3, 4
    s_cmp_ge_u32 s24, 14
    s_cbranch_scc1 wb_done
    s_cmp_ge_u32 s24, 7
    s_cselect_b32 s25, 1, 0
    s_mul_i32 s26, s25, 7
    s_sub_u32 s26, s24, s26
    s_lshl_b32 s27, s5, 5
    s_lshl_b32 s25, s25, 4
    s_add_u32 s27, s27, s25
    v_add_u32 v12, s27, v2
    s_mul_i32 s27, s4, 112
    s_lshl_b32 s26, s26, 4
    s_add_u32 s27, s27, s26
    v_lshl_add_u32 v13, v3, 2, s27
    v_mul_u32_u24 v14, 448, v12
    v_add_u32 v14, v14, v13
    v_lshlrev_b32 v15, 1, v14
    v_lshlrev_b32 v14, 2, v14
    v_lshlrev_b32 v13, 1, v13
    v_lshlrev_b32 v12, 2, v12
    buffer_load_dwordx2 v[16:17], v15, s[8:11], 0 offen
    buffer_load_dwordx2 v[18:19], v13, s[12:15], 0 offen
    buffer_load_dword v20, v12, s[20:23], 0 offen sc1
    s_lshl_b32 s24, s24, 10
    v_add_u32 v21, s24, v10
    ds_read_b128 v[32:35], v21 offset:0
    ds_read_b128 v[36:39], v21 offset:14336
    ds_read_b128 v[40:43], v21 offset:28672
    ds_read_b128 v[44:47], v21 offset:43008
    s_waitcnt lgkmcnt(0)
    v_add_f32 v32, v32, v36
    v_add_f32 v40, v40, v44
    v_add_f32 v32, v32, v40
    v_add_f32 v33, v33, v37
    v_add_f32 v41, v41, v45
    v_add_f32 v33, v33, v41
    v_add_f32 v34, v34, v38
    v_add_f32 v42, v42, v46
    v_add_f32 v34, v34, v42
    v_add_f32 v35, v35, v39
    v_add_f32 v43, v43, v47
    v_add_f32 v35, v35, v43
    s_waitcnt vmcnt(0)
    v_lshlrev_b32 v22, 16, v16
    v_lshlrev_b32 v23, 16, v18
    v_mul_f32 v22, v22, v23
    v_cvt_pk_bf16_f32 v22, v22, v22
    v_lshlrev_b32 v22, 16, v22
    v_fma_f32 v22, v32, 2.0, v22
    v_mul_f32 v24, v20, v22
    v_and_b32 v22, 0xffff0000, v16
    v_and_b32 v23, 0xffff0000, v18
    v_mul_f32 v22, v22, v23
    v_cvt_pk_bf16_f32 v22, v22, v22
    v_lshlrev_b32 v22, 16, v22
    v_fma_f32 v22, v33, 2.0, v22
    v_mul_f32 v25, v20, v22
    v_lshlrev_b32 v22, 16, v17
    v_lshlrev_b32 v23, 16, v19
    v_mul_f32 v22, v22, v23
    v_cvt_pk_bf16_f32 v22, v22, v22
    v_lshlrev_b32 v22, 16, v22
    v_fma_f32 v22, v34, 2.0, v22
    v_mul_f32 v26, v20, v22
    v_and_b32 v22, 0xffff0000, v17
    v_and_b32 v23, 0xffff0000, v19
    v_mul_f32 v22, v22, v23
    v_cvt_pk_bf16_f32 v22, v22, v22
    v_lshlrev_b32 v22, 16, v22
    v_fma_f32 v22, v35, 2.0, v22
    v_mul_f32 v27, v20, v22
    buffer_store_dwordx4 v[24:27], v14, s[16:19], 0 offen sc1
    s_nop 1
    s_add_u32 s24, s3, 8
    s_cmp_ge_u32 s24, 14
    s_cbranch_scc1 wb_done
    s_cmp_ge_u32 s24, 7
    s_cselect_b32 s25, 1, 0
    s_mul_i32 s26, s25, 7
    s_sub_u32 s26, s24, s26
    s_lshl_b32 s27, s5, 5
    s_lshl_b32 s25, s25, 4
    s_add_u32 s27, s27, s25
    v_add_u32 v12, s27, v2
    s_mul_i32 s27, s4, 112
    s_lshl_b32 s26, s26, 4
    s_add_u32 s27, s27, s26
    v_lshl_add_u32 v13, v3, 2, s27
    v_mul_u32_u24 v14, 448, v12
    v_add_u32 v14, v14, v13
    v_lshlrev_b32 v15, 1, v14
    v_lshlrev_b32 v14, 2, v14
    v_lshlrev_b32 v13, 1, v13
    v_lshlrev_b32 v12, 2, v12
    buffer_load_dwordx2 v[16:17], v15, s[8:11], 0 offen
    buffer_load_dwordx2 v[18:19], v13, s[12:15], 0 offen
    buffer_load_dword v20, v12, s[20:23], 0 offen sc1
    s_lshl_b32 s24, s24, 10
    v_add_u32 v21, s24, v10
    ds_read_b128 v[32:35], v21 offset:0
    ds_read_b128 v[36:39], v21 offset:14336
    ds_read_b128 v[40:43], v21 offset:28672
    ds_read_b128 v[44:47], v21 offset:43008
    s_waitcnt lgkmcnt(0)
    v_add_f32 v32, v32, v36
    v_add_f32 v40, v40, v44
    v_add_f32 v32, v32, v40
    v_add_f32 v33, v33, v37
    v_add_f32 v41, v41, v45
    v_add_f32 v33, v33, v41
    v_add_f32 v34, v34, v38
    v_add_f32 v42, v42, v46
    v_add_f32 v34, v34, v42
    v_add_f32 v35, v35, v39
    v_add_f32 v43, v43, v47
    v_add_f32 v35, v35, v43
    s_waitcnt vmcnt(0)
    v_lshlrev_b32 v22, 16, v16
    v_lshlrev_b32 v23, 16, v18
    v_mul_f32 v22, v22, v23
    v_cvt_pk_bf16_f32 v22, v22, v22
    v_lshlrev_b32 v22, 16, v22
    v_fma_f32 v22, v32, 2.0, v22
    v_mul_f32 v24, v20, v22
    v_and_b32 v22, 0xffff0000, v16
    v_and_b32 v23, 0xffff0000, v18
    v_mul_f32 v22, v22, v23
    v_cvt_pk_bf16_f32 v22, v22, v22
    v_lshlrev_b32 v22, 16, v22
    v_fma_f32 v22, v33, 2.0, v22
    v_mul_f32 v25, v20, v22
    v_lshlrev_b32 v22, 16, v17
    v_lshlrev_b32 v23, 16, v19
    v_mul_f32 v22, v22, v23
    v_cvt_pk_bf16_f32 v22, v22, v22
    v_lshlrev_b32 v22, 16, v22
    v_fma_f32 v22, v34, 2.0, v22
    v_mul_f32 v26, v20, v22
    v_and_b32 v22, 0xffff0000, v17
    v_and_b32 v23, 0xffff0000, v19
    v_mul_f32 v22, v22, v23
    v_cvt_pk_bf16_f32 v22, v22, v22
    v_lshlrev_b32 v22, 16, v22
    v_fma_f32 v22, v35, 2.0, v22
    v_mul_f32 v27, v20, v22
    buffer_store_dwordx4 v[24:27], v14, s[16:19], 0 offen sc1
    s_nop 1
    s_add_u32 s24, s3, 12
    s_cmp_ge_u32 s24, 14
    s_cbranch_scc1 wb_done
    s_cmp_ge_u32 s24, 7
    s_cselect_b32 s25, 1, 0
    s_mul_i32 s26, s25, 7
    s_sub_u32 s26, s24, s26
    s_lshl_b32 s27, s5, 5
    s_lshl_b32 s25, s25, 4
    s_add_u32 s27, s27, s25
    v_add_u32 v12, s27, v2
    s_mul_i32 s27, s4, 112
    s_lshl_b32 s26, s26, 4
    s_add_u32 s27, s27, s26
    v_lshl_add_u32 v13, v3, 2, s27
    v_mul_u32_u24 v14, 448, v12
    v_add_u32 v14, v14, v13
    v_lshlrev_b32 v15, 1, v14
    v_lshlrev_b32 v14, 2, v14
    v_lshlrev_b32 v13, 1, v13
    v_lshlrev_b32 v12, 2, v12
    buffer_load_dwordx2 v[16:17], v15, s[8:11], 0 offen
    buffer_load_dwordx2 v[18:19], v13, s[12:15], 0 offen
    buffer_load_dword v20, v12, s[20:23], 0 offen sc1
    s_lshl_b32 s24, s24, 10
    v_add_u32 v21, s24, v10
    ds_read_b128 v[32:35], v21 offset:0
    ds_read_b128 v[36:39], v21 offset:14336
    ds_read_b128 v[40:43], v21 offset:28672
    ds_read_b128 v[44:47], v21 offset:43008
    s_waitcnt lgkmcnt(0)
    v_add_f32 v32, v32, v36
    v_add_f32 v40, v40, v44
    v_add_f32 v32, v32, v40
    v_add_f32 v33, v33, v37
    v_add_f32 v41, v41, v45
    v_add_f32 v33, v33, v41
    v_add_f32 v34, v34, v38
    v_add_f32 v42, v42, v46
    v_add_f32 v34, v34, v42
    v_add_f32 v35, v35, v39
    v_add_f32 v43, v43, v47
    v_add_f32 v35, v35, v43
    s_waitcnt vmcnt(0)
    v_lshlrev_b32 v22, 16, v16
    v_lshlrev_b32 v23, 16, v18
    v_mul_f32 v22, v22, v23
    v_cvt_pk_bf16_f32 v22, v22, v22
    v_lshlrev_b32 v22, 16, v22
    v_fma_f32 v22, v32, 2.0, v22
    v_mul_f32 v24, v20, v22
    v_and_b32 v22, 0xffff0000, v16
    v_and_b32 v23, 0xffff0000, v18
    v_mul_f32 v22, v22, v23
    v_cvt_pk_bf16_f32 v22, v22, v22
    v_lshlrev_b32 v22, 16, v22
    v_fma_f32 v22, v33, 2.0, v22
    v_mul_f32 v25, v20, v22
    v_lshlrev_b32 v22, 16, v17
    v_lshlrev_b32 v23, 16, v19
    v_mul_f32 v22, v22, v23
    v_cvt_pk_bf16_f32 v22, v22, v22
    v_lshlrev_b32 v22, 16, v22
    v_fma_f32 v22, v34, 2.0, v22
    v_mul_f32 v26, v20, v22
    v_and_b32 v22, 0xffff0000, v17
    v_and_b32 v23, 0xffff0000, v19
    v_mul_f32 v22, v22, v23
    v_cvt_pk_bf16_f32 v22, v22, v22
    v_lshlrev_b32 v22, 16, v22
    v_fma_f32 v22, v35, 2.0, v22
    v_mul_f32 v27, v20, v22
    buffer_store_dwordx4 v[24:27], v14, s[16:19], 0 offen sc1
    s_nop 1
wb_done:
    s_branch wk_loop
wk_n3:
    s_cmp_lt_u32 s40, 992
    s_cbranch_scc0 wk_n4
    s_sub_u32 s40, s40, 736
    s_lshr_b32 s41, s40, 4
    s_lshl_b32 s41, s41, 2
    s_add_u32 s41, s41, 128
    s_mov_b32 s53, 16777216
    s_and_b32 s4, s40, 15
    s_lshr_b32 s5, s40, 4
    s_lshl_b32 s5, s5, 2
    s_add_u32 s5, s5, s3
    s_load_dwordx2 s[8:9], s[0:1], 152
    s_waitcnt lgkmcnt(0)
    s_add_u32 s8, s8, 28442624
    s_addc_u32 s9, s9, 0
    s_and_b32 s9, s9, 0xffff
    s_mov_b32 s10, 1835008
    s_mov_b32 s11, 0x20000
    s_mul_i32 s20, s5, 28672
    v_lshlrev_b32 v4, 4, v1
    v_add_u32 v4, s20, v4
    s_mov_b32 s20, 0
    buffer_load_dwordx4 v[16:19], v4, s[8:11], s20 offen
    s_mov_b32 s20, 1024
    buffer_load_dwordx4 v[20:23], v4, s[8:11], s20 offen
    s_mov_b32 s20, 2048
    buffer_load_dwordx4 v[24:27], v4, s[8:11], s20 offen
    s_mov_b32 s20, 3072
    buffer_load_dwordx4 v[28:31], v4, s[8:11], s20 offen
    s_mov_b32 s20, 4096
    buffer_load_dwordx4 v[32:35], v4, s[8:11], s20 offen
    s_mov_b32 s20, 5120
    buffer_load_dwordx4 v[36:39], v4, s[8:11], s20 offen
    s_mov_b32 s20, 6144
    buffer_load_dwordx4 v[40:43], v4, s[8:11], s20 offen
    s_mov_b32 s20, 7168
    buffer_load_dwordx4 v[44:47], v4, s[8:11], s20 offen
    s_mov_b32 s20, 8192
    buffer_load_dwordx4 v[48:51], v4, s[8:11], s20 offen
    s_mov_b32 s20, 9216
    buffer_load_dwordx4 v[52:55], v4, s[8:11], s20 offen
    s_mov_b32 s20, 10240
    buffer_load_dwordx4 v[56:59], v4, s[8:11], s20 offen
    s_mov_b32 s20, 11264
    buffer_load_dwordx4 v[60:63], v4, s[8:11], s20 offen
    s_mov_b32 s20, 12288
    buffer_load_dwordx4 v[64:67], v4, s[8:11], s20 offen
    s_mov_b32 s20, 13312
    buffer_load_dwordx4 v[68:71], v4, s[8:11], s20 offen
    s_mov_b32 s20, 14336
    buffer_load_dwordx4 v[72:75], v4, s[8:11], s20 offen
    s_mov_b32 s20, 15360
    buffer_load_dwordx4 v[76:79], v4, s[8:11], s20 offen
    s_mov_b32 s20, 16384
    buffer_load_dwordx4 v[80:83], v4, s[8:11], s20 offen
    s_mov_b32 s20, 17408
    buffer_load_dwordx4 v[84:87], v4, s[8:11], s20 offen
    s_mov_b32 s20, 18432
    buffer_load_dwordx4 v[88:91], v4, s[8:11], s20 offen
    s_mov_b32 s20, 19456
    buffer_load_dwordx4 v[92:95], v4, s[8:11], s20 offen
    s_mov_b32 s20, 20480
    buffer_load_dwordx4 v[96:99], v4, s[8:11], s20 offen
    s_mov_b32 s20, 21504
    buffer_load_dwordx4 v[100:103], v4, s[8:11], s20 offen
    s_mov_b32 s20, 22528
    buffer_load_dwordx4 v[104:107], v4, s[8:11], s20 offen
    s_mov_b32 s20, 23552
    buffer_load_dwordx4 v[108:111], v4, s[8:11], s20 offen
    s_mov_b32 s20, 24576
    buffer_load_dwordx4 v[112:115], v4, s[8:11], s20 offen
    s_mov_b32 s20, 25600
    buffer_load_dwordx4 v[116:119], v4, s[8:11], s20 offen
    s_mov_b32 s20, 26624
    buffer_load_dwordx4 v[120:123], v4, s[8:11], s20 offen
    s_mov_b32 s20, 27648
    buffer_load_dwordx4 v[124:127], v4, s[8:11], s20 offen
    s_load_dwordx2 s[12:13], s[0:1], 152
    s_waitcnt lgkmcnt(0)
    s_add_u32 s12, s12, 12845056
    s_addc_u32 s13, s13, 0
    s_and_b32 s13, s13, 0xffff
    s_mov_b32 s14, 6422528
    s_mov_b32 s15, 0x20000
    s_load_dwordx2 s[16:17], s[0:1], 152
    s_waitcnt lgkmcnt(0)
    s_add_u32 s16, s16, 30277632
    s_addc_u32 s17, s17, 0
    s_and_b32 s17, s17, 0xffff
    s_mov_b32 s18, 1835008
    s_mov_b32 s19, 0x20000
    s_mul_i32 s29, s4, 401408
    s_mul_i32 s36, s5, 28672
    v_lshlrev_b32 v7, 4, v1
    v_add_u32 v7, s36, v7
    v_accvgpr_write_b32 a0, 0
    v_accvgpr_write_b32 a1, 0
    v_accvgpr_write_b32 a2, 0
    v_accvgpr_write_b32 a3, 0
    v_accvgpr_write_b32 a4, 0
    v_accvgpr_write_b32 a5, 0
    v_accvgpr_write_b32 a6, 0
    v_accvgpr_write_b32 a7, 0
    v_accvgpr_write_b32 a8, 0
    v_accvgpr_write_b32 a9, 0
    v_accvgpr_write_b32 a10, 0
    v_accvgpr_write_b32 a11, 0
    v_accvgpr_write_b32 a12, 0
    v_accvgpr_write_b32 a13, 0
    v_accvgpr_write_b32 a14, 0
    v_accvgpr_write_b32 a15, 0
    v_accvgpr_write_b32 a16, 0
    v_accvgpr_write_b32 a17, 0
    v_accvgpr_write_b32 a18, 0
    v_accvgpr_write_b32 a19, 0
    v_accvgpr_write_b32 a20, 0
    v_accvgpr_write_b32 a21, 0
    v_accvgpr_write_b32 a22, 0
    v_accvgpr_write_b32 a23, 0
    v_lshlrev_b32 v6, 4, v1
    v_lshlrev_b32 v9, 4, v1
    s_mul_i32 s30, s3, 7168
    s_mov_b32 s6, 0
    s_mov_b32 s7, 0
    s_mov_b32 s26, 1
    s_mov_b32 s27, 28672
    s_mul_i32 s23, s6, 28672
    s_add_u32 s23, s23, s29
    s_add_u32 s23, s23, s30
    s_add_u32 s24, s7, s30
    s_add_u32 m0, s24, 0
    s_add_u32 s25, s23, 0
    buffer_load_dwordx4 v6, s[12:15], s25 offen lds
    s_add_u32 m0, s24, 1024
    s_add_u32 s25, s23, 1024
    buffer_load_dwordx4 v6, s[12:15], s25 offen lds
    s_add_u32 m0, s24, 2048
    s_add_u32 s25, s23, 2048
    buffer_load_dwordx4 v6, s[12:15], s25 offen lds
    s_add_u32 m0, s24, 3072
    s_add_u32 s25, s23, 3072
    buffer_load_dwordx4 v6, s[12:15], s25 offen lds
    s_add_u32 m0, s24, 4096
    s_add_u32 s25, s23, 4096
    buffer_load_dwordx4 v6, s[12:15], s25 offen lds
    s_add_u32 m0, s24, 5120
    s_add_u32 s25, s23, 5120
    buffer_load_dwordx4 v6, s[12:15], s25 offen lds
    s_add_u32 m0, s24, 6144
    s_add_u32 s25, s23, 6144
    buffer_load_dwordx4 v6, s[12:15], s25 offen lds
    s_mul_i32 s23, s26, 28672
    s_add_u32 s23, s23, s29
    s_add_u32 s23, s23, s30
    s_add_u32 s24, s27, s30
    s_add_u32 m0, s24, 0
    s_add_u32 s25, s23, 0
    buffer_load_dwordx4 v6, s[12:15], s25 offen lds
    s_add_u32 m0, s24, 1024
    s_add_u32 s25, s23, 1024
    buffer_load_dwordx4 v6, s[12:15], s25 offen lds
    s_add_u32 m0, s24, 2048
    s_add_u32 s25, s23, 2048
    buffer_load_dwordx4 v6, s[12:15], s25 offen lds
    s_add_u32 m0, s24, 3072
    s_add_u32 s25, s23, 3072
    buffer_load_dwordx4 v6, s[12:15], s25 offen lds
    s_add_u32 m0, s24, 4096
    s_add_u32 s25, s23, 4096
    buffer_load_dwordx4 v6, s[12:15], s25 offen lds
    s_add_u32 m0, s24, 5120
    s_add_u32 s25, s23, 5120
    buffer_load_dwordx4 v6, s[12:15], s25 offen lds
    s_add_u32 m0, s24, 6144
    s_add_u32 s25, s23, 6144
    buffer_load_dwordx4 v6, s[12:15], s25 offen lds
    s_waitcnt vmcnt(7)
wp0_loop:
    s_barrier
    s_mov_b32 s31, 0
    buffer_load_dwordx4 a[24:27], v7, s[16:19], s31 offen
    s_mov_b32 s31, 14336
    buffer_load_dwordx4 a[28:31], v7, s[16:19], s31 offen
    s_add_u32 s27, s7, 57344
    s_cmp_ge_u32 s27, 86016
    s_cselect_b32 s28, 86016, 0
    s_sub_u32 s27, s27, s28
    s_add_u32 s26, s6, 2
    s_cmp_lt_u32 s26, 14
    s_cbranch_scc0 wp0_nodma
    s_mul_i32 s23, s26, 28672
    s_add_u32 s23, s23, s29
    s_add_u32 s23, s23, s30
    s_add_u32 s24, s27, s30
    s_add_u32 m0, s24, 0
    s_add_u32 s25, s23, 0
    buffer_load_dwordx4 v6, s[12:15], s25 offen lds
    s_add_u32 m0, s24, 1024
    s_add_u32 s25, s23, 1024
    buffer_load_dwordx4 v6, s[12:15], s25 offen lds
    s_add_u32 m0, s24, 2048
    s_add_u32 s25, s23, 2048
    buffer_load_dwordx4 v6, s[12:15], s25 offen lds
    s_add_u32 m0, s24, 3072
    s_add_u32 s25, s23, 3072
    buffer_load_dwordx4 v6, s[12:15], s25 offen lds
    s_add_u32 m0, s24, 4096
    s_add_u32 s25, s23, 4096
    buffer_load_dwordx4 v6, s[12:15], s25 offen lds
    s_add_u32 m0, s24, 5120
    s_add_u32 s25, s23, 5120
    buffer_load_dwordx4 v6, s[12:15], s25 offen lds
    s_add_u32 m0, s24, 6144
    s_add_u32 s25, s23, 6144
    buffer_load_dwordx4 v6, s[12:15], s25 offen lds
wp0_nodma:
    v_add_u32 v10, s7, v9
    ds_read_b128 v[128:131], v10 offset:0
    ds_read_b128 v[132:135], v10 offset:1024
    ds_read_b128 v[136:139], v10 offset:2048
    ds_read_b128 v[140:143], v10 offset:3072
    ds_read_b128 v[144:147], v10 offset:4096
    ds_read_b128 v[148:151], v10 offset:5120
    ds_read_b128 v[152:155], v10 offset:6144
    ds_read_b128 v[156:159], v10 offset:7168
    ds_read_b128 v[160:163], v10 offset:8192
    ds_read_b128 v[164:167], v10 offset:9216
    ds_read_b128 v[168:171], v10 offset:10240
    ds_read_b128 v[172:175], v10 offset:11264
    ds_read_b128 v[176:179], v10 offset:12288
    ds_read_b128 v[180:183], v10 offset:13312
    ds_read_b128 v[184:187], v10 offset:14336
    s_waitcnt lgkmcnt(14)
    v_mfma_f32_16x16x32_bf16 v[240:243], v[128:131], v[16:19], 0
    v_mfma_f32_16x16x32_bf16 v[244:247], v[128:131], v[72:75], 0
    ds_read_b128 v[188:191], v10 offset:15360
    s_waitcnt lgkmcnt(14)
    v_mfma_f32_16x16x32_bf16 v[240:243], v[132:135], v[20:23], v[240:243]
    v_mfma_f32_16x16x32_bf16 v[244:247], v[132:135], v[76:79], v[244:247]
    ds_read_b128 v[192:195], v10 offset:16384
    s_waitcnt lgkmcnt(14)
    v_mfma_f32_16x16x32_bf16 v[240:243], v[136:139], v[24:27], v[240:243]
    v_mfma_f32_16x16x32_bf16 v[244:247], v[136:139], v[80:83], v[244:247]
    ds_read_b128 v[196:199], v10 offset:17408
    s_waitcnt lgkmcnt(14)
    v_mfma_f32_16x16x32_bf16 v[240:243], v[140:143], v[28:31], v[240:243]
    v_mfma_f32_16x16x32_bf16 v[244:247], v[140:143], v[84:87], v[244:247]
    ds_read_b128 v[200:203], v10 offset:18432
    s_waitcnt lgkmcnt(14)
    v_mfma_f32_16x16x32_bf16 v[240:243], v[144:147], v[32:35], v[240:243]
    v_mfma_f32_16x16x32_bf16 v[244:247], v[144:147], v[88:91], v[244:247]
    ds_read_b128 v[204:207], v10 offset:19456
    s_waitcnt lgkmcnt(14)
    v_mfma_f32_16x16x32_bf16 v[240:243], v[148:151], v[36:39], v[240:243]
    v_mfma_f32_16x16x32_bf16 v[244:247], v[148:151], v[92:95], v[244:247]
    ds_read_b128 v[208:211], v10 offset:20480
    s_waitcnt lgkmcnt(14)
    v_mfma_f32_16x16x32_bf16 v[240:243], v[152:155], v[40:43], v[240:243]
    v_mfma_f32_16x16x32_bf16 v[244:247], v[152:155], v[96:99], v[244:247]
    ds_read_b128 v[212:215], v10 offset:21504
    s_waitcnt lgkmcnt(14)
    v_mfma_f32_16x16x32_bf16 v[240:243], v[156:159], v[44:47], v[240:243]
    v_mfma_f32_16x16x32_bf16 v[244:247], v[156:159], v[100:103], v[244:247]
    ds_read_b128 v[216:219], v10 offset:22528
    s_waitcnt lgkmcnt(14)
    v_mfma_f32_16x16x32_bf16 v[240:243], v[160:163], v[48:51], v[240:243]
    v_mfma_f32_16x16x32_bf16 v[244:247], v[160:163], v[104:107], v[244:247]
    ds_read_b128 v[220:223], v10 offset:23552
    s_waitcnt lgkmcnt(14)
    v_mfma_f32_16x16x32_bf16 v[240:243], v[164:167], v[52:55], v[240:243]
    v_mfma_f32_16x16x32_bf16 v[244:247], v[164:167], v[108:111], v[244:247]
    ds_read_b128 v[224:227], v10 offset:24576
    s_waitcnt lgkmcnt(14)
    v_mfma_f32_16x16x32_bf16 v[240:243], v[168:171], v[56:59], v[240:243]
    v_mfma_f32_16x16x32_bf16 v[244:247], v[168:171], v[112:115], v[244:247]
    ds_read_b128 v[228:231], v10 offset:25600
    s_waitcnt lgkmcnt(14)
    v_mfma_f32_16x16x32_bf16 v[240:243], v[172:175], v[60:63], v[240:243]
    v_mfma_f32_16x16x32_bf16 v[244:247], v[172:175], v[116:119], v[244:247]
    ds_read_b128 v[232:235], v10 offset:26624
    s_waitcnt lgkmcnt(14)
    v_mfma_f32_16x16x32_bf16 v[240:243], v[176:179], v[64:67], v[240:243]
    v_mfma_f32_16x16x32_bf16 v[244:247], v[176:179], v[120:123], v[244:247]
    ds_read_b128 v[236:239], v10 offset:27648
    s_waitcnt lgkmcnt(14)
    v_mfma_f32_16x16x32_bf16 v[240:243], v[180:183], v[68:71], v[240:243]
    v_mfma_f32_16x16x32_bf16 v[244:247], v[180:183], v[124:127], v[244:247]
    s_waitcnt lgkmcnt(13)
    v_mfma_f32_16x16x32_bf16 v[248:251], v[184:187], v[16:19], 0
    v_mfma_f32_16x16x32_bf16 v[252:255], v[184:187], v[72:75], 0
    s_waitcnt lgkmcnt(12)
    v_mfma_f32_16x16x32_bf16 v[248:251], v[188:191], v[20:23], v[248:251]
    v_mfma_f32_16x16x32_bf16 v[252:255], v[188:191], v[76:79], v[252:255]
    s_waitcnt lgkmcnt(11)
    v_mfma_f32_16x16x32_bf16 v[248:251], v[192:195], v[24:27], v[248:251]
    v_mfma_f32_16x16x32_bf16 v[252:255], v[192:195], v[80:83], v[252:255]
    s_waitcnt lgkmcnt(10)
    v_mfma_f32_16x16x32_bf16 v[248:251], v[196:199], v[28:31], v[248:251]
    v_mfma_f32_16x16x32_bf16 v[252:255], v[196:199], v[84:87], v[252:255]
    s_waitcnt lgkmcnt(9)
    v_mfma_f32_16x16x32_bf16 v[248:251], v[200:203], v[32:35], v[248:251]
    v_mfma_f32_16x16x32_bf16 v[252:255], v[200:203], v[88:91], v[252:255]
    s_waitcnt lgkmcnt(8)
    v_mfma_f32_16x16x32_bf16 v[248:251], v[204:207], v[36:39], v[248:251]
    v_mfma_f32_16x16x32_bf16 v[252:255], v[204:207], v[92:95], v[252:255]
    s_waitcnt lgkmcnt(7)
    v_mfma_f32_16x16x32_bf16 v[248:251], v[208:211], v[40:43], v[248:251]
    v_mfma_f32_16x16x32_bf16 v[252:255], v[208:211], v[96:99], v[252:255]
    s_waitcnt lgkmcnt(6)
    v_mfma_f32_16x16x32_bf16 v[248:251], v[212:215], v[44:47], v[248:251]
    v_mfma_f32_16x16x32_bf16 v[252:255], v[212:215], v[100:103], v[252:255]
    s_waitcnt lgkmcnt(5)
    v_mfma_f32_16x16x32_bf16 v[248:251], v[216:219], v[48:51], v[248:251]
    v_mfma_f32_16x16x32_bf16 v[252:255], v[216:219], v[104:107], v[252:255]
    s_waitcnt lgkmcnt(4)
    v_mfma_f32_16x16x32_bf16 v[248:251], v[220:223], v[52:55], v[248:251]
    v_mfma_f32_16x16x32_bf16 v[252:255], v[220:223], v[108:111], v[252:255]
    s_waitcnt lgkmcnt(3)
    v_mfma_f32_16x16x32_bf16 v[248:251], v[224:227], v[56:59], v[248:251]
    v_mfma_f32_16x16x32_bf16 v[252:255], v[224:227], v[112:115], v[252:255]
    s_waitcnt lgkmcnt(2)
    v_mfma_f32_16x16x32_bf16 v[248:251], v[228:231], v[60:63], v[248:251]
    v_mfma_f32_16x16x32_bf16 v[252:255], v[228:231], v[116:119], v[252:255]
    s_waitcnt lgkmcnt(1)
    v_mfma_f32_16x16x32_bf16 v[248:251], v[232:235], v[64:67], v[248:251]
    v_mfma_f32_16x16x32_bf16 v[252:255], v[232:235], v[120:123], v[252:255]
    s_waitcnt lgkmcnt(0)
    v_mfma_f32_16x16x32_bf16 v[248:251], v[236:239], v[68:71], v[248:251]
    v_mfma_f32_16x16x32_bf16 v[252:255], v[236:239], v[124:127], v[252:255]
    s_nop 7
    v_cvt_pk_bf16_f32 v128, v240, v241
    v_cvt_pk_bf16_f32 v129, v242, v243
    v_cvt_pk_bf16_f32 v130, v248, v249
    v_cvt_pk_bf16_f32 v131, v250, v251
    v_cvt_pk_bf16_f32 v132, v244, v245
    v_cvt_pk_bf16_f32 v133, v246, v247
    v_cvt_pk_bf16_f32 v134, v252, v253
    v_cvt_pk_bf16_f32 v135, v254, v255
    s_waitcnt vmcnt(7)
    v_accvgpr_write_b32 a40, v128
    v_accvgpr_write_b32 a41, v129
    v_accvgpr_write_b32 a42, v130
    v_accvgpr_write_b32 a43, v131
    v_accvgpr_write_b32 a44, v132
    v_accvgpr_write_b32 a45, v133
    v_accvgpr_write_b32 a46, v134
    v_accvgpr_write_b32 a47, v135
    v_mfma_f32_16x16x32_bf16 a[0:3], a[24:27], v[128:131], a[0:3]
    v_mfma_f32_16x16x32_bf16 a[4:7], a[24:27], v[132:135], a[4:7]
    v_mfma_f32_16x16x32_bf16 a[8:11], a[28:31], v[128:131], a[8:11]
    v_mfma_f32_16x16x32_bf16 a[12:15], a[28:31], v[132:135], a[12:15]
    s_add_u32 s7, s7, 28672
    s_cmp_ge_u32 s7, 86016
    s_cselect_b32 s28, 86016, 0
    s_sub_u32 s7, s7, s28
    s_add_u32 s6, s6, 1
    s_add_u32 s26, s6, 1
    s_cmp_lt_u32 s26, 14
    s_cbranch_scc1 wp0_w7
    s_waitcnt vmcnt(0)
    s_branch wp0_w
    wp0_w7:
    s_waitcnt vmcnt(7)
    wp0_w:
wp1_loop:
    s_barrier
    s_mov_b32 s31, 1024
    buffer_load_dwordx4 a[24:27], v7, s[16:19], s31 offen
    s_mov_b32 s31, 15360
    buffer_load_dwordx4 a[28:31], v7, s[16:19], s31 offen
    s_add_u32 s27, s7, 57344
    s_cmp_ge_u32 s27, 86016
    s_cselect_b32 s28, 86016, 0
    s_sub_u32 s27, s27, s28
    s_add_u32 s26, s6, 2
    s_cmp_lt_u32 s26, 14
    s_cbranch_scc0 wp1_nodma
    s_mul_i32 s23, s26, 28672
    s_add_u32 s23, s23, s29
    s_add_u32 s23, s23, s30
    s_add_u32 s24, s27, s30
    s_add_u32 m0, s24, 0
    s_add_u32 s25, s23, 0
    buffer_load_dwordx4 v6, s[12:15], s25 offen lds
    s_add_u32 m0, s24, 1024
    s_add_u32 s25, s23, 1024
    buffer_load_dwordx4 v6, s[12:15], s25 offen lds
    s_add_u32 m0, s24, 2048
    s_add_u32 s25, s23, 2048
    buffer_load_dwordx4 v6, s[12:15], s25 offen lds
    s_add_u32 m0, s24, 3072
    s_add_u32 s25, s23, 3072
    buffer_load_dwordx4 v6, s[12:15], s25 offen lds
    s_add_u32 m0, s24, 4096
    s_add_u32 s25, s23, 4096
    buffer_load_dwordx4 v6, s[12:15], s25 offen lds
    s_add_u32 m0, s24, 5120
    s_add_u32 s25, s23, 5120
    buffer_load_dwordx4 v6, s[12:15], s25 offen lds
    s_add_u32 m0, s24, 6144
    s_add_u32 s25, s23, 6144
    buffer_load_dwordx4 v6, s[12:15], s25 offen lds
wp1_nodma:
    v_add_u32 v10, s7, v9
    ds_read_b128 v[128:131], v10 offset:0
    ds_read_b128 v[132:135], v10 offset:1024
    ds_read_b128 v[136:139], v10 offset:2048
    ds_read_b128 v[140:143], v10 offset:3072
    ds_read_b128 v[144:147], v10 offset:4096
    ds_read_b128 v[148:151], v10 offset:5120
    ds_read_b128 v[152:155], v10 offset:6144
    ds_read_b128 v[156:159], v10 offset:7168
    ds_read_b128 v[160:163], v10 offset:8192
    ds_read_b128 v[164:167], v10 offset:9216
    ds_read_b128 v[168:171], v10 offset:10240
    ds_read_b128 v[172:175], v10 offset:11264
    ds_read_b128 v[176:179], v10 offset:12288
    ds_read_b128 v[180:183], v10 offset:13312
    ds_read_b128 v[184:187], v10 offset:14336
    s_waitcnt lgkmcnt(14)
    v_mfma_f32_16x16x32_bf16 v[240:243], v[128:131], v[16:19], 0
    v_mfma_f32_16x16x32_bf16 v[244:247], v[128:131], v[72:75], 0
    ds_read_b128 v[188:191], v10 offset:15360
    s_waitcnt lgkmcnt(14)
    v_mfma_f32_16x16x32_bf16 v[240:243], v[132:135], v[20:23], v[240:243]
    v_mfma_f32_16x16x32_bf16 v[244:247], v[132:135], v[76:79], v[244:247]
    ds_read_b128 v[192:195], v10 offset:16384
    s_waitcnt lgkmcnt(14)
    v_mfma_f32_16x16x32_bf16 v[240:243], v[136:139], v[24:27], v[240:243]
    v_mfma_f32_16x16x32_bf16 v[244:247], v[136:139], v[80:83], v[244:247]
    ds_read_b128 v[196:199], v10 offset:17408
    s_waitcnt lgkmcnt(14)
    v_mfma_f32_16x16x32_bf16 v[240:243], v[140:143], v[28:31], v[240:243]
    v_mfma_f32_16x16x32_bf16 v[244:247], v[140:143], v[84:87], v[244:247]
    ds_read_b128 v[200:203], v10 offset:18432
    s_waitcnt lgkmcnt(14)
    v_mfma_f32_16x16x32_bf16 v[240:243], v[144:147], v[32:35], v[240:243]
    v_mfma_f32_16x16x32_bf16 v[244:247], v[144:147], v[88:91], v[244:247]
    ds_read_b128 v[204:207], v10 offset:19456
    s_waitcnt lgkmcnt(14)
    v_mfma_f32_16x16x32_bf16 v[240:243], v[148:151], v[36:39], v[240:243]
    v_mfma_f32_16x16x32_bf16 v[244:247], v[148:151], v[92:95], v[244:247]
    ds_read_b128 v[208:211], v10 offset:20480
    s_waitcnt lgkmcnt(14)
    v_mfma_f32_16x16x32_bf16 v[240:243], v[152:155], v[40:43], v[240:243]
    v_mfma_f32_16x16x32_bf16 v[244:247], v[152:155], v[96:99], v[244:247]
    ds_read_b128 v[212:215], v10 offset:21504
    s_waitcnt lgkmcnt(14)
    v_mfma_f32_16x16x32_bf16 v[240:243], v[156:159], v[44:47], v[240:243]
    v_mfma_f32_16x16x32_bf16 v[244:247], v[156:159], v[100:103], v[244:247]
    ds_read_b128 v[216:219], v10 offset:22528
    s_waitcnt lgkmcnt(14)
    v_mfma_f32_16x16x32_bf16 v[240:243], v[160:163], v[48:51], v[240:243]
    v_mfma_f32_16x16x32_bf16 v[244:247], v[160:163], v[104:107], v[244:247]
    ds_read_b128 v[220:223], v10 offset:23552
    s_waitcnt lgkmcnt(14)
    v_mfma_f32_16x16x32_bf16 v[240:243], v[164:167], v[52:55], v[240:243]
    v_mfma_f32_16x16x32_bf16 v[244:247], v[164:167], v[108:111], v[244:247]
    ds_read_b128 v[224:227], v10 offset:24576
    s_waitcnt lgkmcnt(14)
    v_mfma_f32_16x16x32_bf16 v[240:243], v[168:171], v[56:59], v[240:243]
    v_mfma_f32_16x16x32_bf16 v[244:247], v[168:171], v[112:115], v[244:247]
    ds_read_b128 v[228:231], v10 offset:25600
    s_waitcnt lgkmcnt(14)
    v_mfma_f32_16x16x32_bf16 v[240:243], v[172:175], v[60:63], v[240:243]
    v_mfma_f32_16x16x32_bf16 v[244:247], v[172:175], v[116:119], v[244:247]
    ds_read_b128 v[232:235], v10 offset:26624
    s_waitcnt lgkmcnt(14)
    v_mfma_f32_16x16x32_bf16 v[240:243], v[176:179], v[64:67], v[240:243]
    v_mfma_f32_16x16x32_bf16 v[244:247], v[176:179], v[120:123], v[244:247]
    ds_read_b128 v[236:239], v10 offset:27648
    s_waitcnt lgkmcnt(14)
    v_mfma_f32_16x16x32_bf16 v[240:243], v[180:183], v[68:71], v[240:243]
    v_mfma_f32_16x16x32_bf16 v[244:247], v[180:183], v[124:127], v[244:247]
    s_waitcnt lgkmcnt(13)
    v_mfma_f32_16x16x32_bf16 v[248:251], v[184:187], v[16:19], 0
    v_mfma_f32_16x16x32_bf16 v[252:255], v[184:187], v[72:75], 0
    s_waitcnt lgkmcnt(12)
    v_mfma_f32_16x16x32_bf16 v[248:251], v[188:191], v[20:23], v[248:251]
    v_mfma_f32_16x16x32_bf16 v[252:255], v[188:191], v[76:79], v[252:255]
    s_waitcnt lgkmcnt(11)
    v_mfma_f32_16x16x32_bf16 v[248:251], v[192:195], v[24:27], v[248:251]
    v_mfma_f32_16x16x32_bf16 v[252:255], v[192:195], v[80:83], v[252:255]
    s_waitcnt lgkmcnt(10)
    v_mfma_f32_16x16x32_bf16 v[248:251], v[196:199], v[28:31], v[248:251]
    v_mfma_f32_16x16x32_bf16 v[252:255], v[196:199], v[84:87], v[252:255]
    s_waitcnt lgkmcnt(9)
    v_mfma_f32_16x16x32_bf16 v[248:251], v[200:203], v[32:35], v[248:251]
    v_mfma_f32_16x16x32_bf16 v[252:255], v[200:203], v[88:91], v[252:255]
    s_waitcnt lgkmcnt(8)
    v_mfma_f32_16x16x32_bf16 v[248:251], v[204:207], v[36:39], v[248:251]
    v_mfma_f32_16x16x32_bf16 v[252:255], v[204:207], v[92:95], v[252:255]
    s_waitcnt lgkmcnt(7)
    v_mfma_f32_16x16x32_bf16 v[248:251], v[208:211], v[40:43], v[248:251]
    v_mfma_f32_16x16x32_bf16 v[252:255], v[208:211], v[96:99], v[252:255]
    s_waitcnt lgkmcnt(6)
    v_mfma_f32_16x16x32_bf16 v[248:251], v[212:215], v[44:47], v[248:251]
    v_mfma_f32_16x16x32_bf16 v[252:255], v[212:215], v[100:103], v[252:255]
    s_waitcnt lgkmcnt(5)
    v_mfma_f32_16x16x32_bf16 v[248:251], v[216:219], v[48:51], v[248:251]
    v_mfma_f32_16x16x32_bf16 v[252:255], v[216:219], v[104:107], v[252:255]
    s_waitcnt lgkmcnt(4)
    v_mfma_f32_16x16x32_bf16 v[248:251], v[220:223], v[52:55], v[248:251]
    v_mfma_f32_16x16x32_bf16 v[252:255], v[220:223], v[108:111], v[252:255]
    s_waitcnt lgkmcnt(3)
    v_mfma_f32_16x16x32_bf16 v[248:251], v[224:227], v[56:59], v[248:251]
    v_mfma_f32_16x16x32_bf16 v[252:255], v[224:227], v[112:115], v[252:255]
    s_waitcnt lgkmcnt(2)
    v_mfma_f32_16x16x32_bf16 v[248:251], v[228:231], v[60:63], v[248:251]
    v_mfma_f32_16x16x32_bf16 v[252:255], v[228:231], v[116:119], v[252:255]
    s_waitcnt lgkmcnt(1)
    v_mfma_f32_16x16x32_bf16 v[248:251], v[232:235], v[64:67], v[248:251]
    v_mfma_f32_16x16x32_bf16 v[252:255], v[232:235], v[120:123], v[252:255]
    s_waitcnt lgkmcnt(0)
    v_mfma_f32_16x16x32_bf16 v[248:251], v[236:239], v[68:71], v[248:251]
    v_mfma_f32_16x16x32_bf16 v[252:255], v[236:239], v[124:127], v[252:255]
    s_nop 7
    v_cvt_pk_bf16_f32 v128, v240, v241
    v_cvt_pk_bf16_f32 v129, v242, v243
    v_cvt_pk_bf16_f32 v130, v248, v249
    v_cvt_pk_bf16_f32 v131, v250, v251
    v_cvt_pk_bf16_f32 v132, v244, v245
    v_cvt_pk_bf16_f32 v133, v246, v247
    v_cvt_pk_bf16_f32 v134, v252, v253
    v_cvt_pk_bf16_f32 v135, v254, v255
    s_waitcnt vmcnt(7)
    v_accvgpr_write_b32 a48, v128
    v_accvgpr_write_b32 a49, v129
    v_accvgpr_write_b32 a50, v130
    v_accvgpr_write_b32 a51, v131
    v_accvgpr_write_b32 a52, v132
    v_accvgpr_write_b32 a53, v133
    v_accvgpr_write_b32 a54, v134
    v_accvgpr_write_b32 a55, v135
    v_mfma_f32_16x16x32_bf16 a[0:3], a[24:27], v[128:131], a[0:3]
    v_mfma_f32_16x16x32_bf16 a[4:7], a[24:27], v[132:135], a[4:7]
    v_mfma_f32_16x16x32_bf16 a[8:11], a[28:31], v[128:131], a[8:11]
    v_mfma_f32_16x16x32_bf16 a[12:15], a[28:31], v[132:135], a[12:15]
    s_add_u32 s7, s7, 28672
    s_cmp_ge_u32 s7, 86016
    s_cselect_b32 s28, 86016, 0
    s_sub_u32 s7, s7, s28
    s_add_u32 s6, s6, 1
    s_add_u32 s26, s6, 1
    s_cmp_lt_u32 s26, 14
    s_cbranch_scc1 wp1_w7
    s_waitcnt vmcnt(0)
    s_branch wp1_w
    wp1_w7:
    s_waitcnt vmcnt(7)
    wp1_w:
wp2_loop:
    s_barrier
    s_mov_b32 s31, 2048
    buffer_load_dwordx4 a[24:27], v7, s[16:19], s31 offen
    s_mov_b32 s31, 16384
    buffer_load_dwordx4 a[28:31], v7, s[16:19], s31 offen
    s_add_u32 s27, s7, 57344
    s_cmp_ge_u32 s27, 86016
    s_cselect_b32 s28, 86016, 0
    s_sub_u32 s27, s27, s28
    s_add_u32 s26, s6, 2
    s_cmp_lt_u32 s26, 14
    s_cbranch_scc0 wp2_nodma
    s_mul_i32 s23, s26, 28672
    s_add_u32 s23, s23, s29
    s_add_u32 s23, s23, s30
    s_add_u32 s24, s27, s30
    s_add_u32 m0, s24, 0
    s_add_u32 s25, s23, 0
    buffer_load_dwordx4 v6, s[12:15], s25 offen lds
    s_add_u32 m0, s24, 1024
    s_add_u32 s25, s23, 1024
    buffer_load_dwordx4 v6, s[12:15], s25 offen lds
    s_add_u32 m0, s24, 2048
    s_add_u32 s25, s23, 2048
    buffer_load_dwordx4 v6, s[12:15], s25 offen lds
    s_add_u32 m0, s24, 3072
    s_add_u32 s25, s23, 3072
    buffer_load_dwordx4 v6, s[12:15], s25 offen lds
    s_add_u32 m0, s24, 4096
    s_add_u32 s25, s23, 4096
    buffer_load_dwordx4 v6, s[12:15], s25 offen lds
    s_add_u32 m0, s24, 5120
    s_add_u32 s25, s23, 5120
    buffer_load_dwordx4 v6, s[12:15], s25 offen lds
    s_add_u32 m0, s24, 6144
    s_add_u32 s25, s23, 6144
    buffer_load_dwordx4 v6, s[12:15], s25 offen lds
wp2_nodma:
    v_add_u32 v10, s7, v9
    ds_read_b128 v[128:131], v10 offset:0
    ds_read_b128 v[132:135], v10 offset:1024
    ds_read_b128 v[136:139], v10 offset:2048
    ds_read_b128 v[140:143], v10 offset:3072
    ds_read_b128 v[144:147], v10 offset:4096
    ds_read_b128 v[148:151], v10 offset:5120
    ds_read_b128 v[152:155], v10 offset:6144
    ds_read_b128 v[156:159], v10 offset:7168
    ds_read_b128 v[160:163], v10 offset:8192
    ds_read_b128 v[164:167], v10 offset:9216
    ds_read_b128 v[168:171], v10 offset:10240
    ds_read_b128 v[172:175], v10 offset:11264
    ds_read_b128 v[176:179], v10 offset:12288
    ds_read_b128 v[180:183], v10 offset:13312
    ds_read_b128 v[184:187], v10 offset:14336
    s_waitcnt lgkmcnt(14)
    v_mfma_f32_16x16x32_bf16 v[240:243], v[128:131], v[16:19], 0
    v_mfma_f32_16x16x32_bf16 v[244:247], v[128:131], v[72:75], 0
    ds_read_b128 v[188:191], v10 offset:15360
    s_waitcnt lgkmcnt(14)
    v_mfma_f32_16x16x32_bf16 v[240:243], v[132:135], v[20:23], v[240:243]
    v_mfma_f32_16x16x32_bf16 v[244:247], v[132:135], v[76:79], v[244:247]
    ds_read_b128 v[192:195], v10 offset:16384
    s_waitcnt lgkmcnt(14)
    v_mfma_f32_16x16x32_bf16 v[240:243], v[136:139], v[24:27], v[240:243]
    v_mfma_f32_16x16x32_bf16 v[244:247], v[136:139], v[80:83], v[244:247]
    ds_read_b128 v[196:199], v10 offset:17408
    s_waitcnt lgkmcnt(14)
    v_mfma_f32_16x16x32_bf16 v[240:243], v[140:143], v[28:31], v[240:243]
    v_mfma_f32_16x16x32_bf16 v[244:247], v[140:143], v[84:87], v[244:247]
    ds_read_b128 v[200:203], v10 offset:18432
    s_waitcnt lgkmcnt(14)
    v_mfma_f32_16x16x32_bf16 v[240:243], v[144:147], v[32:35], v[240:243]
    v_mfma_f32_16x16x32_bf16 v[244:247], v[144:147], v[88:91], v[244:247]
    ds_read_b128 v[204:207], v10 offset:19456
    s_waitcnt lgkmcnt(14)
    v_mfma_f32_16x16x32_bf16 v[240:243], v[148:151], v[36:39], v[240:243]
    v_mfma_f32_16x16x32_bf16 v[244:247], v[148:151], v[92:95], v[244:247]
    ds_read_b128 v[208:211], v10 offset:20480
    s_waitcnt lgkmcnt(14)
    v_mfma_f32_16x16x32_bf16 v[240:243], v[152:155], v[40:43], v[240:243]
    v_mfma_f32_16x16x32_bf16 v[244:247], v[152:155], v[96:99], v[244:247]
    ds_read_b128 v[212:215], v10 offset:21504
    s_waitcnt lgkmcnt(14)
    v_mfma_f32_16x16x32_bf16 v[240:243], v[156:159], v[44:47], v[240:243]
    v_mfma_f32_16x16x32_bf16 v[244:247], v[156:159], v[100:103], v[244:247]
    ds_read_b128 v[216:219], v10 offset:22528
    s_waitcnt lgkmcnt(14)
    v_mfma_f32_16x16x32_bf16 v[240:243], v[160:163], v[48:51], v[240:243]
    v_mfma_f32_16x16x32_bf16 v[244:247], v[160:163], v[104:107], v[244:247]
    ds_read_b128 v[220:223], v10 offset:23552
    s_waitcnt lgkmcnt(14)
    v_mfma_f32_16x16x32_bf16 v[240:243], v[164:167], v[52:55], v[240:243]
    v_mfma_f32_16x16x32_bf16 v[244:247], v[164:167], v[108:111], v[244:247]
    ds_read_b128 v[224:227], v10 offset:24576
    s_waitcnt lgkmcnt(14)
    v_mfma_f32_16x16x32_bf16 v[240:243], v[168:171], v[56:59], v[240:243]
    v_mfma_f32_16x16x32_bf16 v[244:247], v[168:171], v[112:115], v[244:247]
    ds_read_b128 v[228:231], v10 offset:25600
    s_waitcnt lgkmcnt(14)
    v_mfma_f32_16x16x32_bf16 v[240:243], v[172:175], v[60:63], v[240:243]
    v_mfma_f32_16x16x32_bf16 v[244:247], v[172:175], v[116:119], v[244:247]
    ds_read_b128 v[232:235], v10 offset:26624
    s_waitcnt lgkmcnt(14)
    v_mfma_f32_16x16x32_bf16 v[240:243], v[176:179], v[64:67], v[240:243]
    v_mfma_f32_16x16x32_bf16 v[244:247], v[176:179], v[120:123], v[244:247]
    ds_read_b128 v[236:239], v10 offset:27648
    s_waitcnt lgkmcnt(14)
    v_mfma_f32_16x16x32_bf16 v[240:243], v[180:183], v[68:71], v[240:243]
    v_mfma_f32_16x16x32_bf16 v[244:247], v[180:183], v[124:127], v[244:247]
    s_waitcnt lgkmcnt(13)
    v_mfma_f32_16x16x32_bf16 v[248:251], v[184:187], v[16:19], 0
    v_mfma_f32_16x16x32_bf16 v[252:255], v[184:187], v[72:75], 0
    s_waitcnt lgkmcnt(12)
    v_mfma_f32_16x16x32_bf16 v[248:251], v[188:191], v[20:23], v[248:251]
    v_mfma_f32_16x16x32_bf16 v[252:255], v[188:191], v[76:79], v[252:255]
    s_waitcnt lgkmcnt(11)
    v_mfma_f32_16x16x32_bf16 v[248:251], v[192:195], v[24:27], v[248:251]
    v_mfma_f32_16x16x32_bf16 v[252:255], v[192:195], v[80:83], v[252:255]
    s_waitcnt lgkmcnt(10)
    v_mfma_f32_16x16x32_bf16 v[248:251], v[196:199], v[28:31], v[248:251]
    v_mfma_f32_16x16x32_bf16 v[252:255], v[196:199], v[84:87], v[252:255]
    s_waitcnt lgkmcnt(9)
    v_mfma_f32_16x16x32_bf16 v[248:251], v[200:203], v[32:35], v[248:251]
    v_mfma_f32_16x16x32_bf16 v[252:255], v[200:203], v[88:91], v[252:255]
    s_waitcnt lgkmcnt(8)
    v_mfma_f32_16x16x32_bf16 v[248:251], v[204:207], v[36:39], v[248:251]
    v_mfma_f32_16x16x32_bf16 v[252:255], v[204:207], v[92:95], v[252:255]
    s_waitcnt lgkmcnt(7)
    v_mfma_f32_16x16x32_bf16 v[248:251], v[208:211], v[40:43], v[248:251]
    v_mfma_f32_16x16x32_bf16 v[252:255], v[208:211], v[96:99], v[252:255]
    s_waitcnt lgkmcnt(6)
    v_mfma_f32_16x16x32_bf16 v[248:251], v[212:215], v[44:47], v[248:251]
    v_mfma_f32_16x16x32_bf16 v[252:255], v[212:215], v[100:103], v[252:255]
    s_waitcnt lgkmcnt(5)
    v_mfma_f32_16x16x32_bf16 v[248:251], v[216:219], v[48:51], v[248:251]
    v_mfma_f32_16x16x32_bf16 v[252:255], v[216:219], v[104:107], v[252:255]
    s_waitcnt lgkmcnt(4)
    v_mfma_f32_16x16x32_bf16 v[248:251], v[220:223], v[52:55], v[248:251]
    v_mfma_f32_16x16x32_bf16 v[252:255], v[220:223], v[108:111], v[252:255]
    s_waitcnt lgkmcnt(3)
    v_mfma_f32_16x16x32_bf16 v[248:251], v[224:227], v[56:59], v[248:251]
    v_mfma_f32_16x16x32_bf16 v[252:255], v[224:227], v[112:115], v[252:255]
    s_waitcnt lgkmcnt(2)
    v_mfma_f32_16x16x32_bf16 v[248:251], v[228:231], v[60:63], v[248:251]
    v_mfma_f32_16x16x32_bf16 v[252:255], v[228:231], v[116:119], v[252:255]
    s_waitcnt lgkmcnt(1)
    v_mfma_f32_16x16x32_bf16 v[248:251], v[232:235], v[64:67], v[248:251]
    v_mfma_f32_16x16x32_bf16 v[252:255], v[232:235], v[120:123], v[252:255]
    s_waitcnt lgkmcnt(0)
    v_mfma_f32_16x16x32_bf16 v[248:251], v[236:239], v[68:71], v[248:251]
    v_mfma_f32_16x16x32_bf16 v[252:255], v[236:239], v[124:127], v[252:255]
    s_nop 7
    v_cvt_pk_bf16_f32 v128, v240, v241
    v_cvt_pk_bf16_f32 v129, v242, v243
    v_cvt_pk_bf16_f32 v130, v248, v249
    v_cvt_pk_bf16_f32 v131, v250, v251
    v_cvt_pk_bf16_f32 v132, v244, v245
    v_cvt_pk_bf16_f32 v133, v246, v247
    v_cvt_pk_bf16_f32 v134, v252, v253
    v_cvt_pk_bf16_f32 v135, v254, v255
    s_waitcnt vmcnt(7)
    v_accvgpr_write_b32 a56, v128
    v_accvgpr_write_b32 a57, v129
    v_accvgpr_write_b32 a58, v130
    v_accvgpr_write_b32 a59, v131
    v_accvgpr_write_b32 a60, v132
    v_accvgpr_write_b32 a61, v133
    v_accvgpr_write_b32 a62, v134
    v_accvgpr_write_b32 a63, v135
    v_mfma_f32_16x16x32_bf16 a[0:3], a[24:27], v[128:131], a[0:3]
    v_mfma_f32_16x16x32_bf16 a[4:7], a[24:27], v[132:135], a[4:7]
    v_mfma_f32_16x16x32_bf16 a[8:11], a[28:31], v[128:131], a[8:11]
    v_mfma_f32_16x16x32_bf16 a[12:15], a[28:31], v[132:135], a[12:15]
    s_add_u32 s7, s7, 28672
    s_cmp_ge_u32 s7, 86016
    s_cselect_b32 s28, 86016, 0
    s_sub_u32 s7, s7, s28
    s_add_u32 s6, s6, 1
    s_add_u32 s26, s6, 1
    s_cmp_lt_u32 s26, 14
    s_cbranch_scc1 wp2_w7
    s_waitcnt vmcnt(0)
    s_branch wp2_w
    wp2_w7:
    s_waitcnt vmcnt(7)
    wp2_w:
wp3_loop:
    s_barrier
    s_mov_b32 s31, 3072
    buffer_load_dwordx4 a[24:27], v7, s[16:19], s31 offen
    s_mov_b32 s31, 17408
    buffer_load_dwordx4 a[28:31], v7, s[16:19], s31 offen
    s_add_u32 s27, s7, 57344
    s_cmp_ge_u32 s27, 86016
    s_cselect_b32 s28, 86016, 0
    s_sub_u32 s27, s27, s28
    s_add_u32 s26, s6, 2
    s_cmp_lt_u32 s26, 14
    s_cbranch_scc0 wp3_nodma
    s_mul_i32 s23, s26, 28672
    s_add_u32 s23, s23, s29
    s_add_u32 s23, s23, s30
    s_add_u32 s24, s27, s30
    s_add_u32 m0, s24, 0
    s_add_u32 s25, s23, 0
    buffer_load_dwordx4 v6, s[12:15], s25 offen lds
    s_add_u32 m0, s24, 1024
    s_add_u32 s25, s23, 1024
    buffer_load_dwordx4 v6, s[12:15], s25 offen lds
    s_add_u32 m0, s24, 2048
    s_add_u32 s25, s23, 2048
    buffer_load_dwordx4 v6, s[12:15], s25 offen lds
    s_add_u32 m0, s24, 3072
    s_add_u32 s25, s23, 3072
    buffer_load_dwordx4 v6, s[12:15], s25 offen lds
    s_add_u32 m0, s24, 4096
    s_add_u32 s25, s23, 4096
    buffer_load_dwordx4 v6, s[12:15], s25 offen lds
    s_add_u32 m0, s24, 5120
    s_add_u32 s25, s23, 5120
    buffer_load_dwordx4 v6, s[12:15], s25 offen lds
    s_add_u32 m0, s24, 6144
    s_add_u32 s25, s23, 6144
    buffer_load_dwordx4 v6, s[12:15], s25 offen lds
wp3_nodma:
    v_add_u32 v10, s7, v9
    ds_read_b128 v[128:131], v10 offset:0
    ds_read_b128 v[132:135], v10 offset:1024
    ds_read_b128 v[136:139], v10 offset:2048
    ds_read_b128 v[140:143], v10 offset:3072
    ds_read_b128 v[144:147], v10 offset:4096
    ds_read_b128 v[148:151], v10 offset:5120
    ds_read_b128 v[152:155], v10 offset:6144
    ds_read_b128 v[156:159], v10 offset:7168
    ds_read_b128 v[160:163], v10 offset:8192
    ds_read_b128 v[164:167], v10 offset:9216
    ds_read_b128 v[168:171], v10 offset:10240
    ds_read_b128 v[172:175], v10 offset:11264
    ds_read_b128 v[176:179], v10 offset:12288
    ds_read_b128 v[180:183], v10 offset:13312
    ds_read_b128 v[184:187], v10 offset:14336
    s_waitcnt lgkmcnt(14)
    v_mfma_f32_16x16x32_bf16 v[240:243], v[128:131], v[16:19], 0
    v_mfma_f32_16x16x32_bf16 v[244:247], v[128:131], v[72:75], 0
    ds_read_b128 v[188:191], v10 offset:15360
    s_waitcnt lgkmcnt(14)
    v_mfma_f32_16x16x32_bf16 v[240:243], v[132:135], v[20:23], v[240:243]
    v_mfma_f32_16x16x32_bf16 v[244:247], v[132:135], v[76:79], v[244:247]
    ds_read_b128 v[192:195], v10 offset:16384
    s_waitcnt lgkmcnt(14)
    v_mfma_f32_16x16x32_bf16 v[240:243], v[136:139], v[24:27], v[240:243]
    v_mfma_f32_16x16x32_bf16 v[244:247], v[136:139], v[80:83], v[244:247]
    ds_read_b128 v[196:199], v10 offset:17408
    s_waitcnt lgkmcnt(14)
    v_mfma_f32_16x16x32_bf16 v[240:243], v[140:143], v[28:31], v[240:243]
    v_mfma_f32_16x16x32_bf16 v[244:247], v[140:143], v[84:87], v[244:247]
    ds_read_b128 v[200:203], v10 offset:18432
    s_waitcnt lgkmcnt(14)
    v_mfma_f32_16x16x32_bf16 v[240:243], v[144:147], v[32:35], v[240:243]
    v_mfma_f32_16x16x32_bf16 v[244:247], v[144:147], v[88:91], v[244:247]
    ds_read_b128 v[204:207], v10 offset:19456
    s_waitcnt lgkmcnt(14)
    v_mfma_f32_16x16x32_bf16 v[240:243], v[148:151], v[36:39], v[240:243]
    v_mfma_f32_16x16x32_bf16 v[244:247], v[148:151], v[92:95], v[244:247]
    ds_read_b128 v[208:211], v10 offset:20480
    s_waitcnt lgkmcnt(14)
    v_mfma_f32_16x16x32_bf16 v[240:243], v[152:155], v[40:43], v[240:243]
    v_mfma_f32_16x16x32_bf16 v[244:247], v[152:155], v[96:99], v[244:247]
    ds_read_b128 v[212:215], v10 offset:21504
    s_waitcnt lgkmcnt(14)
    v_mfma_f32_16x16x32_bf16 v[240:243], v[156:159], v[44:47], v[240:243]
    v_mfma_f32_16x16x32_bf16 v[244:247], v[156:159], v[100:103], v[244:247]
    ds_read_b128 v[216:219], v10 offset:22528
    s_waitcnt lgkmcnt(14)
    v_mfma_f32_16x16x32_bf16 v[240:243], v[160:163], v[48:51], v[240:243]
    v_mfma_f32_16x16x32_bf16 v[244:247], v[160:163], v[104:107], v[244:247]
    ds_read_b128 v[220:223], v10 offset:23552
    s_waitcnt lgkmcnt(14)
    v_mfma_f32_16x16x32_bf16 v[240:243], v[164:167], v[52:55], v[240:243]
    v_mfma_f32_16x16x32_bf16 v[244:247], v[164:167], v[108:111], v[244:247]
    ds_read_b128 v[224:227], v10 offset:24576
    s_waitcnt lgkmcnt(14)
    v_mfma_f32_16x16x32_bf16 v[240:243], v[168:171], v[56:59], v[240:243]
    v_mfma_f32_16x16x32_bf16 v[244:247], v[168:171], v[112:115], v[244:247]
    ds_read_b128 v[228:231], v10 offset:25600
    s_waitcnt lgkmcnt(14)
    v_mfma_f32_16x16x32_bf16 v[240:243], v[172:175], v[60:63], v[240:243]
    v_mfma_f32_16x16x32_bf16 v[244:247], v[172:175], v[116:119], v[244:247]
    ds_read_b128 v[232:235], v10 offset:26624
    s_waitcnt lgkmcnt(14)
    v_mfma_f32_16x16x32_bf16 v[240:243], v[176:179], v[64:67], v[240:243]
    v_mfma_f32_16x16x32_bf16 v[244:247], v[176:179], v[120:123], v[244:247]
    ds_read_b128 v[236:239], v10 offset:27648
    s_waitcnt lgkmcnt(14)
    v_mfma_f32_16x16x32_bf16 v[240:243], v[180:183], v[68:71], v[240:243]
    v_mfma_f32_16x16x32_bf16 v[244:247], v[180:183], v[124:127], v[244:247]
    s_waitcnt lgkmcnt(13)
    v_mfma_f32_16x16x32_bf16 v[248:251], v[184:187], v[16:19], 0
    v_mfma_f32_16x16x32_bf16 v[252:255], v[184:187], v[72:75], 0
    s_waitcnt lgkmcnt(12)
    v_mfma_f32_16x16x32_bf16 v[248:251], v[188:191], v[20:23], v[248:251]
    v_mfma_f32_16x16x32_bf16 v[252:255], v[188:191], v[76:79], v[252:255]
    s_waitcnt lgkmcnt(11)
    v_mfma_f32_16x16x32_bf16 v[248:251], v[192:195], v[24:27], v[248:251]
    v_mfma_f32_16x16x32_bf16 v[252:255], v[192:195], v[80:83], v[252:255]
    s_waitcnt lgkmcnt(10)
    v_mfma_f32_16x16x32_bf16 v[248:251], v[196:199], v[28:31], v[248:251]
    v_mfma_f32_16x16x32_bf16 v[252:255], v[196:199], v[84:87], v[252:255]
    s_waitcnt lgkmcnt(9)
    v_mfma_f32_16x16x32_bf16 v[248:251], v[200:203], v[32:35], v[248:251]
    v_mfma_f32_16x16x32_bf16 v[252:255], v[200:203], v[88:91], v[252:255]
    s_waitcnt lgkmcnt(8)
    v_mfma_f32_16x16x32_bf16 v[248:251], v[204:207], v[36:39], v[248:251]
    v_mfma_f32_16x16x32_bf16 v[252:255], v[204:207], v[92:95], v[252:255]
    s_waitcnt lgkmcnt(7)
    v_mfma_f32_16x16x32_bf16 v[248:251], v[208:211], v[40:43], v[248:251]
    v_mfma_f32_16x16x32_bf16 v[252:255], v[208:211], v[96:99], v[252:255]
    s_waitcnt lgkmcnt(6)
    v_mfma_f32_16x16x32_bf16 v[248:251], v[212:215], v[44:47], v[248:251]
    v_mfma_f32_16x16x32_bf16 v[252:255], v[212:215], v[100:103], v[252:255]
    s_waitcnt lgkmcnt(5)
    v_mfma_f32_16x16x32_bf16 v[248:251], v[216:219], v[48:51], v[248:251]
    v_mfma_f32_16x16x32_bf16 v[252:255], v[216:219], v[104:107], v[252:255]
    s_waitcnt lgkmcnt(4)
    v_mfma_f32_16x16x32_bf16 v[248:251], v[220:223], v[52:55], v[248:251]
    v_mfma_f32_16x16x32_bf16 v[252:255], v[220:223], v[108:111], v[252:255]
    s_waitcnt lgkmcnt(3)
    v_mfma_f32_16x16x32_bf16 v[248:251], v[224:227], v[56:59], v[248:251]
    v_mfma_f32_16x16x32_bf16 v[252:255], v[224:227], v[112:115], v[252:255]
    s_waitcnt lgkmcnt(2)
    v_mfma_f32_16x16x32_bf16 v[248:251], v[228:231], v[60:63], v[248:251]
    v_mfma_f32_16x16x32_bf16 v[252:255], v[228:231], v[116:119], v[252:255]
    s_waitcnt lgkmcnt(1)
    v_mfma_f32_16x16x32_bf16 v[248:251], v[232:235], v[64:67], v[248:251]
    v_mfma_f32_16x16x32_bf16 v[252:255], v[232:235], v[120:123], v[252:255]
    s_waitcnt lgkmcnt(0)
    v_mfma_f32_16x16x32_bf16 v[248:251], v[236:239], v[68:71], v[248:251]
    v_mfma_f32_16x16x32_bf16 v[252:255], v[236:239], v[124:127], v[252:255]
    s_nop 7
    v_cvt_pk_bf16_f32 v128, v240, v241
    v_cvt_pk_bf16_f32 v129, v242, v243
    v_cvt_pk_bf16_f32 v130, v248, v249
    v_cvt_pk_bf16_f32 v131, v250, v251
    v_cvt_pk_bf16_f32 v132, v244, v245
    v_cvt_pk_bf16_f32 v133, v246, v247
    v_cvt_pk_bf16_f32 v134, v252, v253
    v_cvt_pk_bf16_f32 v135, v254, v255
    s_waitcnt vmcnt(7)
    v_accvgpr_write_b32 a64, v128
    v_accvgpr_write_b32 a65, v129
    v_accvgpr_write_b32 a66, v130
    v_accvgpr_write_b32 a67, v131
    v_accvgpr_write_b32 a68, v132
    v_accvgpr_write_b32 a69, v133
    v_accvgpr_write_b32 a70, v134
    v_accvgpr_write_b32 a71, v135
    v_mfma_f32_16x16x32_bf16 a[0:3], a[24:27], v[128:131], a[0:3]
    v_mfma_f32_16x16x32_bf16 a[4:7], a[24:27], v[132:135], a[4:7]
    v_mfma_f32_16x16x32_bf16 a[8:11], a[28:31], v[128:131], a[8:11]
    v_mfma_f32_16x16x32_bf16 a[12:15], a[28:31], v[132:135], a[12:15]
    s_add_u32 s7, s7, 28672
    s_cmp_ge_u32 s7, 86016
    s_cselect_b32 s28, 86016, 0
    s_sub_u32 s7, s7, s28
    s_add_u32 s6, s6, 1
    s_add_u32 s26, s6, 1
    s_cmp_lt_u32 s26, 14
    s_cbranch_scc1 wp3_w7
    s_waitcnt vmcnt(0)
    s_branch wp3_w
    wp3_w7:
    s_waitcnt vmcnt(7)
    wp3_w:
wp4_loop:
    s_barrier
    s_mov_b32 s31, 4096
    buffer_load_dwordx4 a[24:27], v7, s[16:19], s31 offen
    s_mov_b32 s31, 18432
    buffer_load_dwordx4 a[28:31], v7, s[16:19], s31 offen
    s_add_u32 s27, s7, 57344
    s_cmp_ge_u32 s27, 86016
    s_cselect_b32 s28, 86016, 0
    s_sub_u32 s27, s27, s28
    s_add_u32 s26, s6, 2
    s_cmp_lt_u32 s26, 14
    s_cbranch_scc0 wp4_nodma
    s_mul_i32 s23, s26, 28672
    s_add_u32 s23, s23, s29
    s_add_u32 s23, s23, s30
    s_add_u32 s24, s27, s30
    s_add_u32 m0, s24, 0
    s_add_u32 s25, s23, 0
    buffer_load_dwordx4 v6, s[12:15], s25 offen lds
    s_add_u32 m0, s24, 1024
    s_add_u32 s25, s23, 1024
    buffer_load_dwordx4 v6, s[12:15], s25 offen lds
    s_add_u32 m0, s24, 2048
    s_add_u32 s25, s23, 2048
    buffer_load_dwordx4 v6, s[12:15], s25 offen lds
    s_add_u32 m0, s24, 3072
    s_add_u32 s25, s23, 3072
    buffer_load_dwordx4 v6, s[12:15], s25 offen lds
    s_add_u32 m0, s24, 4096
    s_add_u32 s25, s23, 4096
    buffer_load_dwordx4 v6, s[12:15], s25 offen lds
    s_add_u32 m0, s24, 5120
    s_add_u32 s25, s23, 5120
    buffer_load_dwordx4 v6, s[12:15], s25 offen lds
    s_add_u32 m0, s24, 6144
    s_add_u32 s25, s23, 6144
    buffer_load_dwordx4 v6, s[12:15], s25 offen lds
wp4_nodma:
    v_add_u32 v10, s7, v9
    ds_read_b128 v[128:131], v10 offset:0
    ds_read_b128 v[132:135], v10 offset:1024
    ds_read_b128 v[136:139], v10 offset:2048
    ds_read_b128 v[140:143], v10 offset:3072
    ds_read_b128 v[144:147], v10 offset:4096
    ds_read_b128 v[148:151], v10 offset:5120
    ds_read_b128 v[152:155], v10 offset:6144
    ds_read_b128 v[156:159], v10 offset:7168
    ds_read_b128 v[160:163], v10 offset:8192
    ds_read_b128 v[164:167], v10 offset:9216
    ds_read_b128 v[168:171], v10 offset:10240
    ds_read_b128 v[172:175], v10 offset:11264
    ds_read_b128 v[176:179], v10 offset:12288
    ds_read_b128 v[180:183], v10 offset:13312
    ds_read_b128 v[184:187], v10 offset:14336
    s_waitcnt lgkmcnt(14)
    v_mfma_f32_16x16x32_bf16 v[240:243], v[128:131], v[16:19], 0
    v_mfma_f32_16x16x32_bf16 v[244:247], v[128:131], v[72:75], 0
    ds_read_b128 v[188:191], v10 offset:15360
    s_waitcnt lgkmcnt(14)
    v_mfma_f32_16x16x32_bf16 v[240:243], v[132:135], v[20:23], v[240:243]
    v_mfma_f32_16x16x32_bf16 v[244:247], v[132:135], v[76:79], v[244:247]
    ds_read_b128 v[192:195], v10 offset:16384
    s_waitcnt lgkmcnt(14)
    v_mfma_f32_16x16x32_bf16 v[240:243], v[136:139], v[24:27], v[240:243]
    v_mfma_f32_16x16x32_bf16 v[244:247], v[136:139], v[80:83], v[244:247]
    ds_read_b128 v[196:199], v10 offset:17408
    s_waitcnt lgkmcnt(14)
    v_mfma_f32_16x16x32_bf16 v[240:243], v[140:143], v[28:31], v[240:243]
    v_mfma_f32_16x16x32_bf16 v[244:247], v[140:143], v[84:87], v[244:247]
    ds_read_b128 v[200:203], v10 offset:18432
    s_waitcnt lgkmcnt(14)
    v_mfma_f32_16x16x32_bf16 v[240:243], v[144:147], v[32:35], v[240:243]
    v_mfma_f32_16x16x32_bf16 v[244:247], v[144:147], v[88:91], v[244:247]
    ds_read_b128 v[204:207], v10 offset:19456
    s_waitcnt lgkmcnt(14)
    v_mfma_f32_16x16x32_bf16 v[240:243], v[148:151], v[36:39], v[240:243]
    v_mfma_f32_16x16x32_bf16 v[244:247], v[148:151], v[92:95], v[244:247]
    ds_read_b128 v[208:211], v10 offset:20480
    s_waitcnt lgkmcnt(14)
    v_mfma_f32_16x16x32_bf16 v[240:243], v[152:155], v[40:43], v[240:243]
    v_mfma_f32_16x16x32_bf16 v[244:247], v[152:155], v[96:99], v[244:247]
    ds_read_b128 v[212:215], v10 offset:21504
    s_waitcnt lgkmcnt(14)
    v_mfma_f32_16x16x32_bf16 v[240:243], v[156:159], v[44:47], v[240:243]
    v_mfma_f32_16x16x32_bf16 v[244:247], v[156:159], v[100:103], v[244:247]
    ds_read_b128 v[216:219], v10 offset:22528
    s_waitcnt lgkmcnt(14)
    v_mfma_f32_16x16x32_bf16 v[240:243], v[160:163], v[48:51], v[240:243]
    v_mfma_f32_16x16x32_bf16 v[244:247], v[160:163], v[104:107], v[244:247]
    ds_read_b128 v[220:223], v10 offset:23552
    s_waitcnt lgkmcnt(14)
    v_mfma_f32_16x16x32_bf16 v[240:243], v[164:167], v[52:55], v[240:243]
    v_mfma_f32_16x16x32_bf16 v[244:247], v[164:167], v[108:111], v[244:247]
    ds_read_b128 v[224:227], v10 offset:24576
    s_waitcnt lgkmcnt(14)
    v_mfma_f32_16x16x32_bf16 v[240:243], v[168:171], v[56:59], v[240:243]
    v_mfma_f32_16x16x32_bf16 v[244:247], v[168:171], v[112:115], v[244:247]
    ds_read_b128 v[228:231], v10 offset:25600
    s_waitcnt lgkmcnt(14)
    v_mfma_f32_16x16x32_bf16 v[240:243], v[172:175], v[60:63], v[240:243]
    v_mfma_f32_16x16x32_bf16 v[244:247], v[172:175], v[116:119], v[244:247]
    ds_read_b128 v[232:235], v10 offset:26624
    s_waitcnt lgkmcnt(14)
    v_mfma_f32_16x16x32_bf16 v[240:243], v[176:179], v[64:67], v[240:243]
    v_mfma_f32_16x16x32_bf16 v[244:247], v[176:179], v[120:123], v[244:247]
    ds_read_b128 v[236:239], v10 offset:27648
    s_waitcnt lgkmcnt(14)
    v_mfma_f32_16x16x32_bf16 v[240:243], v[180:183], v[68:71], v[240:243]
    v_mfma_f32_16x16x32_bf16 v[244:247], v[180:183], v[124:127], v[244:247]
    s_waitcnt lgkmcnt(13)
    v_mfma_f32_16x16x32_bf16 v[248:251], v[184:187], v[16:19], 0
    v_mfma_f32_16x16x32_bf16 v[252:255], v[184:187], v[72:75], 0
    s_waitcnt lgkmcnt(12)
    v_mfma_f32_16x16x32_bf16 v[248:251], v[188:191], v[20:23], v[248:251]
    v_mfma_f32_16x16x32_bf16 v[252:255], v[188:191], v[76:79], v[252:255]
    s_waitcnt lgkmcnt(11)
    v_mfma_f32_16x16x32_bf16 v[248:251], v[192:195], v[24:27], v[248:251]
    v_mfma_f32_16x16x32_bf16 v[252:255], v[192:195], v[80:83], v[252:255]
    s_waitcnt lgkmcnt(10)
    v_mfma_f32_16x16x32_bf16 v[248:251], v[196:199], v[28:31], v[248:251]
    v_mfma_f32_16x16x32_bf16 v[252:255], v[196:199], v[84:87], v[252:255]
    s_waitcnt lgkmcnt(9)
    v_mfma_f32_16x16x32_bf16 v[248:251], v[200:203], v[32:35], v[248:251]
    v_mfma_f32_16x16x32_bf16 v[252:255], v[200:203], v[88:91], v[252:255]
    s_waitcnt lgkmcnt(8)
    v_mfma_f32_16x16x32_bf16 v[248:251], v[204:207], v[36:39], v[248:251]
    v_mfma_f32_16x16x32_bf16 v[252:255], v[204:207], v[92:95], v[252:255]
    s_waitcnt lgkmcnt(7)
    v_mfma_f32_16x16x32_bf16 v[248:251], v[208:211], v[40:43], v[248:251]
    v_mfma_f32_16x16x32_bf16 v[252:255], v[208:211], v[96:99], v[252:255]
    s_waitcnt lgkmcnt(6)
    v_mfma_f32_16x16x32_bf16 v[248:251], v[212:215], v[44:47], v[248:251]
    v_mfma_f32_16x16x32_bf16 v[252:255], v[212:215], v[100:103], v[252:255]
    s_waitcnt lgkmcnt(5)
    v_mfma_f32_16x16x32_bf16 v[248:251], v[216:219], v[48:51], v[248:251]
    v_mfma_f32_16x16x32_bf16 v[252:255], v[216:219], v[104:107], v[252:255]
    s_waitcnt lgkmcnt(4)
    v_mfma_f32_16x16x32_bf16 v[248:251], v[220:223], v[52:55], v[248:251]
    v_mfma_f32_16x16x32_bf16 v[252:255], v[220:223], v[108:111], v[252:255]
    s_waitcnt lgkmcnt(3)
    v_mfma_f32_16x16x32_bf16 v[248:251], v[224:227], v[56:59], v[248:251]
    v_mfma_f32_16x16x32_bf16 v[252:255], v[224:227], v[112:115], v[252:255]
    s_waitcnt lgkmcnt(2)
    v_mfma_f32_16x16x32_bf16 v[248:251], v[228:231], v[60:63], v[248:251]
    v_mfma_f32_16x16x32_bf16 v[252:255], v[228:231], v[116:119], v[252:255]
    s_waitcnt lgkmcnt(1)
    v_mfma_f32_16x16x32_bf16 v[248:251], v[232:235], v[64:67], v[248:251]
    v_mfma_f32_16x16x32_bf16 v[252:255], v[232:235], v[120:123], v[252:255]
    s_waitcnt lgkmcnt(0)
    v_mfma_f32_16x16x32_bf16 v[248:251], v[236:239], v[68:71], v[248:251]
    v_mfma_f32_16x16x32_bf16 v[252:255], v[236:239], v[124:127], v[252:255]
    s_nop 7
    v_cvt_pk_bf16_f32 v128, v240, v241
    v_cvt_pk_bf16_f32 v129, v242, v243
    v_cvt_pk_bf16_f32 v130, v248, v249
    v_cvt_pk_bf16_f32 v131, v250, v251
    v_cvt_pk_bf16_f32 v132, v244, v245
    v_cvt_pk_bf16_f32 v133, v246, v247
    v_cvt_pk_bf16_f32 v134, v252, v253
    v_cvt_pk_bf16_f32 v135, v254, v255
    s_waitcnt vmcnt(7)
    v_accvgpr_write_b32 a72, v128
    v_accvgpr_write_b32 a73, v129
    v_accvgpr_write_b32 a74, v130
    v_accvgpr_write_b32 a75, v131
    v_accvgpr_write_b32 a76, v132
    v_accvgpr_write_b32 a77, v133
    v_accvgpr_write_b32 a78, v134
    v_accvgpr_write_b32 a79, v135
    v_mfma_f32_16x16x32_bf16 a[0:3], a[24:27], v[128:131], a[0:3]
    v_mfma_f32_16x16x32_bf16 a[4:7], a[24:27], v[132:135], a[4:7]
    v_mfma_f32_16x16x32_bf16 a[8:11], a[28:31], v[128:131], a[8:11]
    v_mfma_f32_16x16x32_bf16 a[12:15], a[28:31], v[132:135], a[12:15]
    s_add_u32 s7, s7, 28672
    s_cmp_ge_u32 s7, 86016
    s_cselect_b32 s28, 86016, 0
    s_sub_u32 s7, s7, s28
    s_add_u32 s6, s6, 1
    s_add_u32 s26, s6, 1
    s_cmp_lt_u32 s26, 14
    s_cbranch_scc1 wp4_w7
    s_waitcnt vmcnt(0)
    s_branch wp4_w
    wp4_w7:
    s_waitcnt vmcnt(7)
    wp4_w:
wp5_loop:
    s_barrier
    s_mov_b32 s31, 5120
    buffer_load_dwordx4 a[24:27], v7, s[16:19], s31 offen
    s_mov_b32 s31, 19456
    buffer_load_dwordx4 a[28:31], v7, s[16:19], s31 offen
    s_add_u32 s27, s7, 57344
    s_cmp_ge_u32 s27, 86016
    s_cselect_b32 s28, 86016, 0
    s_sub_u32 s27, s27, s28
    s_add_u32 s26, s6, 2
    s_cmp_lt_u32 s26, 14
    s_cbranch_scc0 wp5_nodma
    s_mul_i32 s23, s26, 28672
    s_add_u32 s23, s23, s29
    s_add_u32 s23, s23, s30
    s_add_u32 s24, s27, s30
    s_add_u32 m0, s24, 0
    s_add_u32 s25, s23, 0
    buffer_load_dwordx4 v6, s[12:15], s25 offen lds
    s_add_u32 m0, s24, 1024
    s_add_u32 s25, s23, 1024
    buffer_load_dwordx4 v6, s[12:15], s25 offen lds
    s_add_u32 m0, s24, 2048
    s_add_u32 s25, s23, 2048
    buffer_load_dwordx4 v6, s[12:15], s25 offen lds
    s_add_u32 m0, s24, 3072
    s_add_u32 s25, s23, 3072
    buffer_load_dwordx4 v6, s[12:15], s25 offen lds
    s_add_u32 m0, s24, 4096
    s_add_u32 s25, s23, 4096
    buffer_load_dwordx4 v6, s[12:15], s25 offen lds
    s_add_u32 m0, s24, 5120
    s_add_u32 s25, s23, 5120
    buffer_load_dwordx4 v6, s[12:15], s25 offen lds
    s_add_u32 m0, s24, 6144
    s_add_u32 s25, s23, 6144
    buffer_load_dwordx4 v6, s[12:15], s25 offen lds
wp5_nodma:
    v_add_u32 v10, s7, v9
    ds_read_b128 v[128:131], v10 offset:0
    ds_read_b128 v[132:135], v10 offset:1024
    ds_read_b128 v[136:139], v10 offset:2048
    ds_read_b128 v[140:143], v10 offset:3072
    ds_read_b128 v[144:147], v10 offset:4096
    ds_read_b128 v[148:151], v10 offset:5120
    ds_read_b128 v[152:155], v10 offset:6144
    ds_read_b128 v[156:159], v10 offset:7168
    ds_read_b128 v[160:163], v10 offset:8192
    ds_read_b128 v[164:167], v10 offset:9216
    ds_read_b128 v[168:171], v10 offset:10240
    ds_read_b128 v[172:175], v10 offset:11264
    ds_read_b128 v[176:179], v10 offset:12288
    ds_read_b128 v[180:183], v10 offset:13312
    ds_read_b128 v[184:187], v10 offset:14336
    s_waitcnt lgkmcnt(14)
    v_mfma_f32_16x16x32_bf16 v[240:243], v[128:131], v[16:19], 0
    v_mfma_f32_16x16x32_bf16 v[244:247], v[128:131], v[72:75], 0
    ds_read_b128 v[188:191], v10 offset:15360
    s_waitcnt lgkmcnt(14)
    v_mfma_f32_16x16x32_bf16 v[240:243], v[132:135], v[20:23], v[240:243]
    v_mfma_f32_16x16x32_bf16 v[244:247], v[132:135], v[76:79], v[244:247]
    ds_read_b128 v[192:195], v10 offset:16384
    s_waitcnt lgkmcnt(14)
    v_mfma_f32_16x16x32_bf16 v[240:243], v[136:139], v[24:27], v[240:243]
    v_mfma_f32_16x16x32_bf16 v[244:247], v[136:139], v[80:83], v[244:247]
    ds_read_b128 v[196:199], v10 offset:17408
    s_waitcnt lgkmcnt(14)
    v_mfma_f32_16x16x32_bf16 v[240:243], v[140:143], v[28:31], v[240:243]
    v_mfma_f32_16x16x32_bf16 v[244:247], v[140:143], v[84:87], v[244:247]
    ds_read_b128 v[200:203], v10 offset:18432
    s_waitcnt lgkmcnt(14)
    v_mfma_f32_16x16x32_bf16 v[240:243], v[144:147], v[32:35], v[240:243]
    v_mfma_f32_16x16x32_bf16 v[244:247], v[144:147], v[88:91], v[244:247]
    ds_read_b128 v[204:207], v10 offset:19456
    s_waitcnt lgkmcnt(14)
    v_mfma_f32_16x16x32_bf16 v[240:243], v[148:151], v[36:39], v[240:243]
    v_mfma_f32_16x16x32_bf16 v[244:247], v[148:151], v[92:95], v[244:247]
    ds_read_b128 v[208:211], v10 offset:20480
    s_waitcnt lgkmcnt(14)
    v_mfma_f32_16x16x32_bf16 v[240:243], v[152:155], v[40:43], v[240:243]
    v_mfma_f32_16x16x32_bf16 v[244:247], v[152:155], v[96:99], v[244:247]
    ds_read_b128 v[212:215], v10 offset:21504
    s_waitcnt lgkmcnt(14)
    v_mfma_f32_16x16x32_bf16 v[240:243], v[156:159], v[44:47], v[240:243]
    v_mfma_f32_16x16x32_bf16 v[244:247], v[156:159], v[100:103], v[244:247]
    ds_read_b128 v[216:219], v10 offset:22528
    s_waitcnt lgkmcnt(14)
    v_mfma_f32_16x16x32_bf16 v[240:243], v[160:163], v[48:51], v[240:243]
    v_mfma_f32_16x16x32_bf16 v[244:247], v[160:163], v[104:107], v[244:247]
    ds_read_b128 v[220:223], v10 offset:23552
    s_waitcnt lgkmcnt(14)
    v_mfma_f32_16x16x32_bf16 v[240:243], v[164:167], v[52:55], v[240:243]
    v_mfma_f32_16x16x32_bf16 v[244:247], v[164:167], v[108:111], v[244:247]
    ds_read_b128 v[224:227], v10 offset:24576
    s_waitcnt lgkmcnt(14)
    v_mfma_f32_16x16x32_bf16 v[240:243], v[168:171], v[56:59], v[240:243]
    v_mfma_f32_16x16x32_bf16 v[244:247], v[168:171], v[112:115], v[244:247]
    ds_read_b128 v[228:231], v10 offset:25600
    s_waitcnt lgkmcnt(14)
    v_mfma_f32_16x16x32_bf16 v[240:243], v[172:175], v[60:63], v[240:243]
    v_mfma_f32_16x16x32_bf16 v[244:247], v[172:175], v[116:119], v[244:247]
    ds_read_b128 v[232:235], v10 offset:26624
    s_waitcnt lgkmcnt(14)
    v_mfma_f32_16x16x32_bf16 v[240:243], v[176:179], v[64:67], v[240:243]
    v_mfma_f32_16x16x32_bf16 v[244:247], v[176:179], v[120:123], v[244:247]
    ds_read_b128 v[236:239], v10 offset:27648
    s_waitcnt lgkmcnt(14)
    v_mfma_f32_16x16x32_bf16 v[240:243], v[180:183], v[68:71], v[240:243]
    v_mfma_f32_16x16x32_bf16 v[244:247], v[180:183], v[124:127], v[244:247]
    s_waitcnt lgkmcnt(13)
    v_mfma_f32_16x16x32_bf16 v[248:251], v[184:187], v[16:19], 0
    v_mfma_f32_16x16x32_bf16 v[252:255], v[184:187], v[72:75], 0
    s_waitcnt lgkmcnt(12)
    v_mfma_f32_16x16x32_bf16 v[248:251], v[188:191], v[20:23], v[248:251]
    v_mfma_f32_16x16x32_bf16 v[252:255], v[188:191], v[76:79], v[252:255]
    s_waitcnt lgkmcnt(11)
    v_mfma_f32_16x16x32_bf16 v[248:251], v[192:195], v[24:27], v[248:251]
    v_mfma_f32_16x16x32_bf16 v[252:255], v[192:195], v[80:83], v[252:255]
    s_waitcnt lgkmcnt(10)
    v_mfma_f32_16x16x32_bf16 v[248:251], v[196:199], v[28:31], v[248:251]
    v_mfma_f32_16x16x32_bf16 v[252:255], v[196:199], v[84:87], v[252:255]
    s_waitcnt lgkmcnt(9)
    v_mfma_f32_16x16x32_bf16 v[248:251], v[200:203], v[32:35], v[248:251]
    v_mfma_f32_16x16x32_bf16 v[252:255], v[200:203], v[88:91], v[252:255]
    s_waitcnt lgkmcnt(8)
    v_mfma_f32_16x16x32_bf16 v[248:251], v[204:207], v[36:39], v[248:251]
    v_mfma_f32_16x16x32_bf16 v[252:255], v[204:207], v[92:95], v[252:255]
    s_waitcnt lgkmcnt(7)
    v_mfma_f32_16x16x32_bf16 v[248:251], v[208:211], v[40:43], v[248:251]
    v_mfma_f32_16x16x32_bf16 v[252:255], v[208:211], v[96:99], v[252:255]
    s_waitcnt lgkmcnt(6)
    v_mfma_f32_16x16x32_bf16 v[248:251], v[212:215], v[44:47], v[248:251]
    v_mfma_f32_16x16x32_bf16 v[252:255], v[212:215], v[100:103], v[252:255]
    s_waitcnt lgkmcnt(5)
    v_mfma_f32_16x16x32_bf16 v[248:251], v[216:219], v[48:51], v[248:251]
    v_mfma_f32_16x16x32_bf16 v[252:255], v[216:219], v[104:107], v[252:255]
    s_waitcnt lgkmcnt(4)
    v_mfma_f32_16x16x32_bf16 v[248:251], v[220:223], v[52:55], v[248:251]
    v_mfma_f32_16x16x32_bf16 v[252:255], v[220:223], v[108:111], v[252:255]
    s_waitcnt lgkmcnt(3)
    v_mfma_f32_16x16x32_bf16 v[248:251], v[224:227], v[56:59], v[248:251]
    v_mfma_f32_16x16x32_bf16 v[252:255], v[224:227], v[112:115], v[252:255]
    s_waitcnt lgkmcnt(2)
    v_mfma_f32_16x16x32_bf16 v[248:251], v[228:231], v[60:63], v[248:251]
    v_mfma_f32_16x16x32_bf16 v[252:255], v[228:231], v[116:119], v[252:255]
    s_waitcnt lgkmcnt(1)
    v_mfma_f32_16x16x32_bf16 v[248:251], v[232:235], v[64:67], v[248:251]
    v_mfma_f32_16x16x32_bf16 v[252:255], v[232:235], v[120:123], v[252:255]
    s_waitcnt lgkmcnt(0)
    v_mfma_f32_16x16x32_bf16 v[248:251], v[236:239], v[68:71], v[248:251]
    v_mfma_f32_16x16x32_bf16 v[252:255], v[236:239], v[124:127], v[252:255]
    s_nop 7
    v_cvt_pk_bf16_f32 v128, v240, v241
    v_cvt_pk_bf16_f32 v129, v242, v243
    v_cvt_pk_bf16_f32 v130, v248, v249
    v_cvt_pk_bf16_f32 v131, v250, v251
    v_cvt_pk_bf16_f32 v132, v244, v245
    v_cvt_pk_bf16_f32 v133, v246, v247
    v_cvt_pk_bf16_f32 v134, v252, v253
    v_cvt_pk_bf16_f32 v135, v254, v255
    s_waitcnt vmcnt(7)
    v_accvgpr_write_b32 a80, v128
    v_accvgpr_write_b32 a81, v129
    v_accvgpr_write_b32 a82, v130
    v_accvgpr_write_b32 a83, v131
    v_accvgpr_write_b32 a84, v132
    v_accvgpr_write_b32 a85, v133
    v_accvgpr_write_b32 a86, v134
    v_accvgpr_write_b32 a87, v135
    v_mfma_f32_16x16x32_bf16 a[0:3], a[24:27], v[128:131], a[0:3]
    v_mfma_f32_16x16x32_bf16 a[4:7], a[24:27], v[132:135], a[4:7]
    v_mfma_f32_16x16x32_bf16 a[8:11], a[28:31], v[128:131], a[8:11]
    v_mfma_f32_16x16x32_bf16 a[12:15], a[28:31], v[132:135], a[12:15]
    s_add_u32 s7, s7, 28672
    s_cmp_ge_u32 s7, 86016
    s_cselect_b32 s28, 86016, 0
    s_sub_u32 s7, s7, s28
    s_add_u32 s6, s6, 1
    s_add_u32 s26, s6, 1
    s_cmp_lt_u32 s26, 14
    s_cbranch_scc1 wp5_w7
    s_waitcnt vmcnt(0)
    s_branch wp5_w
    wp5_w7:
    s_waitcnt vmcnt(7)
    wp5_w:
wp6_loop:
    s_barrier
    s_mov_b32 s31, 6144
    buffer_load_dwordx4 a[24:27], v7, s[16:19], s31 offen
    s_mov_b32 s31, 20480
    buffer_load_dwordx4 a[28:31], v7, s[16:19], s31 offen
    s_add_u32 s27, s7, 57344
    s_cmp_ge_u32 s27, 86016
    s_cselect_b32 s28, 86016, 0
    s_sub_u32 s27, s27, s28
    s_add_u32 s26, s6, 2
    s_cmp_lt_u32 s26, 14
    s_cbranch_scc0 wp6_nodma
    s_mul_i32 s23, s26, 28672
    s_add_u32 s23, s23, s29
    s_add_u32 s23, s23, s30
    s_add_u32 s24, s27, s30
    s_add_u32 m0, s24, 0
    s_add_u32 s25, s23, 0
    buffer_load_dwordx4 v6, s[12:15], s25 offen lds
    s_add_u32 m0, s24, 1024
    s_add_u32 s25, s23, 1024
    buffer_load_dwordx4 v6, s[12:15], s25 offen lds
    s_add_u32 m0, s24, 2048
    s_add_u32 s25, s23, 2048
    buffer_load_dwordx4 v6, s[12:15], s25 offen lds
    s_add_u32 m0, s24, 3072
    s_add_u32 s25, s23, 3072
    buffer_load_dwordx4 v6, s[12:15], s25 offen lds
    s_add_u32 m0, s24, 4096
    s_add_u32 s25, s23, 4096
    buffer_load_dwordx4 v6, s[12:15], s25 offen lds
    s_add_u32 m0, s24, 5120
    s_add_u32 s25, s23, 5120
    buffer_load_dwordx4 v6, s[12:15], s25 offen lds
    s_add_u32 m0, s24, 6144
    s_add_u32 s25, s23, 6144
    buffer_load_dwordx4 v6, s[12:15], s25 offen lds
wp6_nodma:
    v_add_u32 v10, s7, v9
    ds_read_b128 v[128:131], v10 offset:0
    ds_read_b128 v[132:135], v10 offset:1024
    ds_read_b128 v[136:139], v10 offset:2048
    ds_read_b128 v[140:143], v10 offset:3072
    ds_read_b128 v[144:147], v10 offset:4096
    ds_read_b128 v[148:151], v10 offset:5120
    ds_read_b128 v[152:155], v10 offset:6144
    ds_read_b128 v[156:159], v10 offset:7168
    ds_read_b128 v[160:163], v10 offset:8192
    ds_read_b128 v[164:167], v10 offset:9216
    ds_read_b128 v[168:171], v10 offset:10240
    ds_read_b128 v[172:175], v10 offset:11264
    ds_read_b128 v[176:179], v10 offset:12288
    ds_read_b128 v[180:183], v10 offset:13312
    ds_read_b128 v[184:187], v10 offset:14336
    s_waitcnt lgkmcnt(14)
    v_mfma_f32_16x16x32_bf16 v[240:243], v[128:131], v[16:19], 0
    v_mfma_f32_16x16x32_bf16 v[244:247], v[128:131], v[72:75], 0
    ds_read_b128 v[188:191], v10 offset:15360
    s_waitcnt lgkmcnt(14)
    v_mfma_f32_16x16x32_bf16 v[240:243], v[132:135], v[20:23], v[240:243]
    v_mfma_f32_16x16x32_bf16 v[244:247], v[132:135], v[76:79], v[244:247]
    ds_read_b128 v[192:195], v10 offset:16384
    s_waitcnt lgkmcnt(14)
    v_mfma_f32_16x16x32_bf16 v[240:243], v[136:139], v[24:27], v[240:243]
    v_mfma_f32_16x16x32_bf16 v[244:247], v[136:139], v[80:83], v[244:247]
    ds_read_b128 v[196:199], v10 offset:17408
    s_waitcnt lgkmcnt(14)
    v_mfma_f32_16x16x32_bf16 v[240:243], v[140:143], v[28:31], v[240:243]
    v_mfma_f32_16x16x32_bf16 v[244:247], v[140:143], v[84:87], v[244:247]
    ds_read_b128 v[200:203], v10 offset:18432
    s_waitcnt lgkmcnt(14)
    v_mfma_f32_16x16x32_bf16 v[240:243], v[144:147], v[32:35], v[240:243]
    v_mfma_f32_16x16x32_bf16 v[244:247], v[144:147], v[88:91], v[244:247]
    ds_read_b128 v[204:207], v10 offset:19456
    s_waitcnt lgkmcnt(14)
    v_mfma_f32_16x16x32_bf16 v[240:243], v[148:151], v[36:39], v[240:243]
    v_mfma_f32_16x16x32_bf16 v[244:247], v[148:151], v[92:95], v[244:247]
    ds_read_b128 v[208:211], v10 offset:20480
    s_waitcnt lgkmcnt(14)
    v_mfma_f32_16x16x32_bf16 v[240:243], v[152:155], v[40:43], v[240:243]
    v_mfma_f32_16x16x32_bf16 v[244:247], v[152:155], v[96:99], v[244:247]
    ds_read_b128 v[212:215], v10 offset:21504
    s_waitcnt lgkmcnt(14)
    v_mfma_f32_16x16x32_bf16 v[240:243], v[156:159], v[44:47], v[240:243]
    v_mfma_f32_16x16x32_bf16 v[244:247], v[156:159], v[100:103], v[244:247]
    ds_read_b128 v[216:219], v10 offset:22528
    s_waitcnt lgkmcnt(14)
    v_mfma_f32_16x16x32_bf16 v[240:243], v[160:163], v[48:51], v[240:243]
    v_mfma_f32_16x16x32_bf16 v[244:247], v[160:163], v[104:107], v[244:247]
    ds_read_b128 v[220:223], v10 offset:23552
    s_waitcnt lgkmcnt(14)
    v_mfma_f32_16x16x32_bf16 v[240:243], v[164:167], v[52:55], v[240:243]
    v_mfma_f32_16x16x32_bf16 v[244:247], v[164:167], v[108:111], v[244:247]
    ds_read_b128 v[224:227], v10 offset:24576
    s_waitcnt lgkmcnt(14)
    v_mfma_f32_16x16x32_bf16 v[240:243], v[168:171], v[56:59], v[240:243]
    v_mfma_f32_16x16x32_bf16 v[244:247], v[168:171], v[112:115], v[244:247]
    ds_read_b128 v[228:231], v10 offset:25600
    s_waitcnt lgkmcnt(14)
    v_mfma_f32_16x16x32_bf16 v[240:243], v[172:175], v[60:63], v[240:243]
    v_mfma_f32_16x16x32_bf16 v[244:247], v[172:175], v[116:119], v[244:247]
    ds_read_b128 v[232:235], v10 offset:26624
    s_waitcnt lgkmcnt(14)
    v_mfma_f32_16x16x32_bf16 v[240:243], v[176:179], v[64:67], v[240:243]
    v_mfma_f32_16x16x32_bf16 v[244:247], v[176:179], v[120:123], v[244:247]
    ds_read_b128 v[236:239], v10 offset:27648
    s_waitcnt lgkmcnt(14)
    v_mfma_f32_16x16x32_bf16 v[240:243], v[180:183], v[68:71], v[240:243]
    v_mfma_f32_16x16x32_bf16 v[244:247], v[180:183], v[124:127], v[244:247]
    s_waitcnt lgkmcnt(13)
    v_mfma_f32_16x16x32_bf16 v[248:251], v[184:187], v[16:19], 0
    v_mfma_f32_16x16x32_bf16 v[252:255], v[184:187], v[72:75], 0
    s_waitcnt lgkmcnt(12)
    v_mfma_f32_16x16x32_bf16 v[248:251], v[188:191], v[20:23], v[248:251]
    v_mfma_f32_16x16x32_bf16 v[252:255], v[188:191], v[76:79], v[252:255]
    s_waitcnt lgkmcnt(11)
    v_mfma_f32_16x16x32_bf16 v[248:251], v[192:195], v[24:27], v[248:251]
    v_mfma_f32_16x16x32_bf16 v[252:255], v[192:195], v[80:83], v[252:255]
    s_waitcnt lgkmcnt(10)
    v_mfma_f32_16x16x32_bf16 v[248:251], v[196:199], v[28:31], v[248:251]
    v_mfma_f32_16x16x32_bf16 v[252:255], v[196:199], v[84:87], v[252:255]
    s_waitcnt lgkmcnt(9)
    v_mfma_f32_16x16x32_bf16 v[248:251], v[200:203], v[32:35], v[248:251]
    v_mfma_f32_16x16x32_bf16 v[252:255], v[200:203], v[88:91], v[252:255]
    s_waitcnt lgkmcnt(8)
    v_mfma_f32_16x16x32_bf16 v[248:251], v[204:207], v[36:39], v[248:251]
    v_mfma_f32_16x16x32_bf16 v[252:255], v[204:207], v[92:95], v[252:255]
    s_waitcnt lgkmcnt(7)
    v_mfma_f32_16x16x32_bf16 v[248:251], v[208:211], v[40:43], v[248:251]
    v_mfma_f32_16x16x32_bf16 v[252:255], v[208:211], v[96:99], v[252:255]
    s_waitcnt lgkmcnt(6)
    v_mfma_f32_16x16x32_bf16 v[248:251], v[212:215], v[44:47], v[248:251]
    v_mfma_f32_16x16x32_bf16 v[252:255], v[212:215], v[100:103], v[252:255]
    s_waitcnt lgkmcnt(5)
    v_mfma_f32_16x16x32_bf16 v[248:251], v[216:219], v[48:51], v[248:251]
    v_mfma_f32_16x16x32_bf16 v[252:255], v[216:219], v[104:107], v[252:255]
    s_waitcnt lgkmcnt(4)
    v_mfma_f32_16x16x32_bf16 v[248:251], v[220:223], v[52:55], v[248:251]
    v_mfma_f32_16x16x32_bf16 v[252:255], v[220:223], v[108:111], v[252:255]
    s_waitcnt lgkmcnt(3)
    v_mfma_f32_16x16x32_bf16 v[248:251], v[224:227], v[56:59], v[248:251]
    v_mfma_f32_16x16x32_bf16 v[252:255], v[224:227], v[112:115], v[252:255]
    s_waitcnt lgkmcnt(2)
    v_mfma_f32_16x16x32_bf16 v[248:251], v[228:231], v[60:63], v[248:251]
    v_mfma_f32_16x16x32_bf16 v[252:255], v[228:231], v[116:119], v[252:255]
    s_waitcnt lgkmcnt(1)
    v_mfma_f32_16x16x32_bf16 v[248:251], v[232:235], v[64:67], v[248:251]
    v_mfma_f32_16x16x32_bf16 v[252:255], v[232:235], v[120:123], v[252:255]
    s_waitcnt lgkmcnt(0)
    v_mfma_f32_16x16x32_bf16 v[248:251], v[236:239], v[68:71], v[248:251]
    v_mfma_f32_16x16x32_bf16 v[252:255], v[236:239], v[124:127], v[252:255]
    s_nop 7
    v_cvt_pk_bf16_f32 v128, v240, v241
    v_cvt_pk_bf16_f32 v129, v242, v243
    v_cvt_pk_bf16_f32 v130, v248, v249
    v_cvt_pk_bf16_f32 v131, v250, v251
    v_cvt_pk_bf16_f32 v132, v244, v245
    v_cvt_pk_bf16_f32 v133, v246, v247
    v_cvt_pk_bf16_f32 v134, v252, v253
    v_cvt_pk_bf16_f32 v135, v254, v255
    s_waitcnt vmcnt(7)
    v_accvgpr_write_b32 a88, v128
    v_accvgpr_write_b32 a89, v129
    v_accvgpr_write_b32 a90, v130
    v_accvgpr_write_b32 a91, v131
    v_accvgpr_write_b32 a92, v132
    v_accvgpr_write_b32 a93, v133
    v_accvgpr_write_b32 a94, v134
    v_accvgpr_write_b32 a95, v135
    v_mfma_f32_16x16x32_bf16 a[0:3], a[24:27], v[128:131], a[0:3]
    v_mfma_f32_16x16x32_bf16 a[4:7], a[24:27], v[132:135], a[4:7]
    v_mfma_f32_16x16x32_bf16 a[8:11], a[28:31], v[128:131], a[8:11]
    v_mfma_f32_16x16x32_bf16 a[12:15], a[28:31], v[132:135], a[12:15]
    s_add_u32 s7, s7, 28672
    s_cmp_ge_u32 s7, 86016
    s_cselect_b32 s28, 86016, 0
    s_sub_u32 s7, s7, s28
    s_add_u32 s6, s6, 1
    s_add_u32 s26, s6, 1
    s_cmp_lt_u32 s26, 14
    s_cbranch_scc1 wp6_w7
    s_waitcnt vmcnt(0)
    s_branch wp6_w
    wp6_w7:
    s_waitcnt vmcnt(7)
    wp6_w:
wp7_loop:
    s_barrier
    s_mov_b32 s31, 7168
    buffer_load_dwordx4 a[24:27], v7, s[16:19], s31 offen
    s_mov_b32 s31, 21504
    buffer_load_dwordx4 a[28:31], v7, s[16:19], s31 offen
    s_add_u32 s27, s7, 57344
    s_cmp_ge_u32 s27, 86016
    s_cselect_b32 s28, 86016, 0
    s_sub_u32 s27, s27, s28
    s_add_u32 s26, s6, 2
    s_cmp_lt_u32 s26, 14
    s_cbranch_scc0 wp7_nodma
    s_mul_i32 s23, s26, 28672
    s_add_u32 s23, s23, s29
    s_add_u32 s23, s23, s30
    s_add_u32 s24, s27, s30
    s_add_u32 m0, s24, 0
    s_add_u32 s25, s23, 0
    buffer_load_dwordx4 v6, s[12:15], s25 offen lds
    s_add_u32 m0, s24, 1024
    s_add_u32 s25, s23, 1024
    buffer_load_dwordx4 v6, s[12:15], s25 offen lds
    s_add_u32 m0, s24, 2048
    s_add_u32 s25, s23, 2048
    buffer_load_dwordx4 v6, s[12:15], s25 offen lds
    s_add_u32 m0, s24, 3072
    s_add_u32 s25, s23, 3072
    buffer_load_dwordx4 v6, s[12:15], s25 offen lds
    s_add_u32 m0, s24, 4096
    s_add_u32 s25, s23, 4096
    buffer_load_dwordx4 v6, s[12:15], s25 offen lds
    s_add_u32 m0, s24, 5120
    s_add_u32 s25, s23, 5120
    buffer_load_dwordx4 v6, s[12:15], s25 offen lds
    s_add_u32 m0, s24, 6144
    s_add_u32 s25, s23, 6144
    buffer_load_dwordx4 v6, s[12:15], s25 offen lds
wp7_nodma:
    v_add_u32 v10, s7, v9
    ds_read_b128 v[128:131], v10 offset:0
    ds_read_b128 v[132:135], v10 offset:1024
    ds_read_b128 v[136:139], v10 offset:2048
    ds_read_b128 v[140:143], v10 offset:3072
    ds_read_b128 v[144:147], v10 offset:4096
    ds_read_b128 v[148:151], v10 offset:5120
    ds_read_b128 v[152:155], v10 offset:6144
    ds_read_b128 v[156:159], v10 offset:7168
    ds_read_b128 v[160:163], v10 offset:8192
    ds_read_b128 v[164:167], v10 offset:9216
    ds_read_b128 v[168:171], v10 offset:10240
    ds_read_b128 v[172:175], v10 offset:11264
    ds_read_b128 v[176:179], v10 offset:12288
    ds_read_b128 v[180:183], v10 offset:13312
    ds_read_b128 v[184:187], v10 offset:14336
    s_waitcnt lgkmcnt(14)
    v_mfma_f32_16x16x32_bf16 v[240:243], v[128:131], v[16:19], 0
    v_mfma_f32_16x16x32_bf16 v[244:247], v[128:131], v[72:75], 0
    ds_read_b128 v[188:191], v10 offset:15360
    s_waitcnt lgkmcnt(14)
    v_mfma_f32_16x16x32_bf16 v[240:243], v[132:135], v[20:23], v[240:243]
    v_mfma_f32_16x16x32_bf16 v[244:247], v[132:135], v[76:79], v[244:247]
    ds_read_b128 v[192:195], v10 offset:16384
    s_waitcnt lgkmcnt(14)
    v_mfma_f32_16x16x32_bf16 v[240:243], v[136:139], v[24:27], v[240:243]
    v_mfma_f32_16x16x32_bf16 v[244:247], v[136:139], v[80:83], v[244:247]
    ds_read_b128 v[196:199], v10 offset:17408
    s_waitcnt lgkmcnt(14)
    v_mfma_f32_16x16x32_bf16 v[240:243], v[140:143], v[28:31], v[240:243]
    v_mfma_f32_16x16x32_bf16 v[244:247], v[140:143], v[84:87], v[244:247]
    ds_read_b128 v[200:203], v10 offset:18432
    s_waitcnt lgkmcnt(14)
    v_mfma_f32_16x16x32_bf16 v[240:243], v[144:147], v[32:35], v[240:243]
    v_mfma_f32_16x16x32_bf16 v[244:247], v[144:147], v[88:91], v[244:247]
    ds_read_b128 v[204:207], v10 offset:19456
    s_waitcnt lgkmcnt(14)
    v_mfma_f32_16x16x32_bf16 v[240:243], v[148:151], v[36:39], v[240:243]
    v_mfma_f32_16x16x32_bf16 v[244:247], v[148:151], v[92:95], v[244:247]
    ds_read_b128 v[208:211], v10 offset:20480
    s_waitcnt lgkmcnt(14)
    v_mfma_f32_16x16x32_bf16 v[240:243], v[152:155], v[40:43], v[240:243]
    v_mfma_f32_16x16x32_bf16 v[244:247], v[152:155], v[96:99], v[244:247]
    ds_read_b128 v[212:215], v10 offset:21504
    s_waitcnt lgkmcnt(14)
    v_mfma_f32_16x16x32_bf16 v[240:243], v[156:159], v[44:47], v[240:243]
    v_mfma_f32_16x16x32_bf16 v[244:247], v[156:159], v[100:103], v[244:247]
    ds_read_b128 v[216:219], v10 offset:22528
    s_waitcnt lgkmcnt(14)
    v_mfma_f32_16x16x32_bf16 v[240:243], v[160:163], v[48:51], v[240:243]
    v_mfma_f32_16x16x32_bf16 v[244:247], v[160:163], v[104:107], v[244:247]
    ds_read_b128 v[220:223], v10 offset:23552
    s_waitcnt lgkmcnt(14)
    v_mfma_f32_16x16x32_bf16 v[240:243], v[164:167], v[52:55], v[240:243]
    v_mfma_f32_16x16x32_bf16 v[244:247], v[164:167], v[108:111], v[244:247]
    ds_read_b128 v[224:227], v10 offset:24576
    s_waitcnt lgkmcnt(14)
    v_mfma_f32_16x16x32_bf16 v[240:243], v[168:171], v[56:59], v[240:243]
    v_mfma_f32_16x16x32_bf16 v[244:247], v[168:171], v[112:115], v[244:247]
    ds_read_b128 v[228:231], v10 offset:25600
    s_waitcnt lgkmcnt(14)
    v_mfma_f32_16x16x32_bf16 v[240:243], v[172:175], v[60:63], v[240:243]
    v_mfma_f32_16x16x32_bf16 v[244:247], v[172:175], v[116:119], v[244:247]
    ds_read_b128 v[232:235], v10 offset:26624
    s_waitcnt lgkmcnt(14)
    v_mfma_f32_16x16x32_bf16 v[240:243], v[176:179], v[64:67], v[240:243]
    v_mfma_f32_16x16x32_bf16 v[244:247], v[176:179], v[120:123], v[244:247]
    ds_read_b128 v[236:239], v10 offset:27648
    s_waitcnt lgkmcnt(14)
    v_mfma_f32_16x16x32_bf16 v[240:243], v[180:183], v[68:71], v[240:243]
    v_mfma_f32_16x16x32_bf16 v[244:247], v[180:183], v[124:127], v[244:247]
    s_waitcnt lgkmcnt(13)
    v_mfma_f32_16x16x32_bf16 v[248:251], v[184:187], v[16:19], 0
    v_mfma_f32_16x16x32_bf16 v[252:255], v[184:187], v[72:75], 0
    s_waitcnt lgkmcnt(12)
    v_mfma_f32_16x16x32_bf16 v[248:251], v[188:191], v[20:23], v[248:251]
    v_mfma_f32_16x16x32_bf16 v[252:255], v[188:191], v[76:79], v[252:255]
    s_waitcnt lgkmcnt(11)
    v_mfma_f32_16x16x32_bf16 v[248:251], v[192:195], v[24:27], v[248:251]
    v_mfma_f32_16x16x32_bf16 v[252:255], v[192:195], v[80:83], v[252:255]
    s_waitcnt lgkmcnt(10)
    v_mfma_f32_16x16x32_bf16 v[248:251], v[196:199], v[28:31], v[248:251]
    v_mfma_f32_16x16x32_bf16 v[252:255], v[196:199], v[84:87], v[252:255]
    s_waitcnt lgkmcnt(9)
    v_mfma_f32_16x16x32_bf16 v[248:251], v[200:203], v[32:35], v[248:251]
    v_mfma_f32_16x16x32_bf16 v[252:255], v[200:203], v[88:91], v[252:255]
    s_waitcnt lgkmcnt(8)
    v_mfma_f32_16x16x32_bf16 v[248:251], v[204:207], v[36:39], v[248:251]
    v_mfma_f32_16x16x32_bf16 v[252:255], v[204:207], v[92:95], v[252:255]
    s_waitcnt lgkmcnt(7)
    v_mfma_f32_16x16x32_bf16 v[248:251], v[208:211], v[40:43], v[248:251]
    v_mfma_f32_16x16x32_bf16 v[252:255], v[208:211], v[96:99], v[252:255]
    s_waitcnt lgkmcnt(6)
    v_mfma_f32_16x16x32_bf16 v[248:251], v[212:215], v[44:47], v[248:251]
    v_mfma_f32_16x16x32_bf16 v[252:255], v[212:215], v[100:103], v[252:255]
    s_waitcnt lgkmcnt(5)
    v_mfma_f32_16x16x32_bf16 v[248:251], v[216:219], v[48:51], v[248:251]
    v_mfma_f32_16x16x32_bf16 v[252:255], v[216:219], v[104:107], v[252:255]
    s_waitcnt lgkmcnt(4)
    v_mfma_f32_16x16x32_bf16 v[248:251], v[220:223], v[52:55], v[248:251]
    v_mfma_f32_16x16x32_bf16 v[252:255], v[220:223], v[108:111], v[252:255]
    s_waitcnt lgkmcnt(3)
    v_mfma_f32_16x16x32_bf16 v[248:251], v[224:227], v[56:59], v[248:251]
    v_mfma_f32_16x16x32_bf16 v[252:255], v[224:227], v[112:115], v[252:255]
    s_waitcnt lgkmcnt(2)
    v_mfma_f32_16x16x32_bf16 v[248:251], v[228:231], v[60:63], v[248:251]
    v_mfma_f32_16x16x32_bf16 v[252:255], v[228:231], v[116:119], v[252:255]
    s_waitcnt lgkmcnt(1)
    v_mfma_f32_16x16x32_bf16 v[248:251], v[232:235], v[64:67], v[248:251]
    v_mfma_f32_16x16x32_bf16 v[252:255], v[232:235], v[120:123], v[252:255]
    s_waitcnt lgkmcnt(0)
    v_mfma_f32_16x16x32_bf16 v[248:251], v[236:239], v[68:71], v[248:251]
    v_mfma_f32_16x16x32_bf16 v[252:255], v[236:239], v[124:127], v[252:255]
    s_nop 7
    v_cvt_pk_bf16_f32 v128, v240, v241
    v_cvt_pk_bf16_f32 v129, v242, v243
    v_cvt_pk_bf16_f32 v130, v248, v249
    v_cvt_pk_bf16_f32 v131, v250, v251
    v_cvt_pk_bf16_f32 v132, v244, v245
    v_cvt_pk_bf16_f32 v133, v246, v247
    v_cvt_pk_bf16_f32 v134, v252, v253
    v_cvt_pk_bf16_f32 v135, v254, v255
    s_waitcnt vmcnt(7)
    v_accvgpr_write_b32 a96, v128
    v_accvgpr_write_b32 a97, v129
    v_accvgpr_write_b32 a98, v130
    v_accvgpr_write_b32 a99, v131
    v_accvgpr_write_b32 a100, v132
    v_accvgpr_write_b32 a101, v133
    v_accvgpr_write_b32 a102, v134
    v_accvgpr_write_b32 a103, v135
    v_mfma_f32_16x16x32_bf16 a[0:3], a[24:27], v[128:131], a[0:3]
    v_mfma_f32_16x16x32_bf16 a[4:7], a[24:27], v[132:135], a[4:7]
    v_mfma_f32_16x16x32_bf16 a[8:11], a[28:31], v[128:131], a[8:11]
    v_mfma_f32_16x16x32_bf16 a[12:15], a[28:31], v[132:135], a[12:15]
    s_add_u32 s7, s7, 28672
    s_cmp_ge_u32 s7, 86016
    s_cselect_b32 s28, 86016, 0
    s_sub_u32 s7, s7, s28
    s_add_u32 s6, s6, 1
    s_add_u32 s26, s6, 1
    s_cmp_lt_u32 s26, 14
    s_cbranch_scc1 wp7_w7
    s_waitcnt vmcnt(0)
    s_branch wp7_w
    wp7_w7:
    s_waitcnt vmcnt(7)
    wp7_w:
wp8_loop:
    s_barrier
    s_mov_b32 s31, 8192
    buffer_load_dwordx4 a[24:27], v7, s[16:19], s31 offen
    s_mov_b32 s31, 22528
    buffer_load_dwordx4 a[28:31], v7, s[16:19], s31 offen
    s_add_u32 s27, s7, 57344
    s_cmp_ge_u32 s27, 86016
    s_cselect_b32 s28, 86016, 0
    s_sub_u32 s27, s27, s28
    s_add_u32 s26, s6, 2
    s_cmp_lt_u32 s26, 14
    s_cbranch_scc0 wp8_nodma
    s_mul_i32 s23, s26, 28672
    s_add_u32 s23, s23, s29
    s_add_u32 s23, s23, s30
    s_add_u32 s24, s27, s30
    s_add_u32 m0, s24, 0
    s_add_u32 s25, s23, 0
    buffer_load_dwordx4 v6, s[12:15], s25 offen lds
    s_add_u32 m0, s24, 1024
    s_add_u32 s25, s23, 1024
    buffer_load_dwordx4 v6, s[12:15], s25 offen lds
    s_add_u32 m0, s24, 2048
    s_add_u32 s25, s23, 2048
    buffer_load_dwordx4 v6, s[12:15], s25 offen lds
    s_add_u32 m0, s24, 3072
    s_add_u32 s25, s23, 3072
    buffer_load_dwordx4 v6, s[12:15], s25 offen lds
    s_add_u32 m0, s24, 4096
    s_add_u32 s25, s23, 4096
    buffer_load_dwordx4 v6, s[12:15], s25 offen lds
    s_add_u32 m0, s24, 5120
    s_add_u32 s25, s23, 5120
    buffer_load_dwordx4 v6, s[12:15], s25 offen lds
    s_add_u32 m0, s24, 6144
    s_add_u32 s25, s23, 6144
    buffer_load_dwordx4 v6, s[12:15], s25 offen lds
wp8_nodma:
    v_add_u32 v10, s7, v9
    ds_read_b128 v[128:131], v10 offset:0
    ds_read_b128 v[132:135], v10 offset:1024
    ds_read_b128 v[136:139], v10 offset:2048
    ds_read_b128 v[140:143], v10 offset:3072
    ds_read_b128 v[144:147], v10 offset:4096
    ds_read_b128 v[148:151], v10 offset:5120
    ds_read_b128 v[152:155], v10 offset:6144
    ds_read_b128 v[156:159], v10 offset:7168
    ds_read_b128 v[160:163], v10 offset:8192
    ds_read_b128 v[164:167], v10 offset:9216
    ds_read_b128 v[168:171], v10 offset:10240
    ds_read_b128 v[172:175], v10 offset:11264
    ds_read_b128 v[176:179], v10 offset:12288
    ds_read_b128 v[180:183], v10 offset:13312
    ds_read_b128 v[184:187], v10 offset:14336
    s_waitcnt lgkmcnt(14)
    v_mfma_f32_16x16x32_bf16 v[240:243], v[128:131], v[16:19], 0
    v_mfma_f32_16x16x32_bf16 v[244:247], v[128:131], v[72:75], 0
    ds_read_b128 v[188:191], v10 offset:15360
    s_waitcnt lgkmcnt(14)
    v_mfma_f32_16x16x32_bf16 v[240:243], v[132:135], v[20:23], v[240:243]
    v_mfma_f32_16x16x32_bf16 v[244:247], v[132:135], v[76:79], v[244:247]
    ds_read_b128 v[192:195], v10 offset:16384
    s_waitcnt lgkmcnt(14)
    v_mfma_f32_16x16x32_bf16 v[240:243], v[136:139], v[24:27], v[240:243]
    v_mfma_f32_16x16x32_bf16 v[244:247], v[136:139], v[80:83], v[244:247]
    ds_read_b128 v[196:199], v10 offset:17408
    s_waitcnt lgkmcnt(14)
    v_mfma_f32_16x16x32_bf16 v[240:243], v[140:143], v[28:31], v[240:243]
    v_mfma_f32_16x16x32_bf16 v[244:247], v[140:143], v[84:87], v[244:247]
    ds_read_b128 v[200:203], v10 offset:18432
    s_waitcnt lgkmcnt(14)
    v_mfma_f32_16x16x32_bf16 v[240:243], v[144:147], v[32:35], v[240:243]
    v_mfma_f32_16x16x32_bf16 v[244:247], v[144:147], v[88:91], v[244:247]
    ds_read_b128 v[204:207], v10 offset:19456
    s_waitcnt lgkmcnt(14)
    v_mfma_f32_16x16x32_bf16 v[240:243], v[148:151], v[36:39], v[240:243]
    v_mfma_f32_16x16x32_bf16 v[244:247], v[148:151], v[92:95], v[244:247]
    ds_read_b128 v[208:211], v10 offset:20480
    s_waitcnt lgkmcnt(14)
    v_mfma_f32_16x16x32_bf16 v[240:243], v[152:155], v[40:43], v[240:243]
    v_mfma_f32_16x16x32_bf16 v[244:247], v[152:155], v[96:99], v[244:247]
    ds_read_b128 v[212:215], v10 offset:21504
    s_waitcnt lgkmcnt(14)
    v_mfma_f32_16x16x32_bf16 v[240:243], v[156:159], v[44:47], v[240:243]
    v_mfma_f32_16x16x32_bf16 v[244:247], v[156:159], v[100:103], v[244:247]
    ds_read_b128 v[216:219], v10 offset:22528
    s_waitcnt lgkmcnt(14)
    v_mfma_f32_16x16x32_bf16 v[240:243], v[160:163], v[48:51], v[240:243]
    v_mfma_f32_16x16x32_bf16 v[244:247], v[160:163], v[104:107], v[244:247]
    ds_read_b128 v[220:223], v10 offset:23552
    s_waitcnt lgkmcnt(14)
    v_mfma_f32_16x16x32_bf16 v[240:243], v[164:167], v[52:55], v[240:243]
    v_mfma_f32_16x16x32_bf16 v[244:247], v[164:167], v[108:111], v[244:247]
    ds_read_b128 v[224:227], v10 offset:24576
    s_waitcnt lgkmcnt(14)
    v_mfma_f32_16x16x32_bf16 v[240:243], v[168:171], v[56:59], v[240:243]
    v_mfma_f32_16x16x32_bf16 v[244:247], v[168:171], v[112:115], v[244:247]
    ds_read_b128 v[228:231], v10 offset:25600
    s_waitcnt lgkmcnt(14)
    v_mfma_f32_16x16x32_bf16 v[240:243], v[172:175], v[60:63], v[240:243]
    v_mfma_f32_16x16x32_bf16 v[244:247], v[172:175], v[116:119], v[244:247]
    ds_read_b128 v[232:235], v10 offset:26624
    s_waitcnt lgkmcnt(14)
    v_mfma_f32_16x16x32_bf16 v[240:243], v[176:179], v[64:67], v[240:243]
    v_mfma_f32_16x16x32_bf16 v[244:247], v[176:179], v[120:123], v[244:247]
    ds_read_b128 v[236:239], v10 offset:27648
    s_waitcnt lgkmcnt(14)
    v_mfma_f32_16x16x32_bf16 v[240:243], v[180:183], v[68:71], v[240:243]
    v_mfma_f32_16x16x32_bf16 v[244:247], v[180:183], v[124:127], v[244:247]
    s_waitcnt lgkmcnt(13)
    v_mfma_f32_16x16x32_bf16 v[248:251], v[184:187], v[16:19], 0
    v_mfma_f32_16x16x32_bf16 v[252:255], v[184:187], v[72:75], 0
    s_waitcnt lgkmcnt(12)
    v_mfma_f32_16x16x32_bf16 v[248:251], v[188:191], v[20:23], v[248:251]
    v_mfma_f32_16x16x32_bf16 v[252:255], v[188:191], v[76:79], v[252:255]
    s_waitcnt lgkmcnt(11)
    v_mfma_f32_16x16x32_bf16 v[248:251], v[192:195], v[24:27], v[248:251]
    v_mfma_f32_16x16x32_bf16 v[252:255], v[192:195], v[80:83], v[252:255]
    s_waitcnt lgkmcnt(10)
    v_mfma_f32_16x16x32_bf16 v[248:251], v[196:199], v[28:31], v[248:251]
    v_mfma_f32_16x16x32_bf16 v[252:255], v[196:199], v[84:87], v[252:255]
    s_waitcnt lgkmcnt(9)
    v_mfma_f32_16x16x32_bf16 v[248:251], v[200:203], v[32:35], v[248:251]
    v_mfma_f32_16x16x32_bf16 v[252:255], v[200:203], v[88:91], v[252:255]
    s_waitcnt lgkmcnt(8)
    v_mfma_f32_16x16x32_bf16 v[248:251], v[204:207], v[36:39], v[248:251]
    v_mfma_f32_16x16x32_bf16 v[252:255], v[204:207], v[92:95], v[252:255]
    s_waitcnt lgkmcnt(7)
    v_mfma_f32_16x16x32_bf16 v[248:251], v[208:211], v[40:43], v[248:251]
    v_mfma_f32_16x16x32_bf16 v[252:255], v[208:211], v[96:99], v[252:255]
    s_waitcnt lgkmcnt(6)
    v_mfma_f32_16x16x32_bf16 v[248:251], v[212:215], v[44:47], v[248:251]
    v_mfma_f32_16x16x32_bf16 v[252:255], v[212:215], v[100:103], v[252:255]
    s_waitcnt lgkmcnt(5)
    v_mfma_f32_16x16x32_bf16 v[248:251], v[216:219], v[48:51], v[248:251]
    v_mfma_f32_16x16x32_bf16 v[252:255], v[216:219], v[104:107], v[252:255]
    s_waitcnt lgkmcnt(4)
    v_mfma_f32_16x16x32_bf16 v[248:251], v[220:223], v[52:55], v[248:251]
    v_mfma_f32_16x16x32_bf16 v[252:255], v[220:223], v[108:111], v[252:255]
    s_waitcnt lgkmcnt(3)
    v_mfma_f32_16x16x32_bf16 v[248:251], v[224:227], v[56:59], v[248:251]
    v_mfma_f32_16x16x32_bf16 v[252:255], v[224:227], v[112:115], v[252:255]
    s_waitcnt lgkmcnt(2)
    v_mfma_f32_16x16x32_bf16 v[248:251], v[228:231], v[60:63], v[248:251]
    v_mfma_f32_16x16x32_bf16 v[252:255], v[228:231], v[116:119], v[252:255]
    s_waitcnt lgkmcnt(1)
    v_mfma_f32_16x16x32_bf16 v[248:251], v[232:235], v[64:67], v[248:251]
    v_mfma_f32_16x16x32_bf16 v[252:255], v[232:235], v[120:123], v[252:255]
    s_waitcnt lgkmcnt(0)
    v_mfma_f32_16x16x32_bf16 v[248:251], v[236:239], v[68:71], v[248:251]
    v_mfma_f32_16x16x32_bf16 v[252:255], v[236:239], v[124:127], v[252:255]
    s_nop 7
    v_cvt_pk_bf16_f32 v128, v240, v241
    v_cvt_pk_bf16_f32 v129, v242, v243
    v_cvt_pk_bf16_f32 v130, v248, v249
    v_cvt_pk_bf16_f32 v131, v250, v251
    v_cvt_pk_bf16_f32 v132, v244, v245
    v_cvt_pk_bf16_f32 v133, v246, v247
    v_cvt_pk_bf16_f32 v134, v252, v253
    v_cvt_pk_bf16_f32 v135, v254, v255
    s_waitcnt vmcnt(7)
    v_accvgpr_write_b32 a104, v128
    v_accvgpr_write_b32 a105, v129
    v_accvgpr_write_b32 a106, v130
    v_accvgpr_write_b32 a107, v131
    v_accvgpr_write_b32 a108, v132
    v_accvgpr_write_b32 a109, v133
    v_accvgpr_write_b32 a110, v134
    v_accvgpr_write_b32 a111, v135
    v_mfma_f32_16x16x32_bf16 a[0:3], a[24:27], v[128:131], a[0:3]
    v_mfma_f32_16x16x32_bf16 a[4:7], a[24:27], v[132:135], a[4:7]
    v_mfma_f32_16x16x32_bf16 a[8:11], a[28:31], v[128:131], a[8:11]
    v_mfma_f32_16x16x32_bf16 a[12:15], a[28:31], v[132:135], a[12:15]
    s_add_u32 s7, s7, 28672
    s_cmp_ge_u32 s7, 86016
    s_cselect_b32 s28, 86016, 0
    s_sub_u32 s7, s7, s28
    s_add_u32 s6, s6, 1
    s_add_u32 s26, s6, 1
    s_cmp_lt_u32 s26, 14
    s_cbranch_scc1 wp8_w7
    s_waitcnt vmcnt(0)
    s_branch wp8_w
    wp8_w7:
    s_waitcnt vmcnt(7)
    wp8_w:
wp9_loop:
    s_barrier
    s_mov_b32 s31, 9216
    buffer_load_dwordx4 a[24:27], v7, s[16:19], s31 offen
    s_mov_b32 s31, 23552
    buffer_load_dwordx4 a[28:31], v7, s[16:19], s31 offen
    s_add_u32 s27, s7, 57344
    s_cmp_ge_u32 s27, 86016
    s_cselect_b32 s28, 86016, 0
    s_sub_u32 s27, s27, s28
    s_add_u32 s26, s6, 2
    s_cmp_lt_u32 s26, 14
    s_cbranch_scc0 wp9_nodma
    s_mul_i32 s23, s26, 28672
    s_add_u32 s23, s23, s29
    s_add_u32 s23, s23, s30
    s_add_u32 s24, s27, s30
    s_add_u32 m0, s24, 0
    s_add_u32 s25, s23, 0
    buffer_load_dwordx4 v6, s[12:15], s25 offen lds
    s_add_u32 m0, s24, 1024
    s_add_u32 s25, s23, 1024
    buffer_load_dwordx4 v6, s[12:15], s25 offen lds
    s_add_u32 m0, s24, 2048
    s_add_u32 s25, s23, 2048
    buffer_load_dwordx4 v6, s[12:15], s25 offen lds
    s_add_u32 m0, s24, 3072
    s_add_u32 s25, s23, 3072
    buffer_load_dwordx4 v6, s[12:15], s25 offen lds
    s_add_u32 m0, s24, 4096
    s_add_u32 s25, s23, 4096
    buffer_load_dwordx4 v6, s[12:15], s25 offen lds
    s_add_u32 m0, s24, 5120
    s_add_u32 s25, s23, 5120
    buffer_load_dwordx4 v6, s[12:15], s25 offen lds
    s_add_u32 m0, s24, 6144
    s_add_u32 s25, s23, 6144
    buffer_load_dwordx4 v6, s[12:15], s25 offen lds
wp9_nodma:
    v_add_u32 v10, s7, v9
    ds_read_b128 v[128:131], v10 offset:0
    ds_read_b128 v[132:135], v10 offset:1024
    ds_read_b128 v[136:139], v10 offset:2048
    ds_read_b128 v[140:143], v10 offset:3072
    ds_read_b128 v[144:147], v10 offset:4096
    ds_read_b128 v[148:151], v10 offset:5120
    ds_read_b128 v[152:155], v10 offset:6144
    ds_read_b128 v[156:159], v10 offset:7168
    ds_read_b128 v[160:163], v10 offset:8192
    ds_read_b128 v[164:167], v10 offset:9216
    ds_read_b128 v[168:171], v10 offset:10240
    ds_read_b128 v[172:175], v10 offset:11264
    ds_read_b128 v[176:179], v10 offset:12288
    ds_read_b128 v[180:183], v10 offset:13312
    ds_read_b128 v[184:187], v10 offset:14336
    s_waitcnt lgkmcnt(14)
    v_mfma_f32_16x16x32_bf16 v[240:243], v[128:131], v[16:19], 0
    v_mfma_f32_16x16x32_bf16 v[244:247], v[128:131], v[72:75], 0
    ds_read_b128 v[188:191], v10 offset:15360
    s_waitcnt lgkmcnt(14)
    v_mfma_f32_16x16x32_bf16 v[240:243], v[132:135], v[20:23], v[240:243]
    v_mfma_f32_16x16x32_bf16 v[244:247], v[132:135], v[76:79], v[244:247]
    ds_read_b128 v[192:195], v10 offset:16384
    s_waitcnt lgkmcnt(14)
    v_mfma_f32_16x16x32_bf16 v[240:243], v[136:139], v[24:27], v[240:243]
    v_mfma_f32_16x16x32_bf16 v[244:247], v[136:139], v[80:83], v[244:247]
    ds_read_b128 v[196:199], v10 offset:17408
    s_waitcnt lgkmcnt(14)
    v_mfma_f32_16x16x32_bf16 v[240:243], v[140:143], v[28:31], v[240:243]
    v_mfma_f32_16x16x32_bf16 v[244:247], v[140:143], v[84:87], v[244:247]
    ds_read_b128 v[200:203], v10 offset:18432
    s_waitcnt lgkmcnt(14)
    v_mfma_f32_16x16x32_bf16 v[240:243], v[144:147], v[32:35], v[240:243]
    v_mfma_f32_16x16x32_bf16 v[244:247], v[144:147], v[88:91], v[244:247]
    ds_read_b128 v[204:207], v10 offset:19456
    s_waitcnt lgkmcnt(14)
    v_mfma_f32_16x16x32_bf16 v[240:243], v[148:151], v[36:39], v[240:243]
    v_mfma_f32_16x16x32_bf16 v[244:247], v[148:151], v[92:95], v[244:247]
    ds_read_b128 v[208:211], v10 offset:20480
    s_waitcnt lgkmcnt(14)
    v_mfma_f32_16x16x32_bf16 v[240:243], v[152:155], v[40:43], v[240:243]
    v_mfma_f32_16x16x32_bf16 v[244:247], v[152:155], v[96:99], v[244:247]
    ds_read_b128 v[212:215], v10 offset:21504
    s_waitcnt lgkmcnt(14)
    v_mfma_f32_16x16x32_bf16 v[240:243], v[156:159], v[44:47], v[240:243]
    v_mfma_f32_16x16x32_bf16 v[244:247], v[156:159], v[100:103], v[244:247]
    ds_read_b128 v[216:219], v10 offset:22528
    s_waitcnt lgkmcnt(14)
    v_mfma_f32_16x16x32_bf16 v[240:243], v[160:163], v[48:51], v[240:243]
    v_mfma_f32_16x16x32_bf16 v[244:247], v[160:163], v[104:107], v[244:247]
    ds_read_b128 v[220:223], v10 offset:23552
    s_waitcnt lgkmcnt(14)
    v_mfma_f32_16x16x32_bf16 v[240:243], v[164:167], v[52:55], v[240:243]
    v_mfma_f32_16x16x32_bf16 v[244:247], v[164:167], v[108:111], v[244:247]
    ds_read_b128 v[224:227], v10 offset:24576
    s_waitcnt lgkmcnt(14)
    v_mfma_f32_16x16x32_bf16 v[240:243], v[168:171], v[56:59], v[240:243]
    v_mfma_f32_16x16x32_bf16 v[244:247], v[168:171], v[112:115], v[244:247]
    ds_read_b128 v[228:231], v10 offset:25600
    s_waitcnt lgkmcnt(14)
    v_mfma_f32_16x16x32_bf16 v[240:243], v[172:175], v[60:63], v[240:243]
    v_mfma_f32_16x16x32_bf16 v[244:247], v[172:175], v[116:119], v[244:247]
    ds_read_b128 v[232:235], v10 offset:26624
    s_waitcnt lgkmcnt(14)
    v_mfma_f32_16x16x32_bf16 v[240:243], v[176:179], v[64:67], v[240:243]
    v_mfma_f32_16x16x32_bf16 v[244:247], v[176:179], v[120:123], v[244:247]
    ds_read_b128 v[236:239], v10 offset:27648
    s_waitcnt lgkmcnt(14)
    v_mfma_f32_16x16x32_bf16 v[240:243], v[180:183], v[68:71], v[240:243]
    v_mfma_f32_16x16x32_bf16 v[244:247], v[180:183], v[124:127], v[244:247]
    s_waitcnt lgkmcnt(13)
    v_mfma_f32_16x16x32_bf16 v[248:251], v[184:187], v[16:19], 0
    v_mfma_f32_16x16x32_bf16 v[252:255], v[184:187], v[72:75], 0
    s_waitcnt lgkmcnt(12)
    v_mfma_f32_16x16x32_bf16 v[248:251], v[188:191], v[20:23], v[248:251]
    v_mfma_f32_16x16x32_bf16 v[252:255], v[188:191], v[76:79], v[252:255]
    s_waitcnt lgkmcnt(11)
    v_mfma_f32_16x16x32_bf16 v[248:251], v[192:195], v[24:27], v[248:251]
    v_mfma_f32_16x16x32_bf16 v[252:255], v[192:195], v[80:83], v[252:255]
    s_waitcnt lgkmcnt(10)
    v_mfma_f32_16x16x32_bf16 v[248:251], v[196:199], v[28:31], v[248:251]
    v_mfma_f32_16x16x32_bf16 v[252:255], v[196:199], v[84:87], v[252:255]
    s_waitcnt lgkmcnt(9)
    v_mfma_f32_16x16x32_bf16 v[248:251], v[200:203], v[32:35], v[248:251]
    v_mfma_f32_16x16x32_bf16 v[252:255], v[200:203], v[88:91], v[252:255]
    s_waitcnt lgkmcnt(8)
    v_mfma_f32_16x16x32_bf16 v[248:251], v[204:207], v[36:39], v[248:251]
    v_mfma_f32_16x16x32_bf16 v[252:255], v[204:207], v[92:95], v[252:255]
    s_waitcnt lgkmcnt(7)
    v_mfma_f32_16x16x32_bf16 v[248:251], v[208:211], v[40:43], v[248:251]
    v_mfma_f32_16x16x32_bf16 v[252:255], v[208:211], v[96:99], v[252:255]
    s_waitcnt lgkmcnt(6)
    v_mfma_f32_16x16x32_bf16 v[248:251], v[212:215], v[44:47], v[248:251]
    v_mfma_f32_16x16x32_bf16 v[252:255], v[212:215], v[100:103], v[252:255]
    s_waitcnt lgkmcnt(5)
    v_mfma_f32_16x16x32_bf16 v[248:251], v[216:219], v[48:51], v[248:251]
    v_mfma_f32_16x16x32_bf16 v[252:255], v[216:219], v[104:107], v[252:255]
    s_waitcnt lgkmcnt(4)
    v_mfma_f32_16x16x32_bf16 v[248:251], v[220:223], v[52:55], v[248:251]
    v_mfma_f32_16x16x32_bf16 v[252:255], v[220:223], v[108:111], v[252:255]
    s_waitcnt lgkmcnt(3)
    v_mfma_f32_16x16x32_bf16 v[248:251], v[224:227], v[56:59], v[248:251]
    v_mfma_f32_16x16x32_bf16 v[252:255], v[224:227], v[112:115], v[252:255]
    s_waitcnt lgkmcnt(2)
    v_mfma_f32_16x16x32_bf16 v[248:251], v[228:231], v[60:63], v[248:251]
    v_mfma_f32_16x16x32_bf16 v[252:255], v[228:231], v[116:119], v[252:255]
    s_waitcnt lgkmcnt(1)
    v_mfma_f32_16x16x32_bf16 v[248:251], v[232:235], v[64:67], v[248:251]
    v_mfma_f32_16x16x32_bf16 v[252:255], v[232:235], v[120:123], v[252:255]
    s_waitcnt lgkmcnt(0)
    v_mfma_f32_16x16x32_bf16 v[248:251], v[236:239], v[68:71], v[248:251]
    v_mfma_f32_16x16x32_bf16 v[252:255], v[236:239], v[124:127], v[252:255]
    s_nop 7
    v_cvt_pk_bf16_f32 v128, v240, v241
    v_cvt_pk_bf16_f32 v129, v242, v243
    v_cvt_pk_bf16_f32 v130, v248, v249
    v_cvt_pk_bf16_f32 v131, v250, v251
    v_cvt_pk_bf16_f32 v132, v244, v245
    v_cvt_pk_bf16_f32 v133, v246, v247
    v_cvt_pk_bf16_f32 v134, v252, v253
    v_cvt_pk_bf16_f32 v135, v254, v255
    s_waitcnt vmcnt(7)
    v_accvgpr_write_b32 a112, v128
    v_accvgpr_write_b32 a113, v129
    v_accvgpr_write_b32 a114, v130
    v_accvgpr_write_b32 a115, v131
    v_accvgpr_write_b32 a116, v132
    v_accvgpr_write_b32 a117, v133
    v_accvgpr_write_b32 a118, v134
    v_accvgpr_write_b32 a119, v135
    v_mfma_f32_16x16x32_bf16 a[0:3], a[24:27], v[128:131], a[0:3]
    v_mfma_f32_16x16x32_bf16 a[4:7], a[24:27], v[132:135], a[4:7]
    v_mfma_f32_16x16x32_bf16 a[8:11], a[28:31], v[128:131], a[8:11]
    v_mfma_f32_16x16x32_bf16 a[12:15], a[28:31], v[132:135], a[12:15]
    s_add_u32 s7, s7, 28672
    s_cmp_ge_u32 s7, 86016
    s_cselect_b32 s28, 86016, 0
    s_sub_u32 s7, s7, s28
    s_add_u32 s6, s6, 1
    s_add_u32 s26, s6, 1
    s_cmp_lt_u32 s26, 14
    s_cbranch_scc1 wp9_w7
    s_waitcnt vmcnt(0)
    s_branch wp9_w
    wp9_w7:
    s_waitcnt vmcnt(7)
    wp9_w:
wp10_loop:
    s_barrier
    s_mov_b32 s31, 10240
    buffer_load_dwordx4 a[24:27], v7, s[16:19], s31 offen
    s_mov_b32 s31, 24576
    buffer_load_dwordx4 a[28:31], v7, s[16:19], s31 offen
    s_add_u32 s27, s7, 57344
    s_cmp_ge_u32 s27, 86016
    s_cselect_b32 s28, 86016, 0
    s_sub_u32 s27, s27, s28
    s_add_u32 s26, s6, 2
    s_cmp_lt_u32 s26, 14
    s_cbranch_scc0 wp10_nodma
    s_mul_i32 s23, s26, 28672
    s_add_u32 s23, s23, s29
    s_add_u32 s23, s23, s30
    s_add_u32 s24, s27, s30
    s_add_u32 m0, s24, 0
    s_add_u32 s25, s23, 0
    buffer_load_dwordx4 v6, s[12:15], s25 offen lds
    s_add_u32 m0, s24, 1024
    s_add_u32 s25, s23, 1024
    buffer_load_dwordx4 v6, s[12:15], s25 offen lds
    s_add_u32 m0, s24, 2048
    s_add_u32 s25, s23, 2048
    buffer_load_dwordx4 v6, s[12:15], s25 offen lds
    s_add_u32 m0, s24, 3072
    s_add_u32 s25, s23, 3072
    buffer_load_dwordx4 v6, s[12:15], s25 offen lds
    s_add_u32 m0, s24, 4096
    s_add_u32 s25, s23, 4096
    buffer_load_dwordx4 v6, s[12:15], s25 offen lds
    s_add_u32 m0, s24, 5120
    s_add_u32 s25, s23, 5120
    buffer_load_dwordx4 v6, s[12:15], s25 offen lds
    s_add_u32 m0, s24, 6144
    s_add_u32 s25, s23, 6144
    buffer_load_dwordx4 v6, s[12:15], s25 offen lds
wp10_nodma:
    v_add_u32 v10, s7, v9
    ds_read_b128 v[128:131], v10 offset:0
    ds_read_b128 v[132:135], v10 offset:1024
    ds_read_b128 v[136:139], v10 offset:2048
    ds_read_b128 v[140:143], v10 offset:3072
    ds_read_b128 v[144:147], v10 offset:4096
    ds_read_b128 v[148:151], v10 offset:5120
    ds_read_b128 v[152:155], v10 offset:6144
    ds_read_b128 v[156:159], v10 offset:7168
    ds_read_b128 v[160:163], v10 offset:8192
    ds_read_b128 v[164:167], v10 offset:9216
    ds_read_b128 v[168:171], v10 offset:10240
    ds_read_b128 v[172:175], v10 offset:11264
    ds_read_b128 v[176:179], v10 offset:12288
    ds_read_b128 v[180:183], v10 offset:13312
    ds_read_b128 v[184:187], v10 offset:14336
    s_waitcnt lgkmcnt(14)
    v_mfma_f32_16x16x32_bf16 v[240:243], v[128:131], v[16:19], 0
    v_mfma_f32_16x16x32_bf16 v[244:247], v[128:131], v[72:75], 0
    ds_read_b128 v[188:191], v10 offset:15360
    s_waitcnt lgkmcnt(14)
    v_mfma_f32_16x16x32_bf16 v[240:243], v[132:135], v[20:23], v[240:243]
    v_mfma_f32_16x16x32_bf16 v[244:247], v[132:135], v[76:79], v[244:247]
    ds_read_b128 v[192:195], v10 offset:16384
    s_waitcnt lgkmcnt(14)
    v_mfma_f32_16x16x32_bf16 v[240:243], v[136:139], v[24:27], v[240:243]
    v_mfma_f32_16x16x32_bf16 v[244:247], v[136:139], v[80:83], v[244:247]
    ds_read_b128 v[196:199], v10 offset:17408
    s_waitcnt lgkmcnt(14)
    v_mfma_f32_16x16x32_bf16 v[240:243], v[140:143], v[28:31], v[240:243]
    v_mfma_f32_16x16x32_bf16 v[244:247], v[140:143], v[84:87], v[244:247]
    ds_read_b128 v[200:203], v10 offset:18432
    s_waitcnt lgkmcnt(14)
    v_mfma_f32_16x16x32_bf16 v[240:243], v[144:147], v[32:35], v[240:243]
    v_mfma_f32_16x16x32_bf16 v[244:247], v[144:147], v[88:91], v[244:247]
    ds_read_b128 v[204:207], v10 offset:19456
    s_waitcnt lgkmcnt(14)
    v_mfma_f32_16x16x32_bf16 v[240:243], v[148:151], v[36:39], v[240:243]
    v_mfma_f32_16x16x32_bf16 v[244:247], v[148:151], v[92:95], v[244:247]
    ds_read_b128 v[208:211], v10 offset:20480
    s_waitcnt lgkmcnt(14)
    v_mfma_f32_16x16x32_bf16 v[240:243], v[152:155], v[40:43], v[240:243]
    v_mfma_f32_16x16x32_bf16 v[244:247], v[152:155], v[96:99], v[244:247]
    ds_read_b128 v[212:215], v10 offset:21504
    s_waitcnt lgkmcnt(14)
    v_mfma_f32_16x16x32_bf16 v[240:243], v[156:159], v[44:47], v[240:243]
    v_mfma_f32_16x16x32_bf16 v[244:247], v[156:159], v[100:103], v[244:247]
    ds_read_b128 v[216:219], v10 offset:22528
    s_waitcnt lgkmcnt(14)
    v_mfma_f32_16x16x32_bf16 v[240:243], v[160:163], v[48:51], v[240:243]
    v_mfma_f32_16x16x32_bf16 v[244:247], v[160:163], v[104:107], v[244:247]
    ds_read_b128 v[220:223], v10 offset:23552
    s_waitcnt lgkmcnt(14)
    v_mfma_f32_16x16x32_bf16 v[240:243], v[164:167], v[52:55], v[240:243]
    v_mfma_f32_16x16x32_bf16 v[244:247], v[164:167], v[108:111], v[244:247]
    ds_read_b128 v[224:227], v10 offset:24576
    s_waitcnt lgkmcnt(14)
    v_mfma_f32_16x16x32_bf16 v[240:243], v[168:171], v[56:59], v[240:243]
    v_mfma_f32_16x16x32_bf16 v[244:247], v[168:171], v[112:115], v[244:247]
    ds_read_b128 v[228:231], v10 offset:25600
    s_waitcnt lgkmcnt(14)
    v_mfma_f32_16x16x32_bf16 v[240:243], v[172:175], v[60:63], v[240:243]
    v_mfma_f32_16x16x32_bf16 v[244:247], v[172:175], v[116:119], v[244:247]
    ds_read_b128 v[232:235], v10 offset:26624
    s_waitcnt lgkmcnt(14)
    v_mfma_f32_16x16x32_bf16 v[240:243], v[176:179], v[64:67], v[240:243]
    v_mfma_f32_16x16x32_bf16 v[244:247], v[176:179], v[120:123], v[244:247]
    ds_read_b128 v[236:239], v10 offset:27648
    s_waitcnt lgkmcnt(14)
    v_mfma_f32_16x16x32_bf16 v[240:243], v[180:183], v[68:71], v[240:243]
    v_mfma_f32_16x16x32_bf16 v[244:247], v[180:183], v[124:127], v[244:247]
    s_waitcnt lgkmcnt(13)
    v_mfma_f32_16x16x32_bf16 v[248:251], v[184:187], v[16:19], 0
    v_mfma_f32_16x16x32_bf16 v[252:255], v[184:187], v[72:75], 0
    s_waitcnt lgkmcnt(12)
    v_mfma_f32_16x16x32_bf16 v[248:251], v[188:191], v[20:23], v[248:251]
    v_mfma_f32_16x16x32_bf16 v[252:255], v[188:191], v[76:79], v[252:255]
    s_waitcnt lgkmcnt(11)
    v_mfma_f32_16x16x32_bf16 v[248:251], v[192:195], v[24:27], v[248:251]
    v_mfma_f32_16x16x32_bf16 v[252:255], v[192:195], v[80:83], v[252:255]
    s_waitcnt lgkmcnt(10)
    v_mfma_f32_16x16x32_bf16 v[248:251], v[196:199], v[28:31], v[248:251]
    v_mfma_f32_16x16x32_bf16 v[252:255], v[196:199], v[84:87], v[252:255]
    s_waitcnt lgkmcnt(9)
    v_mfma_f32_16x16x32_bf16 v[248:251], v[200:203], v[32:35], v[248:251]
    v_mfma_f32_16x16x32_bf16 v[252:255], v[200:203], v[88:91], v[252:255]
    s_waitcnt lgkmcnt(8)
    v_mfma_f32_16x16x32_bf16 v[248:251], v[204:207], v[36:39], v[248:251]
    v_mfma_f32_16x16x32_bf16 v[252:255], v[204:207], v[92:95], v[252:255]
    s_waitcnt lgkmcnt(7)
    v_mfma_f32_16x16x32_bf16 v[248:251], v[208:211], v[40:43], v[248:251]
    v_mfma_f32_16x16x32_bf16 v[252:255], v[208:211], v[96:99], v[252:255]
    s_waitcnt lgkmcnt(6)
    v_mfma_f32_16x16x32_bf16 v[248:251], v[212:215], v[44:47], v[248:251]
    v_mfma_f32_16x16x32_bf16 v[252:255], v[212:215], v[100:103], v[252:255]
    s_waitcnt lgkmcnt(5)
    v_mfma_f32_16x16x32_bf16 v[248:251], v[216:219], v[48:51], v[248:251]
    v_mfma_f32_16x16x32_bf16 v[252:255], v[216:219], v[104:107], v[252:255]
    s_waitcnt lgkmcnt(4)
    v_mfma_f32_16x16x32_bf16 v[248:251], v[220:223], v[52:55], v[248:251]
    v_mfma_f32_16x16x32_bf16 v[252:255], v[220:223], v[108:111], v[252:255]
    s_waitcnt lgkmcnt(3)
    v_mfma_f32_16x16x32_bf16 v[248:251], v[224:227], v[56:59], v[248:251]
    v_mfma_f32_16x16x32_bf16 v[252:255], v[224:227], v[112:115], v[252:255]
    s_waitcnt lgkmcnt(2)
    v_mfma_f32_16x16x32_bf16 v[248:251], v[228:231], v[60:63], v[248:251]
    v_mfma_f32_16x16x32_bf16 v[252:255], v[228:231], v[116:119], v[252:255]
    s_waitcnt lgkmcnt(1)
    v_mfma_f32_16x16x32_bf16 v[248:251], v[232:235], v[64:67], v[248:251]
    v_mfma_f32_16x16x32_bf16 v[252:255], v[232:235], v[120:123], v[252:255]
    s_waitcnt lgkmcnt(0)
    v_mfma_f32_16x16x32_bf16 v[248:251], v[236:239], v[68:71], v[248:251]
    v_mfma_f32_16x16x32_bf16 v[252:255], v[236:239], v[124:127], v[252:255]
    s_nop 7
    v_cvt_pk_bf16_f32 v128, v240, v241
    v_cvt_pk_bf16_f32 v129, v242, v243
    v_cvt_pk_bf16_f32 v130, v248, v249
    v_cvt_pk_bf16_f32 v131, v250, v251
    v_cvt_pk_bf16_f32 v132, v244, v245
    v_cvt_pk_bf16_f32 v133, v246, v247
    v_cvt_pk_bf16_f32 v134, v252, v253
    v_cvt_pk_bf16_f32 v135, v254, v255
    s_waitcnt vmcnt(7)
    v_accvgpr_write_b32 a120, v128
    v_accvgpr_write_b32 a121, v129
    v_accvgpr_write_b32 a122, v130
    v_accvgpr_write_b32 a123, v131
    v_accvgpr_write_b32 a124, v132
    v_accvgpr_write_b32 a125, v133
    v_accvgpr_write_b32 a126, v134
    v_accvgpr_write_b32 a127, v135
    v_mfma_f32_16x16x32_bf16 a[0:3], a[24:27], v[128:131], a[0:3]
    v_mfma_f32_16x16x32_bf16 a[4:7], a[24:27], v[132:135], a[4:7]
    v_mfma_f32_16x16x32_bf16 a[8:11], a[28:31], v[128:131], a[8:11]
    v_mfma_f32_16x16x32_bf16 a[12:15], a[28:31], v[132:135], a[12:15]
    s_add_u32 s7, s7, 28672
    s_cmp_ge_u32 s7, 86016
    s_cselect_b32 s28, 86016, 0
    s_sub_u32 s7, s7, s28
    s_add_u32 s6, s6, 1
    s_add_u32 s26, s6, 1
    s_cmp_lt_u32 s26, 14
    s_cbranch_scc1 wp10_w7
    s_waitcnt vmcnt(0)
    s_branch wp10_w
    wp10_w7:
    s_waitcnt vmcnt(7)
    wp10_w:
wp11_loop:
    s_barrier
    s_mov_b32 s31, 11264
    buffer_load_dwordx4 a[24:27], v7, s[16:19], s31 offen
    s_mov_b32 s31, 25600
    buffer_load_dwordx4 a[28:31], v7, s[16:19], s31 offen
    s_add_u32 s27, s7, 57344
    s_cmp_ge_u32 s27, 86016
    s_cselect_b32 s28, 86016, 0
    s_sub_u32 s27, s27, s28
    s_add_u32 s26, s6, 2
    s_cmp_lt_u32 s26, 14
    s_cbranch_scc0 wp11_nodma
    s_mul_i32 s23, s26, 28672
    s_add_u32 s23, s23, s29
    s_add_u32 s23, s23, s30
    s_add_u32 s24, s27, s30
    s_add_u32 m0, s24, 0
    s_add_u32 s25, s23, 0
    buffer_load_dwordx4 v6, s[12:15], s25 offen lds
    s_add_u32 m0, s24, 1024
    s_add_u32 s25, s23, 1024
    buffer_load_dwordx4 v6, s[12:15], s25 offen lds
    s_add_u32 m0, s24, 2048
    s_add_u32 s25, s23, 2048
    buffer_load_dwordx4 v6, s[12:15], s25 offen lds
    s_add_u32 m0, s24, 3072
    s_add_u32 s25, s23, 3072
    buffer_load_dwordx4 v6, s[12:15], s25 offen lds
    s_add_u32 m0, s24, 4096
    s_add_u32 s25, s23, 4096
    buffer_load_dwordx4 v6, s[12:15], s25 offen lds
    s_add_u32 m0, s24, 5120
    s_add_u32 s25, s23, 5120
    buffer_load_dwordx4 v6, s[12:15], s25 offen lds
    s_add_u32 m0, s24, 6144
    s_add_u32 s25, s23, 6144
    buffer_load_dwordx4 v6, s[12:15], s25 offen lds
wp11_nodma:
    v_add_u32 v10, s7, v9
    ds_read_b128 v[128:131], v10 offset:0
    ds_read_b128 v[132:135], v10 offset:1024
    ds_read_b128 v[136:139], v10 offset:2048
    ds_read_b128 v[140:143], v10 offset:3072
    ds_read_b128 v[144:147], v10 offset:4096
    ds_read_b128 v[148:151], v10 offset:5120
    ds_read_b128 v[152:155], v10 offset:6144
    ds_read_b128 v[156:159], v10 offset:7168
    ds_read_b128 v[160:163], v10 offset:8192
    ds_read_b128 v[164:167], v10 offset:9216
    ds_read_b128 v[168:171], v10 offset:10240
    ds_read_b128 v[172:175], v10 offset:11264
    ds_read_b128 v[176:179], v10 offset:12288
    ds_read_b128 v[180:183], v10 offset:13312
    ds_read_b128 v[184:187], v10 offset:14336
    s_waitcnt lgkmcnt(14)
    v_mfma_f32_16x16x32_bf16 v[240:243], v[128:131], v[16:19], 0
    v_mfma_f32_16x16x32_bf16 v[244:247], v[128:131], v[72:75], 0
    ds_read_b128 v[188:191], v10 offset:15360
    s_waitcnt lgkmcnt(14)
    v_mfma_f32_16x16x32_bf16 v[240:243], v[132:135], v[20:23], v[240:243]
    v_mfma_f32_16x16x32_bf16 v[244:247], v[132:135], v[76:79], v[244:247]
    ds_read_b128 v[192:195], v10 offset:16384
    s_waitcnt lgkmcnt(14)
    v_mfma_f32_16x16x32_bf16 v[240:243], v[136:139], v[24:27], v[240:243]
    v_mfma_f32_16x16x32_bf16 v[244:247], v[136:139], v[80:83], v[244:247]
    ds_read_b128 v[196:199], v10 offset:17408
    s_waitcnt lgkmcnt(14)
    v_mfma_f32_16x16x32_bf16 v[240:243], v[140:143], v[28:31], v[240:243]
    v_mfma_f32_16x16x32_bf16 v[244:247], v[140:143], v[84:87], v[244:247]
    ds_read_b128 v[200:203], v10 offset:18432
    s_waitcnt lgkmcnt(14)
    v_mfma_f32_16x16x32_bf16 v[240:243], v[144:147], v[32:35], v[240:243]
    v_mfma_f32_16x16x32_bf16 v[244:247], v[144:147], v[88:91], v[244:247]
    ds_read_b128 v[204:207], v10 offset:19456
    s_waitcnt lgkmcnt(14)
    v_mfma_f32_16x16x32_bf16 v[240:243], v[148:151], v[36:39], v[240:243]
    v_mfma_f32_16x16x32_bf16 v[244:247], v[148:151], v[92:95], v[244:247]
    ds_read_b128 v[208:211], v10 offset:20480
    s_waitcnt lgkmcnt(14)
    v_mfma_f32_16x16x32_bf16 v[240:243], v[152:155], v[40:43], v[240:243]
    v_mfma_f32_16x16x32_bf16 v[244:247], v[152:155], v[96:99], v[244:247]
    ds_read_b128 v[212:215], v10 offset:21504
    s_waitcnt lgkmcnt(14)
    v_mfma_f32_16x16x32_bf16 v[240:243], v[156:159], v[44:47], v[240:243]
    v_mfma_f32_16x16x32_bf16 v[244:247], v[156:159], v[100:103], v[244:247]
    ds_read_b128 v[216:219], v10 offset:22528
    s_waitcnt lgkmcnt(14)
    v_mfma_f32_16x16x32_bf16 v[240:243], v[160:163], v[48:51], v[240:243]
    v_mfma_f32_16x16x32_bf16 v[244:247], v[160:163], v[104:107], v[244:247]
    ds_read_b128 v[220:223], v10 offset:23552
    s_waitcnt lgkmcnt(14)
    v_mfma_f32_16x16x32_bf16 v[240:243], v[164:167], v[52:55], v[240:243]
    v_mfma_f32_16x16x32_bf16 v[244:247], v[164:167], v[108:111], v[244:247]
    ds_read_b128 v[224:227], v10 offset:24576
    s_waitcnt lgkmcnt(14)
    v_mfma_f32_16x16x32_bf16 v[240:243], v[168:171], v[56:59], v[240:243]
    v_mfma_f32_16x16x32_bf16 v[244:247], v[168:171], v[112:115], v[244:247]
    ds_read_b128 v[228:231], v10 offset:25600
    s_waitcnt lgkmcnt(14)
    v_mfma_f32_16x16x32_bf16 v[240:243], v[172:175], v[60:63], v[240:243]
    v_mfma_f32_16x16x32_bf16 v[244:247], v[172:175], v[116:119], v[244:247]
    ds_read_b128 v[232:235], v10 offset:26624
    s_waitcnt lgkmcnt(14)
    v_mfma_f32_16x16x32_bf16 v[240:243], v[176:179], v[64:67], v[240:243]
    v_mfma_f32_16x16x32_bf16 v[244:247], v[176:179], v[120:123], v[244:247]
    ds_read_b128 v[236:239], v10 offset:27648
    s_waitcnt lgkmcnt(14)
    v_mfma_f32_16x16x32_bf16 v[240:243], v[180:183], v[68:71], v[240:243]
    v_mfma_f32_16x16x32_bf16 v[244:247], v[180:183], v[124:127], v[244:247]
    s_waitcnt lgkmcnt(13)
    v_mfma_f32_16x16x32_bf16 v[248:251], v[184:187], v[16:19], 0
    v_mfma_f32_16x16x32_bf16 v[252:255], v[184:187], v[72:75], 0
    s_waitcnt lgkmcnt(12)
    v_mfma_f32_16x16x32_bf16 v[248:251], v[188:191], v[20:23], v[248:251]
    v_mfma_f32_16x16x32_bf16 v[252:255], v[188:191], v[76:79], v[252:255]
    s_waitcnt lgkmcnt(11)
    v_mfma_f32_16x16x32_bf16 v[248:251], v[192:195], v[24:27], v[248:251]
    v_mfma_f32_16x16x32_bf16 v[252:255], v[192:195], v[80:83], v[252:255]
    s_waitcnt lgkmcnt(10)
    v_mfma_f32_16x16x32_bf16 v[248:251], v[196:199], v[28:31], v[248:251]
    v_mfma_f32_16x16x32_bf16 v[252:255], v[196:199], v[84:87], v[252:255]
    s_waitcnt lgkmcnt(9)
    v_mfma_f32_16x16x32_bf16 v[248:251], v[200:203], v[32:35], v[248:251]
    v_mfma_f32_16x16x32_bf16 v[252:255], v[200:203], v[88:91], v[252:255]
    s_waitcnt lgkmcnt(8)
    v_mfma_f32_16x16x32_bf16 v[248:251], v[204:207], v[36:39], v[248:251]
    v_mfma_f32_16x16x32_bf16 v[252:255], v[204:207], v[92:95], v[252:255]
    s_waitcnt lgkmcnt(7)
    v_mfma_f32_16x16x32_bf16 v[248:251], v[208:211], v[40:43], v[248:251]
    v_mfma_f32_16x16x32_bf16 v[252:255], v[208:211], v[96:99], v[252:255]
    s_waitcnt lgkmcnt(6)
    v_mfma_f32_16x16x32_bf16 v[248:251], v[212:215], v[44:47], v[248:251]
    v_mfma_f32_16x16x32_bf16 v[252:255], v[212:215], v[100:103], v[252:255]
    s_waitcnt lgkmcnt(5)
    v_mfma_f32_16x16x32_bf16 v[248:251], v[216:219], v[48:51], v[248:251]
    v_mfma_f32_16x16x32_bf16 v[252:255], v[216:219], v[104:107], v[252:255]
    s_waitcnt lgkmcnt(4)
    v_mfma_f32_16x16x32_bf16 v[248:251], v[220:223], v[52:55], v[248:251]
    v_mfma_f32_16x16x32_bf16 v[252:255], v[220:223], v[108:111], v[252:255]
    s_waitcnt lgkmcnt(3)
    v_mfma_f32_16x16x32_bf16 v[248:251], v[224:227], v[56:59], v[248:251]
    v_mfma_f32_16x16x32_bf16 v[252:255], v[224:227], v[112:115], v[252:255]
    s_waitcnt lgkmcnt(2)
    v_mfma_f32_16x16x32_bf16 v[248:251], v[228:231], v[60:63], v[248:251]
    v_mfma_f32_16x16x32_bf16 v[252:255], v[228:231], v[116:119], v[252:255]
    s_waitcnt lgkmcnt(1)
    v_mfma_f32_16x16x32_bf16 v[248:251], v[232:235], v[64:67], v[248:251]
    v_mfma_f32_16x16x32_bf16 v[252:255], v[232:235], v[120:123], v[252:255]
    s_waitcnt lgkmcnt(0)
    v_mfma_f32_16x16x32_bf16 v[248:251], v[236:239], v[68:71], v[248:251]
    v_mfma_f32_16x16x32_bf16 v[252:255], v[236:239], v[124:127], v[252:255]
    s_nop 7
    v_cvt_pk_bf16_f32 v128, v240, v241
    v_cvt_pk_bf16_f32 v129, v242, v243
    v_cvt_pk_bf16_f32 v130, v248, v249
    v_cvt_pk_bf16_f32 v131, v250, v251
    v_cvt_pk_bf16_f32 v132, v244, v245
    v_cvt_pk_bf16_f32 v133, v246, v247
    v_cvt_pk_bf16_f32 v134, v252, v253
    v_cvt_pk_bf16_f32 v135, v254, v255
    s_waitcnt vmcnt(7)
    v_accvgpr_write_b32 a128, v128
    v_accvgpr_write_b32 a129, v129
    v_accvgpr_write_b32 a130, v130
    v_accvgpr_write_b32 a131, v131
    v_accvgpr_write_b32 a132, v132
    v_accvgpr_write_b32 a133, v133
    v_accvgpr_write_b32 a134, v134
    v_accvgpr_write_b32 a135, v135
    v_mfma_f32_16x16x32_bf16 a[0:3], a[24:27], v[128:131], a[0:3]
    v_mfma_f32_16x16x32_bf16 a[4:7], a[24:27], v[132:135], a[4:7]
    v_mfma_f32_16x16x32_bf16 a[8:11], a[28:31], v[128:131], a[8:11]
    v_mfma_f32_16x16x32_bf16 a[12:15], a[28:31], v[132:135], a[12:15]
    s_add_u32 s7, s7, 28672
    s_cmp_ge_u32 s7, 86016
    s_cselect_b32 s28, 86016, 0
    s_sub_u32 s7, s7, s28
    s_add_u32 s6, s6, 1
    s_add_u32 s26, s6, 1
    s_cmp_lt_u32 s26, 14
    s_cbranch_scc1 wp11_w7
    s_waitcnt vmcnt(0)
    s_branch wp11_w
    wp11_w7:
    s_waitcnt vmcnt(7)
    wp11_w:
wp12_loop:
    s_barrier
    s_mov_b32 s31, 12288
    buffer_load_dwordx4 a[24:27], v7, s[16:19], s31 offen
    s_mov_b32 s31, 26624
    buffer_load_dwordx4 a[28:31], v7, s[16:19], s31 offen
    s_add_u32 s27, s7, 57344
    s_cmp_ge_u32 s27, 86016
    s_cselect_b32 s28, 86016, 0
    s_sub_u32 s27, s27, s28
    s_add_u32 s26, s6, 2
    s_cmp_lt_u32 s26, 14
    s_cbranch_scc0 wp12_nodma
    s_mul_i32 s23, s26, 28672
    s_add_u32 s23, s23, s29
    s_add_u32 s23, s23, s30
    s_add_u32 s24, s27, s30
    s_add_u32 m0, s24, 0
    s_add_u32 s25, s23, 0
    buffer_load_dwordx4 v6, s[12:15], s25 offen lds
    s_add_u32 m0, s24, 1024
    s_add_u32 s25, s23, 1024
    buffer_load_dwordx4 v6, s[12:15], s25 offen lds
    s_add_u32 m0, s24, 2048
    s_add_u32 s25, s23, 2048
    buffer_load_dwordx4 v6, s[12:15], s25 offen lds
    s_add_u32 m0, s24, 3072
    s_add_u32 s25, s23, 3072
    buffer_load_dwordx4 v6, s[12:15], s25 offen lds
    s_add_u32 m0, s24, 4096
    s_add_u32 s25, s23, 4096
    buffer_load_dwordx4 v6, s[12:15], s25 offen lds
    s_add_u32 m0, s24, 5120
    s_add_u32 s25, s23, 5120
    buffer_load_dwordx4 v6, s[12:15], s25 offen lds
    s_add_u32 m0, s24, 6144
    s_add_u32 s25, s23, 6144
    buffer_load_dwordx4 v6, s[12:15], s25 offen lds
wp12_nodma:
    v_add_u32 v10, s7, v9
    ds_read_b128 v[128:131], v10 offset:0
    ds_read_b128 v[132:135], v10 offset:1024
    ds_read_b128 v[136:139], v10 offset:2048
    ds_read_b128 v[140:143], v10 offset:3072
    ds_read_b128 v[144:147], v10 offset:4096
    ds_read_b128 v[148:151], v10 offset:5120
    ds_read_b128 v[152:155], v10 offset:6144
    ds_read_b128 v[156:159], v10 offset:7168
    ds_read_b128 v[160:163], v10 offset:8192
    ds_read_b128 v[164:167], v10 offset:9216
    ds_read_b128 v[168:171], v10 offset:10240
    ds_read_b128 v[172:175], v10 offset:11264
    ds_read_b128 v[176:179], v10 offset:12288
    ds_read_b128 v[180:183], v10 offset:13312
    ds_read_b128 v[184:187], v10 offset:14336
    s_waitcnt lgkmcnt(14)
    v_mfma_f32_16x16x32_bf16 v[240:243], v[128:131], v[16:19], 0
    v_mfma_f32_16x16x32_bf16 v[244:247], v[128:131], v[72:75], 0
    ds_read_b128 v[188:191], v10 offset:15360
    s_waitcnt lgkmcnt(14)
    v_mfma_f32_16x16x32_bf16 v[240:243], v[132:135], v[20:23], v[240:243]
    v_mfma_f32_16x16x32_bf16 v[244:247], v[132:135], v[76:79], v[244:247]
    ds_read_b128 v[192:195], v10 offset:16384
    s_waitcnt lgkmcnt(14)
    v_mfma_f32_16x16x32_bf16 v[240:243], v[136:139], v[24:27], v[240:243]
    v_mfma_f32_16x16x32_bf16 v[244:247], v[136:139], v[80:83], v[244:247]
    ds_read_b128 v[196:199], v10 offset:17408
    s_waitcnt lgkmcnt(14)
    v_mfma_f32_16x16x32_bf16 v[240:243], v[140:143], v[28:31], v[240:243]
    v_mfma_f32_16x16x32_bf16 v[244:247], v[140:143], v[84:87], v[244:247]
    ds_read_b128 v[200:203], v10 offset:18432
    s_waitcnt lgkmcnt(14)
    v_mfma_f32_16x16x32_bf16 v[240:243], v[144:147], v[32:35], v[240:243]
    v_mfma_f32_16x16x32_bf16 v[244:247], v[144:147], v[88:91], v[244:247]
    ds_read_b128 v[204:207], v10 offset:19456
    s_waitcnt lgkmcnt(14)
    v_mfma_f32_16x16x32_bf16 v[240:243], v[148:151], v[36:39], v[240:243]
    v_mfma_f32_16x16x32_bf16 v[244:247], v[148:151], v[92:95], v[244:247]
    ds_read_b128 v[208:211], v10 offset:20480
    s_waitcnt lgkmcnt(14)
    v_mfma_f32_16x16x32_bf16 v[240:243], v[152:155], v[40:43], v[240:243]
    v_mfma_f32_16x16x32_bf16 v[244:247], v[152:155], v[96:99], v[244:247]
    ds_read_b128 v[212:215], v10 offset:21504
    s_waitcnt lgkmcnt(14)
    v_mfma_f32_16x16x32_bf16 v[240:243], v[156:159], v[44:47], v[240:243]
    v_mfma_f32_16x16x32_bf16 v[244:247], v[156:159], v[100:103], v[244:247]
    ds_read_b128 v[216:219], v10 offset:22528
    s_waitcnt lgkmcnt(14)
    v_mfma_f32_16x16x32_bf16 v[240:243], v[160:163], v[48:51], v[240:243]
    v_mfma_f32_16x16x32_bf16 v[244:247], v[160:163], v[104:107], v[244:247]
    ds_read_b128 v[220:223], v10 offset:23552
    s_waitcnt lgkmcnt(14)
    v_mfma_f32_16x16x32_bf16 v[240:243], v[164:167], v[52:55], v[240:243]
    v_mfma_f32_16x16x32_bf16 v[244:247], v[164:167], v[108:111], v[244:247]
    ds_read_b128 v[224:227], v10 offset:24576
    s_waitcnt lgkmcnt(14)
    v_mfma_f32_16x16x32_bf16 v[240:243], v[168:171], v[56:59], v[240:243]
    v_mfma_f32_16x16x32_bf16 v[244:247], v[168:171], v[112:115], v[244:247]
    ds_read_b128 v[228:231], v10 offset:25600
    s_waitcnt lgkmcnt(14)
    v_mfma_f32_16x16x32_bf16 v[240:243], v[172:175], v[60:63], v[240:243]
    v_mfma_f32_16x16x32_bf16 v[244:247], v[172:175], v[116:119], v[244:247]
    ds_read_b128 v[232:235], v10 offset:26624
    s_waitcnt lgkmcnt(14)
    v_mfma_f32_16x16x32_bf16 v[240:243], v[176:179], v[64:67], v[240:243]
    v_mfma_f32_16x16x32_bf16 v[244:247], v[176:179], v[120:123], v[244:247]
    ds_read_b128 v[236:239], v10 offset:27648
    s_waitcnt lgkmcnt(14)
    v_mfma_f32_16x16x32_bf16 v[240:243], v[180:183], v[68:71], v[240:243]
    v_mfma_f32_16x16x32_bf16 v[244:247], v[180:183], v[124:127], v[244:247]
    s_waitcnt lgkmcnt(13)
    v_mfma_f32_16x16x32_bf16 v[248:251], v[184:187], v[16:19], 0
    v_mfma_f32_16x16x32_bf16 v[252:255], v[184:187], v[72:75], 0
    s_waitcnt lgkmcnt(12)
    v_mfma_f32_16x16x32_bf16 v[248:251], v[188:191], v[20:23], v[248:251]
    v_mfma_f32_16x16x32_bf16 v[252:255], v[188:191], v[76:79], v[252:255]
    s_waitcnt lgkmcnt(11)
    v_mfma_f32_16x16x32_bf16 v[248:251], v[192:195], v[24:27], v[248:251]
    v_mfma_f32_16x16x32_bf16 v[252:255], v[192:195], v[80:83], v[252:255]
    s_waitcnt lgkmcnt(10)
    v_mfma_f32_16x16x32_bf16 v[248:251], v[196:199], v[28:31], v[248:251]
    v_mfma_f32_16x16x32_bf16 v[252:255], v[196:199], v[84:87], v[252:255]
    s_waitcnt lgkmcnt(9)
    v_mfma_f32_16x16x32_bf16 v[248:251], v[200:203], v[32:35], v[248:251]
    v_mfma_f32_16x16x32_bf16 v[252:255], v[200:203], v[88:91], v[252:255]
    s_waitcnt lgkmcnt(8)
    v_mfma_f32_16x16x32_bf16 v[248:251], v[204:207], v[36:39], v[248:251]
    v_mfma_f32_16x16x32_bf16 v[252:255], v[204:207], v[92:95], v[252:255]
    s_waitcnt lgkmcnt(7)
    v_mfma_f32_16x16x32_bf16 v[248:251], v[208:211], v[40:43], v[248:251]
    v_mfma_f32_16x16x32_bf16 v[252:255], v[208:211], v[96:99], v[252:255]
    s_waitcnt lgkmcnt(6)
    v_mfma_f32_16x16x32_bf16 v[248:251], v[212:215], v[44:47], v[248:251]
    v_mfma_f32_16x16x32_bf16 v[252:255], v[212:215], v[100:103], v[252:255]
    s_waitcnt lgkmcnt(5)
    v_mfma_f32_16x16x32_bf16 v[248:251], v[216:219], v[48:51], v[248:251]
    v_mfma_f32_16x16x32_bf16 v[252:255], v[216:219], v[104:107], v[252:255]
    s_waitcnt lgkmcnt(4)
    v_mfma_f32_16x16x32_bf16 v[248:251], v[220:223], v[52:55], v[248:251]
    v_mfma_f32_16x16x32_bf16 v[252:255], v[220:223], v[108:111], v[252:255]
    s_waitcnt lgkmcnt(3)
    v_mfma_f32_16x16x32_bf16 v[248:251], v[224:227], v[56:59], v[248:251]
    v_mfma_f32_16x16x32_bf16 v[252:255], v[224:227], v[112:115], v[252:255]
    s_waitcnt lgkmcnt(2)
    v_mfma_f32_16x16x32_bf16 v[248:251], v[228:231], v[60:63], v[248:251]
    v_mfma_f32_16x16x32_bf16 v[252:255], v[228:231], v[116:119], v[252:255]
    s_waitcnt lgkmcnt(1)
    v_mfma_f32_16x16x32_bf16 v[248:251], v[232:235], v[64:67], v[248:251]
    v_mfma_f32_16x16x32_bf16 v[252:255], v[232:235], v[120:123], v[252:255]
    s_waitcnt lgkmcnt(0)
    v_mfma_f32_16x16x32_bf16 v[248:251], v[236:239], v[68:71], v[248:251]
    v_mfma_f32_16x16x32_bf16 v[252:255], v[236:239], v[124:127], v[252:255]
    s_nop 7
    v_cvt_pk_bf16_f32 v128, v240, v241
    v_cvt_pk_bf16_f32 v129, v242, v243
    v_cvt_pk_bf16_f32 v130, v248, v249
    v_cvt_pk_bf16_f32 v131, v250, v251
    v_cvt_pk_bf16_f32 v132, v244, v245
    v_cvt_pk_bf16_f32 v133, v246, v247
    v_cvt_pk_bf16_f32 v134, v252, v253
    v_cvt_pk_bf16_f32 v135, v254, v255
    s_waitcnt vmcnt(0)
    v_accvgpr_write_b32 a136, v128
    v_accvgpr_write_b32 a137, v129
    v_accvgpr_write_b32 a138, v130
    v_accvgpr_write_b32 a139, v131
    v_accvgpr_write_b32 a140, v132
    v_accvgpr_write_b32 a141, v133
    v_accvgpr_write_b32 a142, v134
    v_accvgpr_write_b32 a143, v135
    v_mfma_f32_16x16x32_bf16 a[0:3], a[24:27], v[128:131], a[0:3]
    v_mfma_f32_16x16x32_bf16 a[4:7], a[24:27], v[132:135], a[4:7]
    v_mfma_f32_16x16x32_bf16 a[8:11], a[28:31], v[128:131], a[8:11]
    v_mfma_f32_16x16x32_bf16 a[12:15], a[28:31], v[132:135], a[12:15]
    s_add_u32 s7, s7, 28672
    s_cmp_ge_u32 s7, 86016
    s_cselect_b32 s28, 86016, 0
    s_sub_u32 s7, s7, s28
    s_add_u32 s6, s6, 1
    s_add_u32 s26, s6, 1
    s_cmp_lt_u32 s26, 14
    s_cbranch_scc1 wp12_w7
    s_waitcnt vmcnt(0)
    s_branch wp12_w
    wp12_w7:
    s_waitcnt vmcnt(7)
    wp12_w:
wp13_loop:
    s_barrier
    s_mov_b32 s31, 13312
    buffer_load_dwordx4 a[24:27], v7, s[16:19], s31 offen
    s_mov_b32 s31, 27648
    buffer_load_dwordx4 a[28:31], v7, s[16:19], s31 offen
    s_add_u32 s27, s7, 57344
    s_cmp_ge_u32 s27, 86016
    s_cselect_b32 s28, 86016, 0
    s_sub_u32 s27, s27, s28
    s_add_u32 s26, s6, 2
    s_cmp_lt_u32 s26, 14
    s_cbranch_scc0 wp13_nodma
    s_mul_i32 s23, s26, 28672
    s_add_u32 s23, s23, s29
    s_add_u32 s23, s23, s30
    s_add_u32 s24, s27, s30
    s_add_u32 m0, s24, 0
    s_add_u32 s25, s23, 0
    buffer_load_dwordx4 v6, s[12:15], s25 offen lds
    s_add_u32 m0, s24, 1024
    s_add_u32 s25, s23, 1024
    buffer_load_dwordx4 v6, s[12:15], s25 offen lds
    s_add_u32 m0, s24, 2048
    s_add_u32 s25, s23, 2048
    buffer_load_dwordx4 v6, s[12:15], s25 offen lds
    s_add_u32 m0, s24, 3072
    s_add_u32 s25, s23, 3072
    buffer_load_dwordx4 v6, s[12:15], s25 offen lds
    s_add_u32 m0, s24, 4096
    s_add_u32 s25, s23, 4096
    buffer_load_dwordx4 v6, s[12:15], s25 offen lds
    s_add_u32 m0, s24, 5120
    s_add_u32 s25, s23, 5120
    buffer_load_dwordx4 v6, s[12:15], s25 offen lds
    s_add_u32 m0, s24, 6144
    s_add_u32 s25, s23, 6144
    buffer_load_dwordx4 v6, s[12:15], s25 offen lds
wp13_nodma:
    v_add_u32 v10, s7, v9
    ds_read_b128 v[128:131], v10 offset:0
    ds_read_b128 v[132:135], v10 offset:1024
    ds_read_b128 v[136:139], v10 offset:2048
    ds_read_b128 v[140:143], v10 offset:3072
    ds_read_b128 v[144:147], v10 offset:4096
    ds_read_b128 v[148:151], v10 offset:5120
    ds_read_b128 v[152:155], v10 offset:6144
    ds_read_b128 v[156:159], v10 offset:7168
    ds_read_b128 v[160:163], v10 offset:8192
    ds_read_b128 v[164:167], v10 offset:9216
    ds_read_b128 v[168:171], v10 offset:10240
    ds_read_b128 v[172:175], v10 offset:11264
    ds_read_b128 v[176:179], v10 offset:12288
    ds_read_b128 v[180:183], v10 offset:13312
    ds_read_b128 v[184:187], v10 offset:14336
    s_waitcnt lgkmcnt(14)
    v_mfma_f32_16x16x32_bf16 v[240:243], v[128:131], v[16:19], 0
    v_mfma_f32_16x16x32_bf16 v[244:247], v[128:131], v[72:75], 0
    ds_read_b128 v[188:191], v10 offset:15360
    s_waitcnt lgkmcnt(14)
    v_mfma_f32_16x16x32_bf16 v[240:243], v[132:135], v[20:23], v[240:243]
    v_mfma_f32_16x16x32_bf16 v[244:247], v[132:135], v[76:79], v[244:247]
    ds_read_b128 v[192:195], v10 offset:16384
    s_waitcnt lgkmcnt(14)
    v_mfma_f32_16x16x32_bf16 v[240:243], v[136:139], v[24:27], v[240:243]
    v_mfma_f32_16x16x32_bf16 v[244:247], v[136:139], v[80:83], v[244:247]
    ds_read_b128 v[196:199], v10 offset:17408
    s_waitcnt lgkmcnt(14)
    v_mfma_f32_16x16x32_bf16 v[240:243], v[140:143], v[28:31], v[240:243]
    v_mfma_f32_16x16x32_bf16 v[244:247], v[140:143], v[84:87], v[244:247]
    ds_read_b128 v[200:203], v10 offset:18432
    s_waitcnt lgkmcnt(14)
    v_mfma_f32_16x16x32_bf16 v[240:243], v[144:147], v[32:35], v[240:243]
    v_mfma_f32_16x16x32_bf16 v[244:247], v[144:147], v[88:91], v[244:247]
    ds_read_b128 v[204:207], v10 offset:19456
    s_waitcnt lgkmcnt(14)
    v_mfma_f32_16x16x32_bf16 v[240:243], v[148:151], v[36:39], v[240:243]
    v_mfma_f32_16x16x32_bf16 v[244:247], v[148:151], v[92:95], v[244:247]
    ds_read_b128 v[208:211], v10 offset:20480
    s_waitcnt lgkmcnt(14)
    v_mfma_f32_16x16x32_bf16 v[240:243], v[152:155], v[40:43], v[240:243]
    v_mfma_f32_16x16x32_bf16 v[244:247], v[152:155], v[96:99], v[244:247]
    ds_read_b128 v[212:215], v10 offset:21504
    s_waitcnt lgkmcnt(14)
    v_mfma_f32_16x16x32_bf16 v[240:243], v[156:159], v[44:47], v[240:243]
    v_mfma_f32_16x16x32_bf16 v[244:247], v[156:159], v[100:103], v[244:247]
    ds_read_b128 v[216:219], v10 offset:22528
    s_waitcnt lgkmcnt(14)
    v_mfma_f32_16x16x32_bf16 v[240:243], v[160:163], v[48:51], v[240:243]
    v_mfma_f32_16x16x32_bf16 v[244:247], v[160:163], v[104:107], v[244:247]
    ds_read_b128 v[220:223], v10 offset:23552
    s_waitcnt lgkmcnt(14)
    v_mfma_f32_16x16x32_bf16 v[240:243], v[164:167], v[52:55], v[240:243]
    v_mfma_f32_16x16x32_bf16 v[244:247], v[164:167], v[108:111], v[244:247]
    ds_read_b128 v[224:227], v10 offset:24576
    s_waitcnt lgkmcnt(14)
    v_mfma_f32_16x16x32_bf16 v[240:243], v[168:171], v[56:59], v[240:243]
    v_mfma_f32_16x16x32_bf16 v[244:247], v[168:171], v[112:115], v[244:247]
    ds_read_b128 v[228:231], v10 offset:25600
    s_waitcnt lgkmcnt(14)
    v_mfma_f32_16x16x32_bf16 v[240:243], v[172:175], v[60:63], v[240:243]
    v_mfma_f32_16x16x32_bf16 v[244:247], v[172:175], v[116:119], v[244:247]
    ds_read_b128 v[232:235], v10 offset:26624
    s_waitcnt lgkmcnt(14)
    v_mfma_f32_16x16x32_bf16 v[240:243], v[176:179], v[64:67], v[240:243]
    v_mfma_f32_16x16x32_bf16 v[244:247], v[176:179], v[120:123], v[244:247]
    ds_read_b128 v[236:239], v10 offset:27648
    s_waitcnt lgkmcnt(14)
    v_mfma_f32_16x16x32_bf16 v[240:243], v[180:183], v[68:71], v[240:243]
    v_mfma_f32_16x16x32_bf16 v[244:247], v[180:183], v[124:127], v[244:247]
    s_waitcnt lgkmcnt(13)
    v_mfma_f32_16x16x32_bf16 v[248:251], v[184:187], v[16:19], 0
    v_mfma_f32_16x16x32_bf16 v[252:255], v[184:187], v[72:75], 0
    s_waitcnt lgkmcnt(12)
    v_mfma_f32_16x16x32_bf16 v[248:251], v[188:191], v[20:23], v[248:251]
    v_mfma_f32_16x16x32_bf16 v[252:255], v[188:191], v[76:79], v[252:255]
    s_waitcnt lgkmcnt(11)
    v_mfma_f32_16x16x32_bf16 v[248:251], v[192:195], v[24:27], v[248:251]
    v_mfma_f32_16x16x32_bf16 v[252:255], v[192:195], v[80:83], v[252:255]
    s_waitcnt lgkmcnt(10)
    v_mfma_f32_16x16x32_bf16 v[248:251], v[196:199], v[28:31], v[248:251]
    v_mfma_f32_16x16x32_bf16 v[252:255], v[196:199], v[84:87], v[252:255]
    s_waitcnt lgkmcnt(9)
    v_mfma_f32_16x16x32_bf16 v[248:251], v[200:203], v[32:35], v[248:251]
    v_mfma_f32_16x16x32_bf16 v[252:255], v[200:203], v[88:91], v[252:255]
    s_waitcnt lgkmcnt(8)
    v_mfma_f32_16x16x32_bf16 v[248:251], v[204:207], v[36:39], v[248:251]
    v_mfma_f32_16x16x32_bf16 v[252:255], v[204:207], v[92:95], v[252:255]
    s_waitcnt lgkmcnt(7)
    v_mfma_f32_16x16x32_bf16 v[248:251], v[208:211], v[40:43], v[248:251]
    v_mfma_f32_16x16x32_bf16 v[252:255], v[208:211], v[96:99], v[252:255]
    s_waitcnt lgkmcnt(6)
    v_mfma_f32_16x16x32_bf16 v[248:251], v[212:215], v[44:47], v[248:251]
    v_mfma_f32_16x16x32_bf16 v[252:255], v[212:215], v[100:103], v[252:255]
    s_waitcnt lgkmcnt(5)
    v_mfma_f32_16x16x32_bf16 v[248:251], v[216:219], v[48:51], v[248:251]
    v_mfma_f32_16x16x32_bf16 v[252:255], v[216:219], v[104:107], v[252:255]
    s_waitcnt lgkmcnt(4)
    v_mfma_f32_16x16x32_bf16 v[248:251], v[220:223], v[52:55], v[248:251]
    v_mfma_f32_16x16x32_bf16 v[252:255], v[220:223], v[108:111], v[252:255]
    s_waitcnt lgkmcnt(3)
    v_mfma_f32_16x16x32_bf16 v[248:251], v[224:227], v[56:59], v[248:251]
    v_mfma_f32_16x16x32_bf16 v[252:255], v[224:227], v[112:115], v[252:255]
    s_waitcnt lgkmcnt(2)
    v_mfma_f32_16x16x32_bf16 v[248:251], v[228:231], v[60:63], v[248:251]
    v_mfma_f32_16x16x32_bf16 v[252:255], v[228:231], v[116:119], v[252:255]
    s_waitcnt lgkmcnt(1)
    v_mfma_f32_16x16x32_bf16 v[248:251], v[232:235], v[64:67], v[248:251]
    v_mfma_f32_16x16x32_bf16 v[252:255], v[232:235], v[120:123], v[252:255]
    s_waitcnt lgkmcnt(0)
    v_mfma_f32_16x16x32_bf16 v[248:251], v[236:239], v[68:71], v[248:251]
    v_mfma_f32_16x16x32_bf16 v[252:255], v[236:239], v[124:127], v[252:255]
    s_nop 7
    v_cvt_pk_bf16_f32 v128, v240, v241
    v_cvt_pk_bf16_f32 v129, v242, v243
    v_cvt_pk_bf16_f32 v130, v248, v249
    v_cvt_pk_bf16_f32 v131, v250, v251
    v_cvt_pk_bf16_f32 v132, v244, v245
    v_cvt_pk_bf16_f32 v133, v246, v247
    v_cvt_pk_bf16_f32 v134, v252, v253
    v_cvt_pk_bf16_f32 v135, v254, v255
    s_waitcnt vmcnt(0)
    v_accvgpr_write_b32 a144, v128
    v_accvgpr_write_b32 a145, v129
    v_accvgpr_write_b32 a146, v130
    v_accvgpr_write_b32 a147, v131
    v_accvgpr_write_b32 a148, v132
    v_accvgpr_write_b32 a149, v133
    v_accvgpr_write_b32 a150, v134
    v_accvgpr_write_b32 a151, v135
    v_mfma_f32_16x16x32_bf16 a[0:3], a[24:27], v[128:131], a[0:3]
    v_mfma_f32_16x16x32_bf16 a[4:7], a[24:27], v[132:135], a[4:7]
    v_mfma_f32_16x16x32_bf16 a[8:11], a[28:31], v[128:131], a[8:11]
    v_mfma_f32_16x16x32_bf16 a[12:15], a[28:31], v[132:135], a[12:15]
    s_add_u32 s7, s7, 28672
    s_cmp_ge_u32 s7, 86016
    s_cselect_b32 s28, 86016, 0
    s_sub_u32 s7, s7, s28
    s_add_u32 s6, s6, 1
    s_add_u32 s26, s6, 1
    s_cmp_lt_u32 s26, 14
    s_cbranch_scc1 wp13_w7
    s_waitcnt vmcnt(0)
    s_branch wp13_w
    wp13_w7:
    s_waitcnt vmcnt(7)
    wp13_w:
    s_load_dwordx2 s[32:33], s[0:1], 152
    s_waitcnt lgkmcnt(0)
    s_add_u32 s32, s32, 36904960
    s_addc_u32 s33, s33, 0
    s_and_b32 s33, s33, 0xffff
    s_mov_b32 s34, 465920
    s_mov_b32 s35, 0x20000
    s_sub_u32 s36, 64, s5
    s_mul_i32 s36, s36, 7168
    v_and_b32 v8, 7, v2
    v_mul_u32_u24 v8, 896, v8
    v_lshl_add_u32 v8, v3, 3, v8
    v_add_u32 v8, s36, v8
    s_mov_b32 s37, 1000000
wp_mq:
    buffer_load_dwordx2 v[16:17], v8, s[32:35], 0 offen offset:864 sc1
    s_waitcnt vmcnt(0)
    v_max_u32 v72, v16, v17
    v_cmp_eq_u32 vcc, -1, v72
    s_cbranch_vccz wp_mp
    s_sleep 2
    s_cmp_ge_u32 s5, 60
    s_cbranch_scc1 wp_ms
    s_sleep 40
    wp_ms:
    s_sub_u32 s37, s37, 1
    s_cmp_lg_u32 s37, 0
    s_cbranch_scc1 wp_mq
    s_branch chain_end
wp_mp:
    buffer_load_dwordx2 v[16:17], v8, s[32:35], 0 offen offset:0 sc1
    buffer_load_dwordx2 v[18:19], v8, s[32:35], 0 offen offset:32 sc1
    buffer_load_dwordx2 v[20:21], v8, s[32:35], 0 offen offset:64 sc1
    buffer_load_dwordx2 v[22:23], v8, s[32:35], 0 offen offset:96 sc1
    buffer_load_dwordx2 v[24:25], v8, s[32:35], 0 offen offset:128 sc1
    buffer_load_dwordx2 v[26:27], v8, s[32:35], 0 offen offset:160 sc1
    buffer_load_dwordx2 v[28:29], v8, s[32:35], 0 offen offset:192 sc1
    buffer_load_dwordx2 v[30:31], v8, s[32:35], 0 offen offset:224 sc1
    buffer_load_dwordx2 v[32:33], v8, s[32:35], 0 offen offset:256 sc1
    buffer_load_dwordx2 v[34:35], v8, s[32:35], 0 offen offset:288 sc1
    buffer_load_dwordx2 v[36:37], v8, s[32:35], 0 offen offset:320 sc1
    buffer_load_dwordx2 v[38:39], v8, s[32:35], 0 offen offset:352 sc1
    buffer_load_dwordx2 v[40:41], v8, s[32:35], 0 offen offset:384 sc1
    buffer_load_dwordx2 v[42:43], v8, s[32:35], 0 offen offset:416 sc1
    buffer_load_dwordx2 v[44:45], v8, s[32:35], 0 offen offset:448 sc1
    buffer_load_dwordx2 v[46:47], v8, s[32:35], 0 offen offset:480 sc1
    buffer_load_dwordx2 v[48:49], v8, s[32:35], 0 offen offset:512 sc1
    buffer_load_dwordx2 v[50:51], v8, s[32:35], 0 offen offset:544 sc1
    buffer_load_dwordx2 v[52:53], v8, s[32:35], 0 offen offset:576 sc1
    buffer_load_dwordx2 v[54:55], v8, s[32:35], 0 offen offset:608 sc1
    buffer_load_dwordx2 v[56:57], v8, s[32:35], 0 offen offset:640 sc1
    buffer_load_dwordx2 v[58:59], v8, s[32:35], 0 offen offset:672 sc1
    buffer_load_dwordx2 v[60:61], v8, s[32:35], 0 offen offset:704 sc1
    buffer_load_dwordx2 v[62:63], v8, s[32:35], 0 offen offset:736 sc1
    buffer_load_dwordx2 v[64:65], v8, s[32:35], 0 offen offset:768 sc1
    buffer_load_dwordx2 v[66:67], v8, s[32:35], 0 offen offset:800 sc1
    buffer_load_dwordx2 v[68:69], v8, s[32:35], 0 offen offset:832 sc1
    buffer_load_dwordx2 v[70:71], v8, s[32:35], 0 offen offset:864 sc1
    s_waitcnt vmcnt(0)
    v_max_u32 v72, v16, v17
    v_max3_u32 v72, v72, v18, v19
    v_max3_u32 v72, v72, v20, v21
    v_max3_u32 v72, v72, v22, v23
    v_max3_u32 v72, v72, v24, v25
    v_max3_u32 v72, v72, v26, v27
    v_max3_u32 v72, v72, v28, v29
    v_max3_u32 v72, v72, v30, v31
    v_max3_u32 v72, v72, v32, v33
    v_max3_u32 v72, v72, v34, v35
    v_max3_u32 v72, v72, v36, v37
    v_max3_u32 v72, v72, v38, v39
    v_max3_u32 v72, v72, v40, v41
    v_max3_u32 v72, v72, v42, v43
    v_max3_u32 v72, v72, v44, v45
    v_max3_u32 v72, v72, v46, v47
    v_max3_u32 v72, v72, v48, v49
    v_max3_u32 v72, v72, v50, v51
    v_max3_u32 v72, v72, v52, v53
    v_max3_u32 v72, v72, v54, v55
    v_max3_u32 v72, v72, v56, v57
    v_max3_u32 v72, v72, v58, v59
    v_max3_u32 v72, v72, v60, v61
    v_max3_u32 v72, v72, v62, v63
    v_max3_u32 v72, v72, v64, v65
    v_max3_u32 v72, v72, v66, v67
    v_max3_u32 v72, v72, v68, v69
    v_max3_u32 v72, v72, v70, v71
    v_cmp_eq_u32 vcc, -1, v72
    s_cbranch_vccz wp_mg
    s_sleep 1
    s_sub_u32 s37, s37, 1
    s_cmp_lg_u32 s37, 0
    s_cbranch_scc1 wp_mp
    s_branch chain_end
wp_mg:
    v_mfma_f32_16x16x32_bf16 a[16:19], v[16:19], a[40:43], a[16:19]
    v_mfma_f32_16x16x32_bf16 a[20:23], v[16:19], a[44:47], a[20:23]
    v_mfma_f32_16x16x32_bf16 a[16:19], v[20:23], a[48:51], a[16:19]
    v_mfma_f32_16x16x32_bf16 a[20:23], v[20:23], a[52:55], a[20:23]
    v_mfma_f32_16x16x32_bf16 a[16:19], v[24:27], a[56:59], a[16:19]
    v_mfma_f32_16x16x32_bf16 a[20:23], v[24:27], a[60:63], a[20:23]
    v_mfma_f32_16x16x32_bf16 a[16:19], v[28:31], a[64:67], a[16:19]
    v_mfma_f32_16x16x32_bf16 a[20:23], v[28:31], a[68:71], a[20:23]
    v_mfma_f32_16x16x32_bf16 a[16:19], v[32:35], a[72:75], a[16:19]
    v_mfma_f32_16x16x32_bf16 a[20:23], v[32:35], a[76:79], a[20:23]
    v_mfma_f32_16x16x32_bf16 a[16:19], v[36:39], a[80:83], a[16:19]
    v_mfma_f32_16x16x32_bf16 a[20:23], v[36:39], a[84:87], a[20:23]
    v_mfma_f32_16x16x32_bf16 a[16:19], v[40:43], a[88:91], a[16:19]
    v_mfma_f32_16x16x32_bf16 a[20:23], v[40:43], a[92:95], a[20:23]
    v_mfma_f32_16x16x32_bf16 a[16:19], v[44:47], a[96:99], a[16:19]
    v_mfma_f32_16x16x32_bf16 a[20:23], v[44:47], a[100:103], a[20:23]
    v_mfma_f32_16x16x32_bf16 a[16:19], v[48:51], a[104:107], a[16:19]
    v_mfma_f32_16x16x32_bf16 a[20:23], v[48:51], a[108:111], a[20:23]
    v_mfma_f32_16x16x32_bf16 a[16:19], v[52:55], a[112:115], a[16:19]
    v_mfma_f32_16x16x32_bf16 a[20:23], v[52:55], a[116:119], a[20:23]
    v_mfma_f32_16x16x32_bf16 a[16:19], v[56:59], a[120:123], a[16:19]
    v_mfma_f32_16x16x32_bf16 a[20:23], v[56:59], a[124:127], a[20:23]
    v_mfma_f32_16x16x32_bf16 a[16:19], v[60:63], a[128:131], a[16:19]
    v_mfma_f32_16x16x32_bf16 a[20:23], v[60:63], a[132:135], a[20:23]
    v_mfma_f32_16x16x32_bf16 a[16:19], v[64:67], a[136:139], a[16:19]
    v_mfma_f32_16x16x32_bf16 a[20:23], v[64:67], a[140:143], a[20:23]
    v_mfma_f32_16x16x32_bf16 a[16:19], v[68:71], a[144:147], a[16:19]
    v_mfma_f32_16x16x32_bf16 a[20:23], v[68:71], a[148:151], a[20:23]
    s_load_dwordx2 s[16:17], s[0:1], 152
    s_waitcnt lgkmcnt(0)
    s_add_u32 s16, s16, 61725696
    s_addc_u32 s17, s17, 0
    s_and_b32 s17, s17, 0xffff
    s_mov_b32 s18, 2621440
    s_mov_b32 s19, 0x20000
    s_nop 7
    s_nop 7
    s_mov_b32 s36, 0x3fb8aa3b
    v_mov_b32 v60, 0xff800000
    v_lshlrev_b32 v61, 2, v3
    v_cmp_gt_u32 s[38:39], 2, v3
    s_lshl_b32 s20, s5, 4
    s_add_u32 s20, s20, s4
    s_lshl_b32 s20, s20, 11
    v_lshrrev_b32 v62, 1, v3
    v_lshlrev_b32 v62, 8, v62
    v_lshl_add_u32 v62, v2, 4, v62
    v_and_b32 v63, 1, v3
    v_lshl_add_u32 v62, v63, 3, v62
    v_add_u32 v62, s20, v62
    s_lshl_b32 s20, s5, 2
    s_lshr_b32 s21, s4, 2
    s_add_u32 s20, s20, s21
    s_lshl_b32 s20, s20, 11
    s_and_b32 s21, s4, 3
    s_lshl_b32 s21, s21, 8
    s_add_u32 s20, s20, s21
    s_add_u32 s20, s20, 2097152
    v_lshlrev_b32 v63, 4, v2
    v_lshl_add_u32 v63, v3, 3, v63
    v_add_u32 v63, s20, v63
    v_mov_b32 v64, 0x7ffffff0
    v_cndmask_b32 v63, v64, v63, s[38:39]
    v_accvgpr_read_b32 v16, a0
    v_accvgpr_read_b32 v17, a1
    v_accvgpr_read_b32 v18, a2
    v_accvgpr_read_b32 v19, a3
    v_accvgpr_read_b32 v20, a8
    v_accvgpr_read_b32 v21, a9
    v_accvgpr_read_b32 v22, a10
    v_accvgpr_read_b32 v23, a11
    v_accvgpr_read_b32 v24, a16
    v_accvgpr_read_b32 v25, a17
    v_accvgpr_read_b32 v26, a18
    v_accvgpr_read_b32 v27, a19
    v_add_u32 v65, 0, v2
    v_add_u32 v66, 0, v61
    v_cmp_ge_u32 vcc, v65, v66
    s_nop 1
    v_cndmask_b32 v16, v60, v16, vcc
    v_add_u32 v66, 1, v61
    v_cmp_ge_u32 vcc, v65, v66
    s_nop 1
    v_cndmask_b32 v17, v60, v17, vcc
    v_add_u32 v66, 2, v61
    v_cmp_ge_u32 vcc, v65, v66
    s_nop 1
    v_cndmask_b32 v18, v60, v18, vcc
    v_add_u32 v66, 3, v61
    v_cmp_ge_u32 vcc, v65, v66
    s_nop 1
    v_cndmask_b32 v19, v60, v19, vcc
    v_add_u32 v66, 16, v61
    v_cmp_ge_u32 vcc, v65, v66
    s_nop 1
    v_cndmask_b32 v20, v60, v20, vcc
    v_add_u32 v66, 17, v61
    v_cmp_ge_u32 vcc, v65, v66
    s_nop 1
    v_cndmask_b32 v21, v60, v21, vcc
    v_add_u32 v66, 18, v61
    v_cmp_ge_u32 vcc, v65, v66
    s_nop 1
    v_cndmask_b32 v22, v60, v22, vcc
    v_add_u32 v66, 19, v61
    v_cmp_ge_u32 vcc, v65, v66
    s_nop 1
    v_cndmask_b32 v23, v60, v23, vcc
    v_cndmask_b32 v24, v60, v24, s[38:39]
    v_cndmask_b32 v25, v60, v25, s[38:39]
    v_cndmask_b32 v26, v60, v26, s[38:39]
    v_cndmask_b32 v27, v60, v27, s[38:39]
    v_max3_f32 v66, v16, v17, v18
    v_max3_f32 v66, v66, v19, v20
    v_max3_f32 v66, v66, v21, v22
    v_max3_f32 v66, v66, v23, v24
    v_max3_f32 v66, v66, v25, v26
    v_max_f32 v66, v66, v27
    v_mov_b32 v67, v66
    s_nop 1
    v_permlane16_swap_b32 v66, v67
    s_nop 1
    v_max_f32 v66, v66, v67
    v_mov_b32 v67, v66
    s_nop 1
    v_permlane32_swap_b32 v66, v67
    s_nop 1
    v_max_f32 v66, v66, v67
    v_mul_f32 v66, 0xbfb8aa3b, v66
    v_fma_f32 v16, v16, s36, v66
    v_exp_f32 v16, v16
    v_fma_f32 v17, v17, s36, v66
    v_exp_f32 v17, v17
    v_fma_f32 v18, v18, s36, v66
    v_exp_f32 v18, v18
    v_fma_f32 v19, v19, s36, v66
    v_exp_f32 v19, v19
    v_fma_f32 v20, v20, s36, v66
    v_exp_f32 v20, v20
    v_fma_f32 v21, v21, s36, v66
    v_exp_f32 v21, v21
    v_fma_f32 v22, v22, s36, v66
    v_exp_f32 v22, v22
    v_fma_f32 v23, v23, s36, v66
    v_exp_f32 v23, v23
    v_fma_f32 v24, v24, s36, v66
    v_exp_f32 v24, v24
    v_fma_f32 v25, v25, s36, v66
    v_exp_f32 v25, v25
    v_fma_f32 v26, v26, s36, v66
    v_exp_f32 v26, v26
    v_fma_f32 v27, v27, s36, v66
    v_exp_f32 v27, v27
    s_nop 0
    v_add_f32 v66, v16, v17
    v_add_f32 v66, v66, v18
    v_add_f32 v66, v66, v19
    v_add_f32 v66, v66, v20
    v_add_f32 v66, v66, v21
    v_add_f32 v66, v66, v22
    v_add_f32 v66, v66, v23
    v_add_f32 v66, v66, v24
    v_add_f32 v66, v66, v25
    v_add_f32 v66, v66, v26
    v_add_f32 v66, v66, v27
    v_mov_b32 v67, v66
    s_nop 1
    v_permlane16_swap_b32 v66, v67
    s_nop 1
    v_add_f32 v66, v66, v67
    v_mov_b32 v67, v66
    s_nop 1
    v_permlane32_swap_b32 v66, v67
    s_nop 1
    v_add_f32 v66, v66, v67
    v_rcp_f32 v66, v66
    s_nop 0
    v_mul_f32 v16, v16, v66
    v_mul_f32 v17, v17, v66
    v_mul_f32 v18, v18, v66
    v_mul_f32 v19, v19, v66
    v_mul_f32 v20, v20, v66
    v_mul_f32 v21, v21, v66
    v_mul_f32 v22, v22, v66
    v_mul_f32 v23, v23, v66
    v_mul_f32 v24, v24, v66
    v_mul_f32 v25, v25, v66
    v_mul_f32 v26, v26, v66
    v_mul_f32 v27, v27, v66
    v_cvt_pk_bf16_f32 v30, v16, v17
    v_cvt_pk_bf16_f32 v31, v18, v19
    v_cvt_pk_bf16_f32 v32, v20, v21
    v_cvt_pk_bf16_f32 v33, v22, v23
    v_cvt_pk_bf16_f32 v34, v24, v25
    v_cvt_pk_bf16_f32 v35, v26, v27
    buffer_store_dwordx2 v[30:31], v62, s[16:19], 0 offen offset:0 sc1
    buffer_store_dwordx2 v[32:33], v62, s[16:19], 0 offen offset:512 sc1
    buffer_store_dwordx2 v[34:35], v63, s[16:19], 0 offen offset:0 sc1
    s_nop 1
    v_accvgpr_read_b32 v16, a4
    v_accvgpr_read_b32 v17, a5
    v_accvgpr_read_b32 v18, a6
    v_accvgpr_read_b32 v19, a7
    v_accvgpr_read_b32 v20, a12
    v_accvgpr_read_b32 v21, a13
    v_accvgpr_read_b32 v22, a14
    v_accvgpr_read_b32 v23, a15
    v_accvgpr_read_b32 v24, a20
    v_accvgpr_read_b32 v25, a21
    v_accvgpr_read_b32 v26, a22
    v_accvgpr_read_b32 v27, a23
    v_add_u32 v65, 16, v2
    v_add_u32 v66, 0, v61
    v_cmp_ge_u32 vcc, v65, v66
    s_nop 1
    v_cndmask_b32 v16, v60, v16, vcc
    v_add_u32 v66, 1, v61
    v_cmp_ge_u32 vcc, v65, v66
    s_nop 1
    v_cndmask_b32 v17, v60, v17, vcc
    v_add_u32 v66, 2, v61
    v_cmp_ge_u32 vcc, v65, v66
    s_nop 1
    v_cndmask_b32 v18, v60, v18, vcc
    v_add_u32 v66, 3, v61
    v_cmp_ge_u32 vcc, v65, v66
    s_nop 1
    v_cndmask_b32 v19, v60, v19, vcc
    v_add_u32 v66, 16, v61
    v_cmp_ge_u32 vcc, v65, v66
    s_nop 1
    v_cndmask_b32 v20, v60, v20, vcc
    v_add_u32 v66, 17, v61
    v_cmp_ge_u32 vcc, v65, v66
    s_nop 1
    v_cndmask_b32 v21, v60, v21, vcc
    v_add_u32 v66, 18, v61
    v_cmp_ge_u32 vcc, v65, v66
    s_nop 1
    v_cndmask_b32 v22, v60, v22, vcc
    v_add_u32 v66, 19, v61
    v_cmp_ge_u32 vcc, v65, v66
    s_nop 1
    v_cndmask_b32 v23, v60, v23, vcc
    v_cndmask_b32 v24, v60, v24, s[38:39]
    v_cndmask_b32 v25, v60, v25, s[38:39]
    v_cndmask_b32 v26, v60, v26, s[38:39]
    v_cndmask_b32 v27, v60, v27, s[38:39]
    v_max3_f32 v66, v16, v17, v18
    v_max3_f32 v66, v66, v19, v20
    v_max3_f32 v66, v66, v21, v22
    v_max3_f32 v66, v66, v23, v24
    v_max3_f32 v66, v66, v25, v26
    v_max_f32 v66, v66, v27
    v_mov_b32 v67, v66
    s_nop 1
    v_permlane16_swap_b32 v66, v67
    s_nop 1
    v_max_f32 v66, v66, v67
    v_mov_b32 v67, v66
    s_nop 1
    v_permlane32_swap_b32 v66, v67
    s_nop 1
    v_max_f32 v66, v66, v67
    v_mul_f32 v66, 0xbfb8aa3b, v66
    v_fma_f32 v16, v16, s36, v66
    v_exp_f32 v16, v16
    v_fma_f32 v17, v17, s36, v66
    v_exp_f32 v17, v17
    v_fma_f32 v18, v18, s36, v66
    v_exp_f32 v18, v18
    v_fma_f32 v19, v19, s36, v66
    v_exp_f32 v19, v19
    v_fma_f32 v20, v20, s36, v66
    v_exp_f32 v20, v20
    v_fma_f32 v21, v21, s36, v66
    v_exp_f32 v21, v21
    v_fma_f32 v22, v22, s36, v66
    v_exp_f32 v22, v22
    v_fma_f32 v23, v23, s36, v66
    v_exp_f32 v23, v23
    v_fma_f32 v24, v24, s36, v66
    v_exp_f32 v24, v24
    v_fma_f32 v25, v25, s36, v66
    v_exp_f32 v25, v25
    v_fma_f32 v26, v26, s36, v66
    v_exp_f32 v26, v26
    v_fma_f32 v27, v27, s36, v66
    v_exp_f32 v27, v27
    s_nop 0
    v_add_f32 v66, v16, v17
    v_add_f32 v66, v66, v18
    v_add_f32 v66, v66, v19
    v_add_f32 v66, v66, v20
    v_add_f32 v66, v66, v21
    v_add_f32 v66, v66, v22
    v_add_f32 v66, v66, v23
    v_add_f32 v66, v66, v24
    v_add_f32 v66, v66, v25
    v_add_f32 v66, v66, v26
    v_add_f32 v66, v66, v27
    v_mov_b32 v67, v66
    s_nop 1
    v_permlane16_swap_b32 v66, v67
    s_nop 1
    v_add_f32 v66, v66, v67
    v_mov_b32 v67, v66
    s_nop 1
    v_permlane32_swap_b32 v66, v67
    s_nop 1
    v_add_f32 v66, v66, v67
    v_rcp_f32 v66, v66
    s_nop 0
    v_mul_f32 v16, v16, v66
    v_mul_f32 v17, v17, v66
    v_mul_f32 v18, v18, v66
    v_mul_f32 v19, v19, v66
    v_mul_f32 v20, v20, v66
    v_mul_f32 v21, v21, v66
    v_mul_f32 v22, v22, v66
    v_mul_f32 v23, v23, v66
    v_mul_f32 v24, v24, v66
    v_mul_f32 v25, v25, v66
    v_mul_f32 v26, v26, v66
    v_mul_f32 v27, v27, v66
    v_cvt_pk_bf16_f32 v30, v16, v17
    v_cvt_pk_bf16_f32 v31, v18, v19
    v_cvt_pk_bf16_f32 v32, v20, v21
    v_cvt_pk_bf16_f32 v33, v22, v23
    v_cvt_pk_bf16_f32 v34, v24, v25
    v_cvt_pk_bf16_f32 v35, v26, v27
    buffer_store_dwordx2 v[30:31], v62, s[16:19], 0 offen offset:1024 sc1
    buffer_store_dwordx2 v[32:33], v62, s[16:19], 0 offen offset:1536 sc1
    buffer_store_dwordx2 v[34:35], v63, s[16:19], 0 offen offset:1024 sc1
    s_nop 1
    s_branch wk_loop
wk_n4:
    s_cmp_lt_u32 s40, 1248
    s_cbranch_scc0 chain_end
    s_sub_u32 s40, s40, 992
    s_mov_b32 s41, -1
    s_lshr_b32 s20, s40, 4
    v_lshlrev_b32 v32, 2, v2
    v_add_u32 v32, 128, v32
    v_cmp_eq_u32 s[22:23], s20, v2
    s_mov_b32 s35, 2000000
wk_wb:
    global_load_dword v33, v32, s[42:43] sc1
    s_waitcnt vmcnt(0)
    v_bfe_u32 v33, v33, 16, 8
    v_cmp_gt_u32 vcc, 16, v33
    s_and_b64 vcc, vcc, s[22:23]
    s_cbranch_vccz wk_gb
    s_sleep 2
    s_cmp_eq_u32 s20, 15
    s_cbranch_scc1 wk_sb
    s_sleep 40
    wk_sb:
    s_sub_u32 s35, s35, 1
    s_cmp_lg_u32 s35, 0
    s_cbranch_scc1 wk_wb
    s_branch chain_end
wk_gb:
    s_load_dwordx2 s[32:33], s[0:1], 152
    s_waitcnt lgkmcnt(0)
    s_add_u32 s32, s32, 36904960
    s_addc_u32 s33, s33, 0
    s_and_b32 s33, s33, 0xffff
    s_mov_b32 s34, 465920
    s_mov_b32 s35, 0x20000
    s_lshr_b32 s20, s40, 2
    s_cmp_ge_u32 s20, 62
    s_cbranch_scc0 wk_su
    s_mov_b32 s36, 4000000
    v_mov_b32 v32, 72
wk_wl:
    global_load_dword v33, v32, s[42:43] sc1
    s_waitcnt vmcnt(0)
    v_cmp_gt_u32 vcc, 16, v33
    s_cbranch_vccz wk_gu
    s_sleep 1
    s_sub_u32 s36, s36, 1
    s_cmp_lg_u32 s36, 0
    s_cbranch_scc1 wk_wl
    s_branch chain_end
wk_su:
    s_sub_u32 s20, 62, s20
    s_mul_i32 s20, s20, 7168
    v_lshlrev_b32 v32, 4, v1
    v_cmp_gt_u32 vcc, 56, v1
    s_nop 1
    v_cndmask_b32 v32, 0, v32, vcc
    v_add_u32 v32, s20, v32
    s_mov_b32 s36, 2000000
wk_wu:
    buffer_load_dwordx4 v[36:39], v32, s[32:35], 0 offen sc1
    s_waitcnt vmcnt(0)
    v_max3_u32 v36, v36, v37, v38
    v_max_u32 v36, v36, v39
    v_cmp_eq_u32 vcc, -1, v36
    s_cbranch_vccz wk_gu
    s_sleep 40
    s_sub_u32 s36, s36, 1
    s_cmp_lg_u32 s36, 0
    s_cbranch_scc1 wk_wu
    s_branch chain_end
wk_gu:
    s_lshr_b32 s5, s40, 2
    s_and_b32 s4, s40, 3
    s_lshl_b32 s4, s4, 2
    s_add_u32 s4, s4, s3
    s_load_dwordx2 s[8:9], s[0:1], 152
    s_waitcnt lgkmcnt(0)
    s_add_u32 s8, s8, 44948480
    s_addc_u32 s9, s9, 0
    s_and_b32 s9, s9, 0xffff
    s_mov_b32 s10, 52953088
    s_mov_b32 s11, 0x20000
    s_load_dwordx2 s[12:13], s[0:1], 152
    s_waitcnt lgkmcnt(0)
    s_add_u32 s12, s12, 32112640
    s_addc_u32 s13, s13, 0
    s_and_b32 s13, s13, 0xffff
    s_mov_b32 s14, 3670016
    s_mov_b32 s15, 0x20000
    s_load_dwordx2 s[16:17], s[0:1], 136
    s_waitcnt lgkmcnt(0)
    s_and_b32 s17, s17, 0xffff
    s_mov_b32 s18, 3670016
    s_mov_b32 s19, 0x20000
    s_load_dwordx2 s[20:21], s[0:1], 152
    s_waitcnt lgkmcnt(0)
    s_add_u32 s20, s20, 37370880
    s_addc_u32 s21, s21, 0
    s_and_b32 s21, s21, 0xffff
    s_mov_b32 s22, 8192
    s_mov_b32 s23, 0x20000
    v_lshlrev_b32 v4, 4, v1
    s_lshl_b32 s24, s5, 4
    s_add_u32 s24, s24, s4
    s_mul_i32 s25, s24, 16384
    s_mul_i32 s24, s24, 32768
    s_add_u32 s24, s24, 19398656
    s_mul_i32 s26, s5, 32768
    s_add_u32 s26, s26, 16777216
    s_mul_i32 s27, s5, 8192
    s_add_u32 s27, s27, 18874368
    s_lshl_b32 s28, s5, 5
    v_add_u32 v5, s28, v2
    v_lshlrev_b32 v6, 2, v5
    v_mul_u32_u24 v5, 448, v5
    s_mul_i32 s28, s4, 28
    v_lshl_add_u32 v7, v3, 2, s28
    v_add_u32 v5, v5, v7
    v_lshlrev_b32 v5, 2, v5
    v_mov_b32 v8, 0x7ffffff0
    v_cmp_gt_u32 vcc, 3, v3
    v_add_u32 v9, 64, v5
    s_nop 0
    v_cndmask_b32 v9, v8, v9, vcc
    s_mov_b32 s28, 0
    buffer_load_dwordx4 v[16:19], v5, s[12:15], s28 offen sc1
    buffer_load_dwordx4 v[20:23], v9, s[12:15], s28 offen sc1
    buffer_load_dword v10, v6, s[20:23], 0 offen offset:0
    s_mov_b32 s28, 28672
    buffer_load_dwordx4 v[24:27], v5, s[12:15], s28 offen sc1
    buffer_load_dwordx4 v[28:31], v9, s[12:15], s28 offen sc1
    buffer_load_dword v11, v6, s[20:23], 0 offen offset:64
    s_add_u32 s28, s24, 0
    buffer_load_dwordx4 a[0:3], v4, s[8:11], s28 offen sc1
    s_add_u32 s28, s24, 1024
    buffer_load_dwordx4 a[4:7], v4, s[8:11], s28 offen sc1
    s_add_u32 s28, s24, 2048
    buffer_load_dwordx4 a[8:11], v4, s[8:11], s28 offen sc1
    s_add_u32 s28, s24, 3072
    buffer_load_dwordx4 a[12:15], v4, s[8:11], s28 offen sc1
    s_add_u32 s28, s24, 4096
    buffer_load_dwordx4 a[16:19], v4, s[8:11], s28 offen sc1
    s_add_u32 s28, s24, 5120
    buffer_load_dwordx4 a[20:23], v4, s[8:11], s28 offen sc1
    s_add_u32 s28, s24, 6144
    buffer_load_dwordx4 a[24:27], v4, s[8:11], s28 offen sc1
    s_add_u32 s28, s24, 7168
    buffer_load_dwordx4 a[28:31], v4, s[8:11], s28 offen sc1
    s_add_u32 s28, s24, 8192
    buffer_load_dwordx4 a[32:35], v4, s[8:11], s28 offen sc1
    s_add_u32 s28, s24, 9216
    buffer_load_dwordx4 a[36:39], v4, s[8:11], s28 offen sc1
    s_add_u32 s28, s24, 10240
    buffer_load_dwordx4 a[40:43], v4, s[8:11], s28 offen sc1
    s_add_u32 s28, s24, 11264
    buffer_load_dwordx4 a[44:47], v4, s[8:11], s28 offen sc1
    s_add_u32 s28, s24, 12288
    buffer_load_dwordx4 a[48:51], v4, s[8:11], s28 offen sc1
    s_add_u32 s28, s24, 13312
    buffer_load_dwordx4 a[52:55], v4, s[8:11], s28 offen sc1
    s_add_u32 s28, s24, 14336
    buffer_load_dwordx4 a[56:59], v4, s[8:11], s28 offen sc1
    s_add_u32 s28, s24, 15360
    buffer_load_dwordx4 a[60:63], v4, s[8:11], s28 offen sc1
    s_add_u32 s28, s24, 16384
    buffer_load_dwordx4 a[64:67], v4, s[8:11], s28 offen sc1
    s_add_u32 s28, s24, 17408
    buffer_load_dwordx4 a[68:71], v4, s[8:11], s28 offen sc1
    s_add_u32 s28, s24, 18432
    buffer_load_dwordx4 a[72:75], v4, s[8:11], s28 offen sc1
    s_add_u32 s28, s24, 19456
    buffer_load_dwordx4 a[76:79], v4, s[8:11], s28 offen sc1
    s_add_u32 s28, s24, 20480
    buffer_load_dwordx4 a[80:83], v4, s[8:11], s28 offen sc1
    s_add_u32 s28, s24, 21504
    buffer_load_dwordx4 a[84:87], v4, s[8:11], s28 offen sc1
    s_add_u32 s28, s24, 22528
    buffer_load_dwordx4 a[88:91], v4, s[8:11], s28 offen sc1
    s_add_u32 s28, s24, 23552
    buffer_load_dwordx4 a[92:95], v4, s[8:11], s28 offen sc1
    s_add_u32 s28, s24, 24576
    buffer_load_dwordx4 a[96:99], v4, s[8:11], s28 offen sc1
    s_add_u32 s28, s24, 25600
    buffer_load_dwordx4 a[100:103], v4, s[8:11], s28 offen sc1
    s_add_u32 s28, s24, 26624
    buffer_load_dwordx4 a[104:107], v4, s[8:11], s28 offen sc1
    s_add_u32 s28, s24, 27648
    buffer_load_dwordx4 a[108:111], v4, s[8:11], s28 offen sc1
    s_add_u32 s28, s24, 28672
    buffer_load_dwordx4 a[112:115], v4, s[8:11], s28 offen sc1
    s_add_u32 s28, s24, 29696
    buffer_load_dwordx4 a[116:119], v4, s[8:11], s28 offen sc1
    s_add_u32 s28, s24, 30720
    buffer_load_dwordx4 a[120:123], v4, s[8:11], s28 offen sc1
    s_add_u32 s28, s24, 31744
    buffer_load_dwordx4 a[124:127], v4, s[8:11], s28 offen sc1
    s_add_u32 s28, s25, 0
    buffer_load_dwordx4 a[128:131], v4, s[8:11], s28 offen sc1
    s_add_u32 s28, s25, 2048
    buffer_load_dwordx4 a[132:135], v4, s[8:11], s28 offen sc1
    s_add_u32 s28, s25, 1024
    buffer_load_dwordx4 a[136:139], v4, s[8:11], s28 offen sc1
    s_add_u32 s28, s25, 3072
    buffer_load_dwordx4 a[140:143], v4, s[8:11], s28 offen sc1
    s_add_u32 s28, s25, 4096
    buffer_load_dwordx4 a[144:147], v4, s[8:11], s28 offen sc1
    s_add_u32 s28, s25, 6144
    buffer_load_dwordx4 a[148:151], v4, s[8:11], s28 offen sc1
    s_add_u32 s28, s25, 5120
    buffer_load_dwordx4 a[152:155], v4, s[8:11], s28 offen sc1
    s_add_u32 s28, s25, 7168
    buffer_load_dwordx4 a[156:159], v4, s[8:11], s28 offen sc1
    s_add_u32 s28, s25, 8192
    buffer_load_dwordx4 a[160:163], v4, s[8:11], s28 offen sc1
    s_add_u32 s28, s25, 10240
    buffer_load_dwordx4 a[164:167], v4, s[8:11], s28 offen sc1
    s_add_u32 s28, s25, 9216
    buffer_load_dwordx4 a[168:171], v4, s[8:11], s28 offen sc1
    s_add_u32 s28, s25, 11264
    buffer_load_dwordx4 a[172:175], v4, s[8:11], s28 offen sc1
    s_add_u32 s28, s25, 12288
    buffer_load_dwordx4 a[176:179], v4, s[8:11], s28 offen sc1
    s_add_u32 s28, s25, 14336
    buffer_load_dwordx4 a[180:183], v4, s[8:11], s28 offen sc1
    s_add_u32 s28, s25, 13312
    buffer_load_dwordx4 a[184:187], v4, s[8:11], s28 offen sc1
    s_add_u32 s28, s25, 15360
    buffer_load_dwordx4 a[188:191], v4, s[8:11], s28 offen sc1
    s_lshr_b32 s20, s40, 4
    v_lshlrev_b32 v32, 2, v2
    v_add_u32 v32, 128, v32
    v_cmp_eq_u32 s[22:23], s20, v2
    s_mov_b32 s35, 2000000
wk_wp:
    global_load_dword v33, v32, s[42:43] sc1
    s_waitcnt vmcnt(0)
    v_bfe_u32 v33, v33, 24, 8
    v_cmp_gt_u32 vcc, 16, v33
    s_and_b64 vcc, vcc, s[22:23]
    s_cbranch_vccz wk_gp
    s_sleep 2
    s_cmp_eq_u32 s20, 15
    s_cbranch_scc1 wk_sp
    s_sleep 40
    wk_sp:
    s_sub_u32 s35, s35, 1
    s_cmp_lg_u32 s35, 0
    s_cbranch_scc1 wk_wp
    s_branch chain_end
wk_gp:
    s_add_u32 s28, s26, 0
    buffer_load_dwordx4 v[64:67], v4, s[8:11], s28 offen sc1
    s_add_u32 s28, s26, 1024
    buffer_load_dwordx4 v[68:71], v4, s[8:11], s28 offen sc1
    s_add_u32 s28, s26, 2048
    buffer_load_dwordx4 v[72:75], v4, s[8:11], s28 offen sc1
    s_add_u32 s28, s26, 3072
    buffer_load_dwordx4 v[76:79], v4, s[8:11], s28 offen sc1
    s_add_u32 s28, s26, 4096
    buffer_load_dwordx4 v[80:83], v4, s[8:11], s28 offen sc1
    s_add_u32 s28, s26, 5120
    buffer_load_dwordx4 v[84:87], v4, s[8:11], s28 offen sc1
    s_add_u32 s28, s26, 6144
    buffer_load_dwordx4 v[88:91], v4, s[8:11], s28 offen sc1
    s_add_u32 s28, s26, 7168
    buffer_load_dwordx4 v[92:95], v4, s[8:11], s28 offen sc1
    s_add_u32 s28, s26, 8192
    buffer_load_dwordx4 v[96:99], v4, s[8:11], s28 offen sc1
    s_add_u32 s28, s26, 9216
    buffer_load_dwordx4 v[100:103], v4, s[8:11], s28 offen sc1
    s_add_u32 s28, s26, 10240
    buffer_load_dwordx4 v[104:107], v4, s[8:11], s28 offen sc1
    s_add_u32 s28, s26, 11264
    buffer_load_dwordx4 v[108:111], v4, s[8:11], s28 offen sc1
    s_add_u32 s28, s26, 12288
    buffer_load_dwordx4 v[112:115], v4, s[8:11], s28 offen sc1
    s_add_u32 s28, s26, 13312
    buffer_load_dwordx4 v[116:119], v4, s[8:11], s28 offen sc1
    s_add_u32 s28, s26, 14336
    buffer_load_dwordx4 v[120:123], v4, s[8:11], s28 offen sc1
    s_add_u32 s28, s26, 15360
    buffer_load_dwordx4 v[124:127], v4, s[8:11], s28 offen sc1
    s_add_u32 s28, s26, 16384
    buffer_load_dwordx4 v[128:131], v4, s[8:11], s28 offen sc1
    s_add_u32 s28, s26, 17408
    buffer_load_dwordx4 v[132:135], v4, s[8:11], s28 offen sc1
    s_add_u32 s28, s26, 18432
    buffer_load_dwordx4 v[136:139], v4, s[8:11], s28 offen sc1
    s_add_u32 s28, s26, 19456
    buffer_load_dwordx4 v[140:143], v4, s[8:11], s28 offen sc1
    s_add_u32 s28, s26, 20480
    buffer_load_dwordx4 v[144:147], v4, s[8:11], s28 offen sc1
    s_add_u32 s28, s26, 21504
    buffer_load_dwordx4 v[148:151], v4, s[8:11], s28 offen sc1
    s_add_u32 s28, s26, 22528
    buffer_load_dwordx4 v[152:155], v4, s[8:11], s28 offen sc1
    s_add_u32 s28, s26, 23552
    buffer_load_dwordx4 v[156:159], v4, s[8:11], s28 offen sc1
    s_add_u32 s28, s26, 24576
    buffer_load_dwordx4 v[160:163], v4, s[8:11], s28 offen sc1
    s_add_u32 s28, s26, 25600
    buffer_load_dwordx4 v[164:167], v4, s[8:11], s28 offen sc1
    s_add_u32 s28, s26, 26624
    buffer_load_dwordx4 v[168:171], v4, s[8:11], s28 offen sc1
    s_add_u32 s28, s26, 27648
    buffer_load_dwordx4 v[172:175], v4, s[8:11], s28 offen sc1
    s_add_u32 s28, s26, 28672
    buffer_load_dwordx4 v[176:179], v4, s[8:11], s28 offen sc1
    s_add_u32 s28, s26, 29696
    buffer_load_dwordx4 v[180:183], v4, s[8:11], s28 offen sc1
    s_add_u32 s28, s26, 30720
    buffer_load_dwordx4 v[184:187], v4, s[8:11], s28 offen sc1
    s_add_u32 s28, s26, 31744
    buffer_load_dwordx4 v[188:191], v4, s[8:11], s28 offen sc1
    s_add_u32 s28, s27, 0
    buffer_load_dwordx4 v[192:195], v4, s[8:11], s28 offen sc1
    s_add_u32 s28, s27, 1024
    buffer_load_dwordx4 v[196:199], v4, s[8:11], s28 offen sc1
    s_add_u32 s28, s27, 2048
    buffer_load_dwordx4 v[200:203], v4, s[8:11], s28 offen sc1
    s_add_u32 s28, s27, 3072
    buffer_load_dwordx4 v[204:207], v4, s[8:11], s28 offen sc1
    s_add_u32 s28, s27, 4096
    buffer_load_dwordx4 v[208:211], v4, s[8:11], s28 offen sc1
    s_add_u32 s28, s27, 5120
    buffer_load_dwordx4 v[212:215], v4, s[8:11], s28 offen sc1
    s_add_u32 s28, s27, 6144
    buffer_load_dwordx4 v[216:219], v4, s[8:11], s28 offen sc1
    s_add_u32 s28, s27, 7168
    buffer_load_dwordx4 v[220:223], v4, s[8:11], s28 offen sc1
    s_waitcnt vmcnt(38)
    v_mfma_f32_16x16x32_bf16 v[40:43], a[0:3], v[64:67], 0
    v_mfma_f32_16x16x32_bf16 v[44:47], a[0:3], v[68:71], 0
    v_mfma_f32_16x16x32_bf16 v[48:51], a[4:7], v[64:67], 0
    v_mfma_f32_16x16x32_bf16 v[52:55], a[4:7], v[68:71], 0
    s_waitcnt vmcnt(36)
    v_mfma_f32_16x16x32_bf16 v[40:43], a[8:11], v[72:75], v[40:43]
    v_mfma_f32_16x16x32_bf16 v[44:47], a[8:11], v[76:79], v[44:47]
    v_mfma_f32_16x16x32_bf16 v[48:51], a[12:15], v[72:75], v[48:51]
    v_mfma_f32_16x16x32_bf16 v[52:55], a[12:15], v[76:79], v[52:55]
    s_waitcnt vmcnt(34)
    v_mfma_f32_16x16x32_bf16 v[40:43], a[16:19], v[80:83], v[40:43]
    v_mfma_f32_16x16x32_bf16 v[44:47], a[16:19], v[84:87], v[44:47]
    v_mfma_f32_16x16x32_bf16 v[48:51], a[20:23], v[80:83], v[48:51]
    v_mfma_f32_16x16x32_bf16 v[52:55], a[20:23], v[84:87], v[52:55]
    s_waitcnt vmcnt(32)
    v_mfma_f32_16x16x32_bf16 v[40:43], a[24:27], v[88:91], v[40:43]
    v_mfma_f32_16x16x32_bf16 v[44:47], a[24:27], v[92:95], v[44:47]
    v_mfma_f32_16x16x32_bf16 v[48:51], a[28:31], v[88:91], v[48:51]
    v_mfma_f32_16x16x32_bf16 v[52:55], a[28:31], v[92:95], v[52:55]
    s_waitcnt vmcnt(30)
    v_mfma_f32_16x16x32_bf16 v[40:43], a[32:35], v[96:99], v[40:43]
    v_mfma_f32_16x16x32_bf16 v[44:47], a[32:35], v[100:103], v[44:47]
    v_mfma_f32_16x16x32_bf16 v[48:51], a[36:39], v[96:99], v[48:51]
    v_mfma_f32_16x16x32_bf16 v[52:55], a[36:39], v[100:103], v[52:55]
    s_waitcnt vmcnt(28)
    v_mfma_f32_16x16x32_bf16 v[40:43], a[40:43], v[104:107], v[40:43]
    v_mfma_f32_16x16x32_bf16 v[44:47], a[40:43], v[108:111], v[44:47]
    v_mfma_f32_16x16x32_bf16 v[48:51], a[44:47], v[104:107], v[48:51]
    v_mfma_f32_16x16x32_bf16 v[52:55], a[44:47], v[108:111], v[52:55]
    s_waitcnt vmcnt(26)
    v_mfma_f32_16x16x32_bf16 v[40:43], a[48:51], v[112:115], v[40:43]
    v_mfma_f32_16x16x32_bf16 v[44:47], a[48:51], v[116:119], v[44:47]
    v_mfma_f32_16x16x32_bf16 v[48:51], a[52:55], v[112:115], v[48:51]
    v_mfma_f32_16x16x32_bf16 v[52:55], a[52:55], v[116:119], v[52:55]
    s_waitcnt vmcnt(24)
    v_mfma_f32_16x16x32_bf16 v[40:43], a[56:59], v[120:123], v[40:43]
    v_mfma_f32_16x16x32_bf16 v[44:47], a[56:59], v[124:127], v[44:47]
    v_mfma_f32_16x16x32_bf16 v[48:51], a[60:63], v[120:123], v[48:51]
    v_mfma_f32_16x16x32_bf16 v[52:55], a[60:63], v[124:127], v[52:55]
    s_waitcnt vmcnt(22)
    v_mfma_f32_16x16x32_bf16 v[40:43], a[64:67], v[128:131], v[40:43]
    v_mfma_f32_16x16x32_bf16 v[44:47], a[64:67], v[132:135], v[44:47]
    v_mfma_f32_16x16x32_bf16 v[48:51], a[68:71], v[128:131], v[48:51]
    v_mfma_f32_16x16x32_bf16 v[52:55], a[68:71], v[132:135], v[52:55]
    s_waitcnt vmcnt(20)
    v_mfma_f32_16x16x32_bf16 v[40:43], a[72:75], v[136:139], v[40:43]
    v_mfma_f32_16x16x32_bf16 v[44:47], a[72:75], v[140:143], v[44:47]
    v_mfma_f32_16x16x32_bf16 v[48:51], a[76:79], v[136:139], v[48:51]
    v_mfma_f32_16x16x32_bf16 v[52:55], a[76:79], v[140:143], v[52:55]
    s_waitcnt vmcnt(18)
    v_mfma_f32_16x16x32_bf16 v[40:43], a[80:83], v[144:147], v[40:43]
    v_mfma_f32_16x16x32_bf16 v[44:47], a[80:83], v[148:151], v[44:47]
    v_mfma_f32_16x16x32_bf16 v[48:51], a[84:87], v[144:147], v[48:51]
    v_mfma_f32_16x16x32_bf16 v[52:55], a[84:87], v[148:151], v[52:55]
    s_waitcnt vmcnt(16)
    v_mfma_f32_16x16x32_bf16 v[40:43], a[88:91], v[152:155], v[40:43]
    v_mfma_f32_16x16x32_bf16 v[44:47], a[88:91], v[156:159], v[44:47]
    v_mfma_f32_16x16x32_bf16 v[48:51], a[92:95], v[152:155], v[48:51]
    v_mfma_f32_16x16x32_bf16 v[52:55], a[92:95], v[156:159], v[52:55]
    s_waitcnt vmcnt(14)
    v_mfma_f32_16x16x32_bf16 v[40:43], a[96:99], v[160:163], v[40:43]
    v_mfma_f32_16x16x32_bf16 v[44:47], a[96:99], v[164:167], v[44:47]
    v_mfma_f32_16x16x32_bf16 v[48:51], a[100:103], v[160:163], v[48:51]
    v_mfma_f32_16x16x32_bf16 v[52:55], a[100:103], v[164:167], v[52:55]
    s_waitcnt vmcnt(12)
    v_mfma_f32_16x16x32_bf16 v[40:43], a[104:107], v[168:171], v[40:43]
    v_mfma_f32_16x16x32_bf16 v[44:47], a[104:107], v[172:175], v[44:47]
    v_mfma_f32_16x16x32_bf16 v[48:51], a[108:111], v[168:171], v[48:51]
    v_mfma_f32_16x16x32_bf16 v[52:55], a[108:111], v[172:175], v[52:55]
    s_waitcnt vmcnt(10)
    v_mfma_f32_16x16x32_bf16 v[40:43], a[112:115], v[176:179], v[40:43]
    v_mfma_f32_16x16x32_bf16 v[44:47], a[112:115], v[180:183], v[44:47]
    v_mfma_f32_16x16x32_bf16 v[48:51], a[116:119], v[176:179], v[48:51]
    v_mfma_f32_16x16x32_bf16 v[52:55], a[116:119], v[180:183], v[52:55]
    s_waitcnt vmcnt(8)
    v_mfma_f32_16x16x32_bf16 v[40:43], a[120:123], v[184:187], v[40:43]
    v_mfma_f32_16x16x32_bf16 v[44:47], a[120:123], v[188:191], v[44:47]
    v_mfma_f32_16x16x32_bf16 v[48:51], a[124:127], v[184:187], v[48:51]
    v_mfma_f32_16x16x32_bf16 v[52:55], a[124:127], v[188:191], v[52:55]
    s_waitcnt vmcnt(0)
    v_mfma_f32_16x16x32_bf16 v[40:43], a[128:131], v[192:195], v[40:43]
    v_mfma_f32_16x16x32_bf16 v[44:47], a[128:131], v[196:199], v[44:47]
    v_mfma_f32_16x16x32_bf16 v[48:51], a[132:135], v[192:195], v[48:51]
    v_mfma_f32_16x16x32_bf16 v[52:55], a[132:135], v[196:199], v[52:55]
    v_mfma_f32_16x16x32_bf16 v[40:43], a[136:139], v[192:195], v[40:43]
    v_mfma_f32_16x16x32_bf16 v[44:47], a[136:139], v[196:199], v[44:47]
    v_mfma_f32_16x16x32_bf16 v[48:51], a[140:143], v[192:195], v[48:51]
    v_mfma_f32_16x16x32_bf16 v[52:55], a[140:143], v[196:199], v[52:55]
    v_mfma_f32_16x16x32_bf16 v[40:43], a[144:147], v[200:203], v[40:43]
    v_mfma_f32_16x16x32_bf16 v[44:47], a[144:147], v[204:207], v[44:47]
    v_mfma_f32_16x16x32_bf16 v[48:51], a[148:151], v[200:203], v[48:51]
    v_mfma_f32_16x16x32_bf16 v[52:55], a[148:151], v[204:207], v[52:55]
    v_mfma_f32_16x16x32_bf16 v[40:43], a[152:155], v[200:203], v[40:43]
    v_mfma_f32_16x16x32_bf16 v[44:47], a[152:155], v[204:207], v[44:47]
    v_mfma_f32_16x16x32_bf16 v[48:51], a[156:159], v[200:203], v[48:51]
    v_mfma_f32_16x16x32_bf16 v[52:55], a[156:159], v[204:207], v[52:55]
    v_mfma_f32_16x16x32_bf16 v[40:43], a[160:163], v[208:211], v[40:43]
    v_mfma_f32_16x16x32_bf16 v[44:47], a[160:163], v[212:215], v[44:47]
    v_mfma_f32_16x16x32_bf16 v[48:51], a[164:167], v[208:211], v[48:51]
    v_mfma_f32_16x16x32_bf16 v[52:55], a[164:167], v[212:215], v[52:55]
    v_mfma_f32_16x16x32_bf16 v[40:43], a[168:171], v[208:211], v[40:43]
    v_mfma_f32_16x16x32_bf16 v[44:47], a[168:171], v[212:215], v[44:47]
    v_mfma_f32_16x16x32_bf16 v[48:51], a[172:175], v[208:211], v[48:51]
    v_mfma_f32_16x16x32_bf16 v[52:55], a[172:175], v[212:215], v[52:55]
    v_mfma_f32_16x16x32_bf16 v[40:43], a[176:179], v[216:219], v[40:43]
    v_mfma_f32_16x16x32_bf16 v[44:47], a[176:179], v[220:223], v[44:47]
    v_mfma_f32_16x16x32_bf16 v[48:51], a[180:183], v[216:219], v[48:51]
    v_mfma_f32_16x16x32_bf16 v[52:55], a[180:183], v[220:223], v[52:55]
    v_mfma_f32_16x16x32_bf16 v[40:43], a[184:187], v[216:219], v[40:43]
    v_mfma_f32_16x16x32_bf16 v[44:47], a[184:187], v[220:223], v[44:47]
    v_mfma_f32_16x16x32_bf16 v[48:51], a[188:191], v[216:219], v[48:51]
    v_mfma_f32_16x16x32_bf16 v[52:55], a[188:191], v[220:223], v[52:55]
    s_nop 7
    s_nop 7
    v_sub_f32 v12, 1.0, v10
    v_cvt_pk_bf16_f32 v12, v12, v12
    v_lshlrev_b32 v12, 16, v12
    v_cvt_pk_bf16_f32 v13, v40, v40
    v_lshlrev_b32 v13, 16, v13
    v_mul_f32 v13, v12, v13
    v_cvt_pk_bf16_f32 v13, v13, v13
    v_lshlrev_b32 v13, 16, v13
    v_add_f32 v16, v16, v13
    v_cvt_pk_bf16_f32 v13, v41, v41
    v_lshlrev_b32 v13, 16, v13
    v_mul_f32 v13, v12, v13
    v_cvt_pk_bf16_f32 v13, v13, v13
    v_lshlrev_b32 v13, 16, v13
    v_add_f32 v17, v17, v13
    v_cvt_pk_bf16_f32 v13, v42, v42
    v_lshlrev_b32 v13, 16, v13
    v_mul_f32 v13, v12, v13
    v_cvt_pk_bf16_f32 v13, v13, v13
    v_lshlrev_b32 v13, 16, v13
    v_add_f32 v18, v18, v13
    v_cvt_pk_bf16_f32 v13, v43, v43
    v_lshlrev_b32 v13, 16, v13
    v_mul_f32 v13, v12, v13
    v_cvt_pk_bf16_f32 v13, v13, v13
    v_lshlrev_b32 v13, 16, v13
    v_add_f32 v19, v19, v13
    s_mov_b32 s28, 0
    buffer_store_dwordx4 v[16:19], v5, s[16:19], s28 offen
    s_nop 1
    v_cvt_pk_bf16_f32 v13, v48, v48
    v_lshlrev_b32 v13, 16, v13
    v_mul_f32 v13, v12, v13
    v_cvt_pk_bf16_f32 v13, v13, v13
    v_lshlrev_b32 v13, 16, v13
    v_add_f32 v20, v20, v13
    v_cvt_pk_bf16_f32 v13, v49, v49
    v_lshlrev_b32 v13, 16, v13
    v_mul_f32 v13, v12, v13
    v_cvt_pk_bf16_f32 v13, v13, v13
    v_lshlrev_b32 v13, 16, v13
    v_add_f32 v21, v21, v13
    v_cvt_pk_bf16_f32 v13, v50, v50
    v_lshlrev_b32 v13, 16, v13
    v_mul_f32 v13, v12, v13
    v_cvt_pk_bf16_f32 v13, v13, v13
    v_lshlrev_b32 v13, 16, v13
    v_add_f32 v22, v22, v13
    v_cvt_pk_bf16_f32 v13, v51, v51
    v_lshlrev_b32 v13, 16, v13
    v_mul_f32 v13, v12, v13
    v_cvt_pk_bf16_f32 v13, v13, v13
    v_lshlrev_b32 v13, 16, v13
    v_add_f32 v23, v23, v13
    s_mov_b32 s28, 0
    buffer_store_dwordx4 v[20:23], v9, s[16:19], s28 offen
    s_nop 1
    v_sub_f32 v12, 1.0, v11
    v_cvt_pk_bf16_f32 v12, v12, v12
    v_lshlrev_b32 v12, 16, v12
    v_cvt_pk_bf16_f32 v13, v44, v44
    v_lshlrev_b32 v13, 16, v13
    v_mul_f32 v13, v12, v13
    v_cvt_pk_bf16_f32 v13, v13, v13
    v_lshlrev_b32 v13, 16, v13
    v_add_f32 v24, v24, v13
    v_cvt_pk_bf16_f32 v13, v45, v45
    v_lshlrev_b32 v13, 16, v13
    v_mul_f32 v13, v12, v13
    v_cvt_pk_bf16_f32 v13, v13, v13
    v_lshlrev_b32 v13, 16, v13
    v_add_f32 v25, v25, v13
    v_cvt_pk_bf16_f32 v13, v46, v46
    v_lshlrev_b32 v13, 16, v13
    v_mul_f32 v13, v12, v13
    v_cvt_pk_bf16_f32 v13, v13, v13
    v_lshlrev_b32 v13, 16, v13
    v_add_f32 v26, v26, v13
    v_cvt_pk_bf16_f32 v13, v47, v47
    v_lshlrev_b32 v13, 16, v13
    v_mul_f32 v13, v12, v13
    v_cvt_pk_bf16_f32 v13, v13, v13
    v_lshlrev_b32 v13, 16, v13
    v_add_f32 v27, v27, v13
    s_mov_b32 s28, 28672
    buffer_store_dwordx4 v[24:27], v5, s[16:19], s28 offen
    s_nop 1
    v_cvt_pk_bf16_f32 v13, v52, v52
    v_lshlrev_b32 v13, 16, v13
    v_mul_f32 v13, v12, v13
    v_cvt_pk_bf16_f32 v13, v13, v13
    v_lshlrev_b32 v13, 16, v13
    v_add_f32 v28, v28, v13
    v_cvt_pk_bf16_f32 v13, v53, v53
    v_lshlrev_b32 v13, 16, v13
    v_mul_f32 v13, v12, v13
    v_cvt_pk_bf16_f32 v13, v13, v13
    v_lshlrev_b32 v13, 16, v13
    v_add_f32 v29, v29, v13
    v_cvt_pk_bf16_f32 v13, v54, v54
    v_lshlrev_b32 v13, 16, v13
    v_mul_f32 v13, v12, v13
    v_cvt_pk_bf16_f32 v13, v13, v13
    v_lshlrev_b32 v13, 16, v13
    v_add_f32 v30, v30, v13
    v_cvt_pk_bf16_f32 v13, v55, v55
    v_lshlrev_b32 v13, 16, v13
    v_mul_f32 v13, v12, v13
    v_cvt_pk_bf16_f32 v13, v13, v13
    v_lshlrev_b32 v13, 16, v13
    v_add_f32 v31, v31, v13
    s_mov_b32 s28, 28672
    buffer_store_dwordx4 v[28:31], v9, s[16:19], s28 offen
    s_nop 1
    s_branch wk_loop
chain_end:
    s_endpgm
.section .rodata,"a"
.p2align 6
.amdhsa_kernel prep_kernel
  .amdhsa_next_free_vgpr 224
  .amdhsa_next_free_sgpr 102
  .amdhsa_accum_offset 224
  .amdhsa_group_segment_fixed_size 0
  .amdhsa_kernarg_size 160
  .amdhsa_user_sgpr_count 2
  .amdhsa_user_sgpr_kernarg_segment_ptr 1
  .amdhsa_system_sgpr_workgroup_id_x 1
.end_amdhsa_kernel
.p2align 6
.amdhsa_kernel chain_kernel
  .amdhsa_next_free_vgpr 512
  .amdhsa_next_free_sgpr 102
  .amdhsa_accum_offset 256
  .amdhsa_group_segment_fixed_size 0
  .amdhsa_kernarg_size 160
  .amdhsa_user_sgpr_count 2
  .amdhsa_user_sgpr_kernarg_segment_ptr 1
  .amdhsa_system_sgpr_workgroup_id_x 1
.end_amdhsa_kernel
```
